```python
import torch

def _softmax(x, axis=-1):
    return torch.softmax(x, dim=axis)
def _gelu(x):
    return torch.nn.functional.gelu(x, approximate="tanh")
def _silu(x):
    return torch.nn.functional.silu(x)
def _sigmoid(x):
    return torch.sigmoid(x)
def _layernorm(x, axis=-1, eps=1e-5):
    m = x.mean(dim=axis, keepdim=True)
    v = x.var(dim=axis, keepdim=True, unbiased=False)
    return (x - m) / torch.sqrt(v + eps)
def _scatter_add(tgt, idx, src, axis=0):
    return tgt.clone().index_add_(axis, idx, src)
def _segment_sum(src, seg, n):
    out = torch.zeros((n,) + src.shape[1:], dtype=src.dtype)
    return out.index_add_(0, seg, src)
def _pad(x, pw):
    flat = tuple(v for pair in reversed(pw) for v in pair)
    return torch.nn.functional.pad(x, flat)

kernel_name = 'parallel_sum__linear_attn_block__mixer_token_mlp__prompt'

def setup_inputs():

    _w = (lambda a: (lambda t: t.to(torch.bfloat16) if t.is_floating_point() else t)(torch.as_tensor(a)))
    def _A_setup():
        B, S, D = 1, 2048, 512
        return {
            "x": _w((lambda *s: torch.randn(*s, dtype=torch.bfloat16) * 0.05)(B, S, D)),
            "wqkv": _w((lambda *s: torch.randn(*s, dtype=torch.bfloat16) * 0.05)(D, 3 * D)),
            "wo": _w((lambda *s: torch.randn(*s, dtype=torch.bfloat16) * 0.05)(D, D)),
        }
    _A_in = _A_setup()

    def _B_setup():
        B, S, D, F = 1, 2048, 512, 1376
        return {
            "x": _w((lambda *s: torch.randn(*s, dtype=torch.bfloat16) * 0.05)(B, S, D)),
            "w1": _w((lambda *s: torch.randn(*s, dtype=torch.bfloat16) * 0.4)(S, F) * (S ** -0.5)),
            "b1": _w((lambda *s: torch.randn(*s, dtype=torch.bfloat16) * 3.2)(F) * 0.02),
            "w2": _w((lambda *s: torch.randn(*s, dtype=torch.bfloat16) * 0.2)(F, S) * (F ** -0.5)),
            "b2": _w((lambda *s: torch.randn(*s, dtype=torch.bfloat16) * 0.8)(S) * 0.02),
        }
    _B_in = _B_setup()

    return {
        "A_x": _A_in["x"],
        "A_wqkv": _A_in["wqkv"],
        "A_wo": _A_in["wo"],
        "B_x": _B_in["x"],
        "B_w1": _B_in["w1"],
        "B_b1": _B_in["b1"],
        "B_w2": _B_in["w2"],
        "B_b2": _B_in["b2"],
    }

def reference(A_x, A_wqkv, A_wo, B_x, B_w1, B_b1, B_w2, B_b2):
    def _A_ref(x, wqkv, wo):
        B, S, D = x.shape
        H = 32; Dh = D // H
        qkv = (lambda x, *d: x.permute(*d))((x @ wqkv).reshape(B, S, 3, H, Dh), 2, 0, 3, 1, 4)
        q, k, v = qkv[0], qkv[1], qkv[2]
        phi = lambda t: torch.where(t > 0, t + 1, torch.exp(t)) + 1e-6
        pq, pk = phi(q), phi(k)
        kv = torch.einsum("bhsd,bhse->bhde", pk, v)
        z = torch.einsum("bhsd->bhd", pk)
        num = torch.einsum("bhqd,bhde->bhqe", pq, kv)
        den = torch.einsum("bhqd,bhd->bhq", pq, z)[..., None] + 1e-6
        o = num / den
        return (lambda x, *d: x.permute(*d))(o, 0, 2, 1, 3).reshape(B, S, D) @ wo

    def _B_ref(x, w1, b1, w2, b2):
        B, S, D = x.shape
        h = _layernorm(x, axis=-1)
        u = torch.einsum("bsd,sf->bdf", h, w1) + b1
        u = _gelu(u)
        y = torch.einsum("bdf,fs->bds", u, w2) + b2
        return (lambda x, *d: x.permute(*d))(y, 0, 2, 1)

    x = A_x
    xn = _layernorm(x, axis=-1)
    return x + _A_ref(xn, A_wqkv, A_wo) + _B_ref(xn, B_w1, B_b1, B_w2, B_b2)
```

```asm
; @launch grid=(256,1,1) block=(256,1,1) lds=163840
.amdgcn_target "amdgcn-amd-amdhsa--gfx950"
.text
.globl parallel_sum__linear_attn_block__mixer_token_mlp__prompt_kernel
.p2align 8
.type parallel_sum__linear_attn_block__mixer_token_mlp__prompt_kernel,@function
parallel_sum__linear_attn_block__mixer_token_mlp__prompt_kernel:
  s_cmp_ge_u32 s2, 256
  s_cbranch_scc1 END
  s_load_dwordx16 s[4:19], s[0:1], 0
  s_load_dwordx4 s[20:23], s[0:1], 64
  s_load_dwordx2 s[24:25], s[0:1], 80
  v_lshrrev_b32 v255, 6, v0
  s_and_b32 s27, s2, 7
  v_readfirstlane_b32 s26, v255
  s_lshr_b32 s40, s2, 3
  s_xor_b32 s40, s40, 16
  s_xor_b32 s2, s2, 128
  v_and_b32 v255, 63, v0
  s_getpc_b64 s[50:51]
CODEBASE:
  s_cmp_ge_u32 s40, 16
  s_cselect_b32 s45, QBODY-PSTART, 0
  s_add_u32 s45, s45, PSTART-CODEBASE
  s_and_b32 s44, s40, 15
  s_lshl_b32 s44, s44, 2
  s_add_u32 s44, s44, s26
  s_lshl_b32 s44, s44, 7
  s_add_u32 s44, s44, s45
  v_mul_u32_u24 v252, 8192, v255
  v_add_u32 v252, s44, v252
  v_min_u32 v252, CODEEND-CODEBASE-4, v252
  s_mov_b64 exec, 0x7
  global_load_dword v253, v252, s[50:51]
  s_mov_b64 exec, -1
  v_lshlrev_b32 v254, 4, v255
  s_mul_i32 s43, s26, 40960
  s_cmp_lt_u32 s40, 16
  s_cbranch_scc1 PSTART
  s_lshl_b32 s41, s27, 4
  s_and_b32 s44, s40, 15
  s_add_u32 s41, s41, s44
  s_lshl_b32 s41, s41, 1
  s_add_u32 s41, s41, 1
  s_lshl_b32 s44, s41, 2
  s_add_u32 s44, s44, s26
  s_lshl_b32 s44, s44, 11
  s_add_u32 s45, s44, 8192
  s_waitcnt lgkmcnt(0)
  s_mov_b32 s28, s4
  s_mov_b32 s29, s5
  s_mov_b32 s30, 0x200000
  s_mov_b32 s31, 0x20000
  buffer_load_dwordx4 v[4:7], v254, s[28:31], s44 offen offset:0
  buffer_load_dwordx4 v[8:11], v254, s[28:31], s44 offen offset:1024
  s_lshr_b32 s44, s27, 1
  s_lshl_b32 s44, s44, 2
  s_and_b32 s45, s40, 3
  s_add_u32 s56, s44, s45
  s_and_b32 s44, s27, 1
  s_lshl_b32 s44, s44, 2
  s_bfe_u32 s46, s40, 0x20002
  s_add_u32 s57, s44, s46
  s_add_u32 s60, s45, s46
  s_lshl_b32 s47, s56, 2
  s_add_u32 s47, s47, s26
  s_lshl_b32 s47, s47, 15
  s_mul_i32 s48, s26, 49152
  s_lshl_b32 s45, s57, 7
  s_add_u32 s48, s48, s45
  v_lshrrev_b32 v245, 4, v255
  v_xor_b32 v245, v245, v255
  v_and_b32 v245, 7, v245
  v_lshlrev_b32 v245, 4, v245
  v_lshrrev_b32 v244, 3, v255
  v_lshl_add_u32 v251, v244, 10, v245
  v_xor_b32 v250, 64, v251
  v_add_u32 v250, 7168, v250
  v_add_u32 v249, 14336, v251
  v_add_u32 v248, 14336, v250
  v_lshrrev_b32 v245, 2, v255
  v_and_b32 v245, 4, v245
  v_xor_b32 v245, v245, v255
  v_and_b32 v245, 7, v245
  v_lshlrev_b32 v245, 4, v245
  v_mul_u32_u24 v247, 3072, v244
  v_add_u32 v247, v247, v245
  v_add_u32 v246, 23552, v247
  s_waitcnt lgkmcnt(0)
  s_add_u32 s64, s4, s47
  s_addc_u32 s65, s5, 0
  s_sub_u32 s66, 0x200000, s47
  s_mov_b32 s67, 0x20000
  s_add_u32 s68, s6, s48
  s_addc_u32 s69, s7, 0
  s_sub_u32 s70, 0x180000, s48
  s_mov_b32 s71, 0x20000
  s_add_u32 s61, s60, 0
  s_and_b32 s61, s61, 3
  s_mul_i32 s62, s61, 196608
  s_lshl_b32 s61, s61, 7
  s_add_u32 m0, s43, 20480
  s_nop 0
  buffer_load_dwordx4 v251, s[64:67], s61 offen offset:0 lds
  buffer_load_dwordx4 v250, s[64:67], s61 offen offset:1024 lds
  buffer_load_dwordx4 v249, s[64:67], s61 offen offset:2048 lds
  buffer_load_dwordx4 v248, s[64:67], s61 offen offset:3072 lds
  s_add_u32 m0, s43, 24576
  s_add_u32 s63, s62, 0
  buffer_load_dwordx4 v247, s[68:71], s63 offen offset:0 lds
  buffer_load_dwordx4 v246, s[68:71], s63 offen offset:1024 lds
  s_branch QBODY
PSTART:
  s_lshl_b32 s41, s27, 4
  s_and_b32 s44, s40, 15
  s_add_u32 s41, s41, s44
  s_lshl_b32 s41, s41, 1
  s_lshl_b32 s44, s41, 2
  s_add_u32 s44, s44, s26
  s_lshl_b32 s44, s44, 11
  s_add_u32 s45, s44, 8192
  s_waitcnt lgkmcnt(0)
  s_mov_b32 s28, s4
  s_mov_b32 s29, s5
  s_mov_b32 s30, 0x200000
  s_mov_b32 s31, 0x20000
  buffer_load_dwordx4 v[4:7], v254, s[28:31], s44 offen offset:0
  buffer_load_dwordx4 v[8:11], v254, s[28:31], s44 offen offset:1024
  s_or_b32 s44, s2, s26
  s_cmp_lg_u32 s44, 0
  s_cbranch_scc1 NOTAG_1
  s_memrealtime s[52:53]
  v_mov_b32 v250, 0
  s_waitcnt lgkmcnt(0)
  s_or_b32 s52, s52, 1
  v_mov_b32 v251, s52
  global_store_dword v250, v251, s[22:23] sc1
NOTAG_1:
  s_lshr_b32 s44, s27, 1
  s_lshl_b32 s44, s44, 2
  s_lshr_b32 s45, s40, 2
  s_add_u32 s56, s44, s45
  s_and_b32 s46, s40, 3
  s_lshr_b32 s47, s26, 1
  s_lshl_b32 s57, s46, 1
  s_add_u32 s57, s57, s47
  s_add_u32 s45, s45, s46
  s_and_b32 s45, s45, 3
  s_lshl_b32 s45, s45, 1
  s_lshl_b32 s59, s45, 14
  s_add_u32 s45, s45, s47
  s_mul_i32 s58, s45, 44032
  s_and_b32 s60, s27, 1
  s_and_b32 s61, s26, 1
  s_lshl_b32 s44, s60, 1
  s_add_u32 s61, s61, s44
  s_mul_i32 s44, s61, 1409024
  s_mul_i32 s45, s56, 192
  s_add_u32 s44, s44, s45
  s_add_u32 s64, s12, s44
  s_addc_u32 s65, s13, 0
  s_sub_u32 s66, 0x560000, s44
  s_mov_b32 s67, 0x20000
  s_cmp_eq_u32 s56, 15
  s_cselect_b32 s66, 0, s66
  v_add_u32 v248, 0, v255
  v_mul_u32_u24 v247, 5462, v248
  v_lshrrev_b32 v247, 16, v247
  v_mul_u32_u24 v251, 2560, v247
  v_lshl_add_u32 v251, v248, 4, v251
  v_add_u32 v248, 64, v255
  v_mul_u32_u24 v247, 5462, v248
  v_lshrrev_b32 v247, 16, v247
  v_mul_u32_u24 v250, 2560, v247
  v_lshl_add_u32 v250, v248, 4, v250
  v_subrev_u32 v250, 1024, v250
  v_add_u32 v248, 128, v255
  v_mul_u32_u24 v247, 5462, v248
  v_lshrrev_b32 v247, 16, v247
  v_mul_u32_u24 v249, 2560, v247
  v_lshl_add_u32 v249, v248, 4, v249
  v_subrev_u32 v249, 2048, v249
  s_add_u32 s62, s58, 0
  s_sub_u32 s3, s62, 352256
  s_min_u32 s62, s62, s3
  s_add_u32 m0, s43, 0
  s_nop 0
  buffer_load_dwordx4 v251, s[64:67], s62 offen offset:0 lds
  buffer_load_dwordx4 v250, s[64:67], s62 offen offset:1024 lds
  buffer_load_dwordx4 v249, s[64:67], s62 offen offset:2048 lds
  s_add_u32 s62, s58, 88064
  s_sub_u32 s3, s62, 352256
  s_min_u32 s62, s62, s3
  s_add_u32 m0, s43, 3072
  s_nop 0
  buffer_load_dwordx4 v251, s[64:67], s62 offen offset:0 lds
  buffer_load_dwordx4 v250, s[64:67], s62 offen offset:1024 lds
  buffer_load_dwordx4 v249, s[64:67], s62 offen offset:2048 lds
  s_mov_b32 s32, s24
  s_mov_b32 s33, s25
  s_mov_b32 s34, 0xb00000
  s_mov_b32 s35, 0x20000
  s_add_u32 s36, s24, 0x200000
  s_addc_u32 s37, s25, 0
  s_mov_b32 s38, 0x158000
  s_mov_b32 s39, 0x20000
  v_lshrrev_b32 v244, 5, v255
  v_and_b32 v246, 31, v255
  v_lshlrev_b32 v246, 4, v246
  v_lshl_add_u32 v246, v244, 13, v246
  s_and_b32 s44, s26, 1
  s_lshl_b32 s44, s44, 9
  v_add_u32 v246, s44, v246
  v_xor_b32 v245, 512, v246
  s_and_b32 s44, s26, 1
  s_xor_b32 s45, s44, s60
  s_lshl_b32 s45, s45, 9
  v_xor_b32 v244, s45, v246
  v_xor_b32 v243, 512, v244
  s_mul_i32 s60, s44, 3
  s_mul_i32 s44, s56, 6
  s_add_u32 s44, s44, s60
  s_lshl_b32 s45, s44, 14
  s_lshl_b32 s46, s57, 10
  s_add_u32 s63, s45, s46
  s_add_u32 s72, s63, 16384
  s_add_u32 s73, s63, 32768
  v_mov_b32 v12, -1
  v_mov_b32 v13, -1
  v_mov_b32 v14, -1
  v_mov_b32 v15, -1
  s_mov_b32 s76, s14
  s_mov_b32 s77, s15
  s_mov_b32 s78, 0xac0
  s_mov_b32 s79, 0x20000
  v_lshrrev_b32 v248, 5, v255
  v_lshlrev_b32 v242, 3, v248
  s_lshl_b32 s74, s44, 5
  v_bfe_u32 v247, v255, 2, 2
  v_lshl_add_u32 v247, v248, 3, v247
  v_mul_u32_u24 v247, 192, v247
  v_and_b32 v248, 3, v255
  v_lshl_add_u32 v247, v248, 3, v247
  s_and_b32 s44, s26, 1
  s_mul_i32 s44, s44, 40960
  v_add_u32 v247, s44, v247
  v_bfe_u32 v248, v255, 4, 1
  s_add_u32 s44, s60, 0
  v_add_u32 v248, s44, v248
  v_subrev_u32 v241, 6, v248
  v_min_u32 v248, v248, v241
  v_lshl_add_u32 v241, v248, 5, v247
  v_add_u32 v238, 81920, v241
  v_bfe_u32 v248, v255, 4, 1
  s_add_u32 s44, s60, 2
  v_add_u32 v248, s44, v248
  v_subrev_u32 v240, 6, v248
  v_min_u32 v248, v248, v240
  v_lshl_add_u32 v240, v248, 5, v247
  v_add_u32 v237, 81920, v240
  v_bfe_u32 v248, v255, 4, 1
  s_add_u32 s44, s60, 4
  v_add_u32 v248, s44, v248
  v_subrev_u32 v239, 6, v248
  v_min_u32 v248, v248, v239
  v_lshl_add_u32 v239, v248, 5, v247
  v_add_u32 v236, 81920, v239
  v_lshrrev_b32 v248, 4, v255
  v_mul_u32_u24 v248, 40960, v248
  v_and_b32 v247, 15, v255
  v_lshl_add_u32 v248, v247, 4, v248
  s_mul_i32 s44, s26, 640
  s_add_u32 s44, s44, 32768
  v_add_u32 v248, s44, v248
  v_lshrrev_b32 v247, 2, v247
  v_mul_u32_u24 v247, 320, v247
  v_lshrrev_b32 v235, 4, v255
  v_lshl_add_u32 v247, v235, 5, v247
  v_and_b32 v235, 3, v255
  v_lshl_add_u32 v247, v235, 3, v247
  v_mul_u32_u24 v235, 40960, v235
  s_lshl_b32 s44, s26, 3
  s_add_u32 s44, s44, 37888
  v_add_u32 v235, s44, v235
  s_add_u32 s46, s43, 32768
  v_add_u32 v247, s46, v247
  s_waitcnt vmcnt(6)
  s_add_u32 s62, s58, 0
  s_sub_u32 s3, s62, 352256
  s_min_u32 s62, s62, s3
  s_add_u32 s62, s62, 352256
  s_add_u32 m0, s43, 6144
  s_nop 0
  buffer_load_dwordx4 v251, s[64:67], s62 offen offset:0 lds
  buffer_load_dwordx4 v250, s[64:67], s62 offen offset:1024 lds
  buffer_load_dwordx4 v249, s[64:67], s62 offen offset:2048 lds
  buffer_load_dwordx2 v[16:17], v242, s[76:79], s74 offen offset:0
  buffer_load_dwordx2 v[18:19], v242, s[76:79], s74 offen offset:16
  buffer_load_dwordx2 v[20:21], v242, s[76:79], s74 offen offset:32
  buffer_load_dwordx2 v[22:23], v242, s[76:79], s74 offen offset:48
  buffer_load_dwordx2 v[24:25], v242, s[76:79], s74 offen offset:64
  buffer_load_dwordx2 v[26:27], v242, s[76:79], s74 offen offset:80
  v_lshlrev_b32 v28, 16, v4
  v_and_b32 v29, 0xffff0000, v4
  v_lshlrev_b32 v30, 16, v5
  v_and_b32 v31, 0xffff0000, v5
  v_lshlrev_b32 v32, 16, v6
  v_and_b32 v33, 0xffff0000, v6
  v_lshlrev_b32 v34, 16, v7
  v_and_b32 v35, 0xffff0000, v7
  v_lshlrev_b32 v36, 16, v8
  v_and_b32 v37, 0xffff0000, v8
  v_lshlrev_b32 v38, 16, v9
  v_and_b32 v39, 0xffff0000, v9
  v_lshlrev_b32 v40, 16, v10
  v_and_b32 v41, 0xffff0000, v10
  v_lshlrev_b32 v42, 16, v11
  v_and_b32 v43, 0xffff0000, v11
  v_pk_add_f32 v[44:45], v[28:29], v[30:31]
  v_pk_add_f32 v[46:47], v[32:33], v[34:35]
  v_pk_add_f32 v[48:49], v[36:37], v[38:39]
  v_pk_add_f32 v[50:51], v[40:41], v[42:43]
  v_pk_add_f32 v[44:45], v[44:45], v[46:47]
  v_pk_add_f32 v[48:49], v[48:49], v[50:51]
  v_add_f32 v44, v44, v45
  v_add_f32 v48, v48, v49
  s_nop 1
  v_permlane32_swap_b32 v44, v48
  v_add_f32 v44, v44, v48
  s_nop 1
  v_add_f32_dpp v44, v44, v44 row_shr:1 row_mask:0xf bank_mask:0xf bound_ctrl:0
  buffer_store_dwordx4 v[12:15], v244, s[36:39], s63 offen sc1
  buffer_store_dwordx4 v[12:15], v244, s[36:39], s72 offen sc1
  buffer_store_dwordx4 v[12:15], v244, s[36:39], s73 offen sc1
  s_mov_b64 exec, -1
  v_add_f32_dpp v44, v44, v44 row_shr:2 row_mask:0xf bank_mask:0xf bound_ctrl:0
  s_nop 1
  v_add_f32_dpp v44, v44, v44 row_shr:4 row_mask:0xf bank_mask:0xf bound_ctrl:0
  s_nop 1
  v_add_f32_dpp v44, v44, v44 row_shr:8 row_mask:0xf bank_mask:0xf bound_ctrl:0
  s_nop 1
  v_add_f32_dpp v44, v44, v44 row_bcast:15 row_mask:0xa bank_mask:0xf
  v_mul_f32 v44, 0x3b000000, v44
  s_nop 0
  v_readlane_b32 s80, v44, 31
  v_readlane_b32 s81, v44, 63
  s_nop 1
  v_pk_add_f32 v[28:29], v[28:29], s[80:81] op_sel:[0,0] op_sel_hi:[1,0] neg_lo:[0,1] neg_hi:[0,1]
  v_pk_add_f32 v[30:31], v[30:31], s[80:81] op_sel:[0,0] op_sel_hi:[1,0] neg_lo:[0,1] neg_hi:[0,1]
  v_pk_add_f32 v[32:33], v[32:33], s[80:81] op_sel:[0,0] op_sel_hi:[1,0] neg_lo:[0,1] neg_hi:[0,1]
  v_pk_add_f32 v[34:35], v[34:35], s[80:81] op_sel:[0,0] op_sel_hi:[1,0] neg_lo:[0,1] neg_hi:[0,1]
  v_pk_add_f32 v[36:37], v[36:37], s[80:81] op_sel:[0,1] op_sel_hi:[1,1] neg_lo:[0,1] neg_hi:[0,1]
  v_pk_add_f32 v[38:39], v[38:39], s[80:81] op_sel:[0,1] op_sel_hi:[1,1] neg_lo:[0,1] neg_hi:[0,1]
  v_pk_add_f32 v[40:41], v[40:41], s[80:81] op_sel:[0,1] op_sel_hi:[1,1] neg_lo:[0,1] neg_hi:[0,1]
  v_pk_add_f32 v[42:43], v[42:43], s[80:81] op_sel:[0,1] op_sel_hi:[1,1] neg_lo:[0,1] neg_hi:[0,1]
  v_pk_mul_f32 v[44:45], v[28:29], v[28:29]
  v_pk_mul_f32 v[48:49], v[36:37], v[36:37]
  v_pk_fma_f32 v[44:45], v[30:31], v[30:31], v[44:45]
  v_pk_fma_f32 v[48:49], v[38:39], v[38:39], v[48:49]
  v_pk_fma_f32 v[44:45], v[32:33], v[32:33], v[44:45]
  v_pk_fma_f32 v[48:49], v[40:41], v[40:41], v[48:49]
  v_pk_fma_f32 v[44:45], v[34:35], v[34:35], v[44:45]
  v_pk_fma_f32 v[48:49], v[42:43], v[42:43], v[48:49]
  v_add_f32 v44, v44, v45
  v_add_f32 v48, v48, v49
  s_nop 1
  v_permlane32_swap_b32 v44, v48
  v_add_f32 v44, v44, v48
  s_add_u32 s62, s58, 176128
  s_sub_u32 s3, s62, 352256
  s_min_u32 s62, s62, s3
  s_add_u32 m0, s43, 9216
  s_nop 0
  buffer_load_dwordx4 v251, s[64:67], s62 offen offset:0 lds
  buffer_load_dwordx4 v250, s[64:67], s62 offen offset:1024 lds
  buffer_load_dwordx4 v249, s[64:67], s62 offen offset:2048 lds
  v_add_f32_dpp v44, v44, v44 row_shr:1 row_mask:0xf bank_mask:0xf bound_ctrl:0
  s_nop 1
  v_add_f32_dpp v44, v44, v44 row_shr:2 row_mask:0xf bank_mask:0xf bound_ctrl:0
  s_nop 1
  v_add_f32_dpp v44, v44, v44 row_shr:4 row_mask:0xf bank_mask:0xf bound_ctrl:0
  s_nop 1
  v_add_f32_dpp v44, v44, v44 row_shr:8 row_mask:0xf bank_mask:0xf bound_ctrl:0
  s_nop 1
  v_add_f32_dpp v44, v44, v44 row_bcast:15 row_mask:0xa bank_mask:0xf
  v_mul_f32 v44, 0x3b000000, v44
  v_mov_b32 v48, 0x3727c5ac
  v_add_f32 v45, v44, v48
  v_rsq_f32 v45, v45
  s_nop 0
  v_mul_f32 v46, v44, v45
  v_fma_f32 v46, v46, v45, v48
  v_rsq_f32 v46, v46
  s_nop 0
  v_mul_f32 v47, v46, v45
  v_mul_f32 v45, 0x3fb8aa3b, v45
  v_readlane_b32 s88, v47, 31
  v_readlane_b32 s89, v47, 63
  v_readlane_b32 s84, v45, 31
  v_readlane_b32 s85, v45, 63
  v_pk_mul_f32 v[28:29], v[28:29], s[88:89] op_sel:[0,0] op_sel_hi:[1,0]
  v_pk_mul_f32 v[30:31], v[30:31], s[88:89] op_sel:[0,0] op_sel_hi:[1,0]
  v_pk_mul_f32 v[32:33], v[32:33], s[88:89] op_sel:[0,0] op_sel_hi:[1,0]
  v_pk_mul_f32 v[34:35], v[34:35], s[88:89] op_sel:[0,0] op_sel_hi:[1,0]
  v_cvt_pk_bf16_f32 v4, v28, v29
  v_cvt_pk_bf16_f32 v5, v30, v31
  v_cvt_pk_bf16_f32 v6, v32, v33
  v_cvt_pk_bf16_f32 v7, v34, v35
  ds_write_b128 v248, v[4:7] offset:0
  s_add_u32 s62, s58, 264192
  s_sub_u32 s3, s62, 352256
  s_min_u32 s62, s62, s3
  s_add_u32 m0, s43, 12288
  s_nop 0
  buffer_load_dwordx4 v251, s[64:67], s62 offen offset:0 lds
  buffer_load_dwordx4 v250, s[64:67], s62 offen offset:1024 lds
  buffer_load_dwordx4 v249, s[64:67], s62 offen offset:2048 lds
  v_pk_mul_f32 v[36:37], v[36:37], s[88:89] op_sel:[0,1] op_sel_hi:[1,1]
  v_pk_mul_f32 v[38:39], v[38:39], s[88:89] op_sel:[0,1] op_sel_hi:[1,1]
  v_pk_mul_f32 v[40:41], v[40:41], s[88:89] op_sel:[0,1] op_sel_hi:[1,1]
  v_pk_mul_f32 v[42:43], v[42:43], s[88:89] op_sel:[0,1] op_sel_hi:[1,1]
  v_cvt_pk_bf16_f32 v8, v36, v37
  v_cvt_pk_bf16_f32 v9, v38, v39
  v_cvt_pk_bf16_f32 v10, v40, v41
  v_cvt_pk_bf16_f32 v11, v42, v43
  ds_write_b128 v248, v[8:11] offset:320
  v_mov_b32 v46, s84
  v_mov_b32 v47, s85
  v_pk_mul_f32 v[44:45], v[46:47], s[80:81]
  ds_write_b64 v235, v[44:45] offset:0
  ds_write_b64 v235, v[46:47] offset:32
  v_mov_b32 v248, 0
  global_load_dword v49, v248, s[22:23] sc1
  s_lshl_b32 s44, s41, 13
  s_lshl_b32 s45, s26, 11
  s_add_u32 s44, s44, s45
  s_add_u32 s47, s44, 8192
  s_lshl_b32 s45, s41, 6
  s_add_u32 s45, s45, 0x610000
  s_waitcnt lgkmcnt(0)
  s_barrier
  ds_read_b64_tr_b16 v[28:29], v247 offset:0
  ds_read_b64_tr_b16 v[30:31], v247 offset:1280
  ds_read_b64_tr_b16 v[36:37], v247 offset:128
  ds_read_b64_tr_b16 v[38:39], v247 offset:1408
  v_add_u32 v247, s46, v254
  ds_read_b128 v[44:47], v247 offset:5120
  s_waitcnt lgkmcnt(3)
  buffer_store_dwordx4 v[28:31], v254, s[32:35], s44 offen offset:0 sc1
  s_waitcnt lgkmcnt(1)
  buffer_store_dwordx4 v[36:39], v254, s[32:35], s44 offen offset:1024 sc1
  s_waitcnt lgkmcnt(0)
  s_mov_b64 exec, 0xf
  buffer_store_dwordx4 v[44:47], v254, s[32:35], s45 offen sc1
  s_mov_b64 exec, -1
  s_and_b32 s44, s40, 31
  s_or_b32 s44, s44, s26
  s_cmp_lg_u32 s44, 0
  s_cbranch_scc1 NOZERO_2
  v_mov_b32 v32, 0
  v_mov_b32 v33, 0
  v_mov_b32 v34, 0
  v_mov_b32 v35, 0
  s_mul_i32 s44, s27, 4352
  s_add_u32 s44, s44, 0x600000
  buffer_store_dwordx4 v[32:35], v254, s[32:35], s44 offen offset:0 sc1
  buffer_store_dwordx4 v[32:35], v254, s[32:35], s44 offen offset:1024 sc1
  buffer_store_dwordx4 v[32:35], v254, s[32:35], s44 offen offset:2048 sc1
  buffer_store_dwordx4 v[32:35], v254, s[32:35], s44 offen offset:3072 sc1
  s_add_u32 s44, s44, 4096
  s_mov_b64 exec, 0xffff
  buffer_store_dwordx4 v[32:35], v254, s[32:35], s44 offen sc1
  s_mov_b64 exec, -1
NOZERO_2:
  s_add_u32 s62, s58, 88064
  s_sub_u32 s3, s62, 352256
  s_min_u32 s62, s62, s3
  s_add_u32 s62, s62, 352256
  s_add_u32 m0, s43, 15360
  s_nop 0
  buffer_load_dwordx4 v251, s[64:67], s62 offen offset:0 lds
  buffer_load_dwordx4 v250, s[64:67], s62 offen offset:1024 lds
  buffer_load_dwordx4 v249, s[64:67], s62 offen offset:2048 lds
  s_waitcnt vmcnt(28)
  s_barrier
  ds_read_b64_tr_b16 a[0:1], v241 offset:0
  ds_read_b64_tr_b16 a[2:3], v241 offset:768
  ds_read_b64_tr_b16 a[4:5], v240 offset:0
  ds_read_b64_tr_b16 a[6:7], v240 offset:768
  ds_read_b64_tr_b16 a[8:9], v239 offset:0
  ds_read_b64_tr_b16 a[10:11], v239 offset:768
  ds_read_b64_tr_b16 a[12:13], v238 offset:0
  ds_read_b64_tr_b16 a[14:15], v238 offset:768
  ds_read_b64_tr_b16 a[16:17], v237 offset:0
  ds_read_b64_tr_b16 a[18:19], v237 offset:768
  ds_read_b64_tr_b16 a[20:21], v236 offset:0
  ds_read_b64_tr_b16 a[22:23], v236 offset:768
  s_waitcnt vmcnt(25) lgkmcnt(0)
  s_barrier
  s_add_u32 s62, s58, 0
  s_sub_u32 s3, s62, 352256
  s_min_u32 s62, s62, s3
  s_add_u32 s62, s62, 704512
  s_add_u32 m0, s43, 0
  s_nop 0
  buffer_load_dwordx4 v251, s[64:67], s62 offen offset:0 lds
  buffer_load_dwordx4 v250, s[64:67], s62 offen offset:1024 lds
  buffer_load_dwordx4 v249, s[64:67], s62 offen offset:2048 lds
  ds_read_b64_tr_b16 a[24:25], v241 offset:3072
  ds_read_b64_tr_b16 a[26:27], v241 offset:3840
  ds_read_b64_tr_b16 a[28:29], v240 offset:3072
  ds_read_b64_tr_b16 a[30:31], v240 offset:3840
  ds_read_b64_tr_b16 a[32:33], v239 offset:3072
  ds_read_b64_tr_b16 a[34:35], v239 offset:3840
  ds_read_b64_tr_b16 a[36:37], v238 offset:3072
  ds_read_b64_tr_b16 a[38:39], v238 offset:3840
  ds_read_b64_tr_b16 a[40:41], v237 offset:3072
  ds_read_b64_tr_b16 a[42:43], v237 offset:3840
  ds_read_b64_tr_b16 a[44:45], v236 offset:3072
  ds_read_b64_tr_b16 a[46:47], v236 offset:3840
  s_lshl_b32 s44, s26, 8
  s_add_u32 s44, s44, s41
  s_lshl_b32 s44, s44, 4
  s_add_u32 s44, s44, 0x620000
  s_waitcnt vmcnt(6)
  v_readfirstlane_b32 s42, v49
  s_cmp_eq_u32 s42, 0
  s_cbranch_scc1 TAG_3
TAGOK_4:
  v_mov_b32 v235, s42
  s_mov_b64 exec, 1
  buffer_store_dword v235, v248, s[32:35], s44 offen sc1
  s_mov_b64 exec, -1
  s_waitcnt lgkmcnt(0)
  s_barrier
  s_add_u32 s62, s58, 176128
  s_sub_u32 s3, s62, 352256
  s_min_u32 s62, s62, s3
  s_add_u32 s62, s62, 352256
  s_add_u32 m0, s43, 3072
  s_nop 0
  buffer_load_dwordx4 v251, s[64:67], s62 offen offset:0 lds
  buffer_load_dwordx4 v250, s[64:67], s62 offen offset:1024 lds
  buffer_load_dwordx4 v249, s[64:67], s62 offen offset:2048 lds
  ds_read_b64_tr_b16 a[48:49], v241 offset:6144
  ds_read_b64_tr_b16 a[50:51], v241 offset:6912
  ds_read_b64_tr_b16 a[52:53], v240 offset:6144
  ds_read_b64_tr_b16 a[54:55], v240 offset:6912
  ds_read_b64_tr_b16 a[56:57], v239 offset:6144
  ds_read_b64_tr_b16 a[58:59], v239 offset:6912
  ds_read_b64_tr_b16 a[60:61], v238 offset:6144
  ds_read_b64_tr_b16 a[62:63], v238 offset:6912
  ds_read_b64_tr_b16 a[64:65], v237 offset:6144
  ds_read_b64_tr_b16 a[66:67], v237 offset:6912
  ds_read_b64_tr_b16 a[68:69], v236 offset:6144
  ds_read_b64_tr_b16 a[70:71], v236 offset:6912
  v_lshlrev_b32 v28, 16, v16
  v_and_b32 v29, 0xffff0000, v16
  v_lshlrev_b32 v30, 16, v17
  v_and_b32 v31, 0xffff0000, v17
  v_lshlrev_b32 v32, 16, v18
  v_and_b32 v33, 0xffff0000, v18
  v_lshlrev_b32 v34, 16, v19
  v_and_b32 v35, 0xffff0000, v19
  v_lshlrev_b32 v36, 16, v20
  v_and_b32 v37, 0xffff0000, v20
  v_lshlrev_b32 v38, 16, v21
  v_and_b32 v39, 0xffff0000, v21
  s_waitcnt lgkmcnt(0)
  s_barrier
  s_add_u32 s62, s58, 264192
  s_sub_u32 s3, s62, 352256
  s_min_u32 s62, s62, s3
  s_add_u32 s62, s62, 352256
  s_add_u32 m0, s43, 6144
  s_nop 0
  buffer_load_dwordx4 v251, s[64:67], s62 offen offset:0 lds
  buffer_load_dwordx4 v250, s[64:67], s62 offen offset:1024 lds
  buffer_load_dwordx4 v249, s[64:67], s62 offen offset:2048 lds
  ds_read_b64_tr_b16 a[72:73], v241 offset:9216
  ds_read_b64_tr_b16 a[74:75], v241 offset:9984
  ds_read_b64_tr_b16 a[76:77], v240 offset:9216
  ds_read_b64_tr_b16 a[78:79], v240 offset:9984
  ds_read_b64_tr_b16 a[80:81], v239 offset:9216
  ds_read_b64_tr_b16 a[82:83], v239 offset:9984
  ds_read_b64_tr_b16 a[84:85], v238 offset:9216
  ds_read_b64_tr_b16 a[86:87], v238 offset:9984
  ds_read_b64_tr_b16 a[88:89], v237 offset:9216
  ds_read_b64_tr_b16 a[90:91], v237 offset:9984
  ds_read_b64_tr_b16 a[92:93], v236 offset:9216
  ds_read_b64_tr_b16 a[94:95], v236 offset:9984
  v_lshlrev_b32 v40, 16, v22
  v_and_b32 v41, 0xffff0000, v22
  v_lshlrev_b32 v42, 16, v23
  v_and_b32 v43, 0xffff0000, v23
  v_lshlrev_b32 v68, 16, v24
  v_and_b32 v69, 0xffff0000, v24
  v_lshlrev_b32 v70, 16, v25
  v_and_b32 v71, 0xffff0000, v25
  v_lshlrev_b32 v72, 16, v26
  v_and_b32 v73, 0xffff0000, v26
  v_lshlrev_b32 v74, 16, v27
  v_and_b32 v75, 0xffff0000, v27
  s_waitcnt lgkmcnt(0)
  s_barrier
  s_add_u32 s62, s58, 88064
  s_sub_u32 s3, s62, 352256
  s_min_u32 s62, s62, s3
  s_add_u32 s62, s62, 704512
  s_add_u32 m0, s43, 9216
  s_nop 0
  buffer_load_dwordx4 v251, s[64:67], s62 offen offset:0 lds
  buffer_load_dwordx4 v250, s[64:67], s62 offen offset:1024 lds
  buffer_load_dwordx4 v249, s[64:67], s62 offen offset:2048 lds
  ds_read_b64_tr_b16 a[96:97], v241 offset:12288
  ds_read_b64_tr_b16 a[98:99], v241 offset:13056
  ds_read_b64_tr_b16 a[100:101], v240 offset:12288
  ds_read_b64_tr_b16 a[102:103], v240 offset:13056
  ds_read_b64_tr_b16 a[104:105], v239 offset:12288
  ds_read_b64_tr_b16 a[106:107], v239 offset:13056
  ds_read_b64_tr_b16 a[108:109], v238 offset:12288
  ds_read_b64_tr_b16 a[110:111], v238 offset:13056
  ds_read_b64_tr_b16 a[112:113], v237 offset:12288
  ds_read_b64_tr_b16 a[114:115], v237 offset:13056
  ds_read_b64_tr_b16 a[116:117], v236 offset:12288
  ds_read_b64_tr_b16 a[118:119], v236 offset:13056
  v_mov_b32 v76, 0
  v_mov_b32 v77, 0
  v_mov_b32 v78, 0
  v_mov_b32 v79, 0
  v_mov_b32 v80, 0
  v_mov_b32 v81, 0
  v_mov_b32 v82, 0
  v_mov_b32 v83, 0
  s_lshl_b32 s44, s61, 19
  s_lshl_b32 s45, s57, 10
  s_add_u32 s44, s44, s45
  s_add_u32 s68, s24, s44
  s_addc_u32 s69, s25, 0
  s_waitcnt vmcnt(13) lgkmcnt(0)
  s_barrier
  s_add_u32 s62, s58, 0
  s_sub_u32 s3, s62, 352256
  s_min_u32 s62, s62, s3
  s_add_u32 s62, s62, 1056768
  s_add_u32 m0, s43, 12288
  s_nop 0
  buffer_load_dwordx4 v251, s[64:67], s62 offen offset:0 lds
  buffer_load_dwordx4 v250, s[64:67], s62 offen offset:1024 lds
  buffer_load_dwordx4 v249, s[64:67], s62 offen offset:2048 lds
  ds_read_b64_tr_b16 a[120:121], v241 offset:15360
  ds_read_b64_tr_b16 a[122:123], v241 offset:16128
  ds_read_b64_tr_b16 a[124:125], v240 offset:15360
  ds_read_b64_tr_b16 a[126:127], v240 offset:16128
  ds_read_b64_tr_b16 a[128:129], v239 offset:15360
  ds_read_b64_tr_b16 a[130:131], v239 offset:16128
  ds_read_b64_tr_b16 a[132:133], v238 offset:15360
  ds_read_b64_tr_b16 a[134:135], v238 offset:16128
  ds_read_b64_tr_b16 a[136:137], v237 offset:15360
  ds_read_b64_tr_b16 a[138:139], v237 offset:16128
  ds_read_b64_tr_b16 a[140:141], v236 offset:15360
  ds_read_b64_tr_b16 a[142:143], v236 offset:16128
  s_mov_b32 s70, 0x80000
  s_mov_b32 s71, 0x20000
  s_cmp_eq_u32 s56, 15
  s_cselect_b32 s70, 0, s70
  s_lshr_b32 s44, s57, 1
  s_lshl_b32 s44, s44, 2
  s_add_u32 s44, s44, s61
  s_lshl_b32 s44, s44, 10
  s_add_u32 s44, s44, 0x620000
  v_and_b32 v247, 63, v255
  v_lshl_add_u32 v247, v247, 4, s44
  s_waitcnt vmcnt(13) lgkmcnt(0)
  s_barrier
  s_add_u32 s62, s58, 176128
  s_sub_u32 s3, s62, 352256
  s_min_u32 s62, s62, s3
  s_add_u32 s62, s62, 704512
  s_add_u32 m0, s43, 15360
  s_nop 0
  buffer_load_dwordx4 v251, s[64:67], s62 offen offset:0 lds
  buffer_load_dwordx4 v250, s[64:67], s62 offen offset:1024 lds
  buffer_load_dwordx4 v249, s[64:67], s62 offen offset:2048 lds
  ds_read_b64_tr_b16 a[144:145], v241 offset:0
  ds_read_b64_tr_b16 a[146:147], v241 offset:768
  ds_read_b64_tr_b16 a[148:149], v240 offset:0
  ds_read_b64_tr_b16 a[150:151], v240 offset:768
  ds_read_b64_tr_b16 a[152:153], v239 offset:0
  ds_read_b64_tr_b16 a[154:155], v239 offset:768
  ds_read_b64_tr_b16 a[156:157], v238 offset:0
  ds_read_b64_tr_b16 a[158:159], v238 offset:768
  ds_read_b64_tr_b16 a[160:161], v237 offset:0
  ds_read_b64_tr_b16 a[162:163], v237 offset:768
  ds_read_b64_tr_b16 a[164:165], v236 offset:0
  ds_read_b64_tr_b16 a[166:167], v236 offset:768
  s_waitcnt vmcnt(12) lgkmcnt(0)
  s_barrier
  s_add_u32 s62, s58, 264192
  s_sub_u32 s3, s62, 352256
  s_min_u32 s62, s62, s3
  s_add_u32 s62, s62, 704512
  s_add_u32 m0, s43, 0
  s_nop 0
  buffer_load_dwordx4 v251, s[64:67], s62 offen offset:0 lds
  buffer_load_dwordx4 v250, s[64:67], s62 offen offset:1024 lds
  buffer_load_dwordx4 v249, s[64:67], s62 offen offset:2048 lds
  ds_read_b64_tr_b16 a[168:169], v241 offset:3072
  ds_read_b64_tr_b16 a[170:171], v241 offset:3840
  ds_read_b64_tr_b16 a[172:173], v240 offset:3072
  ds_read_b64_tr_b16 a[174:175], v240 offset:3840
  ds_read_b64_tr_b16 a[176:177], v239 offset:3072
  ds_read_b64_tr_b16 a[178:179], v239 offset:3840
  ds_read_b64_tr_b16 a[180:181], v238 offset:3072
  ds_read_b64_tr_b16 a[182:183], v238 offset:3840
  ds_read_b64_tr_b16 a[184:185], v237 offset:3072
  ds_read_b64_tr_b16 a[186:187], v237 offset:3840
  ds_read_b64_tr_b16 a[188:189], v236 offset:3072
  ds_read_b64_tr_b16 a[190:191], v236 offset:3840
  s_waitcnt vmcnt(12) lgkmcnt(0)
  s_barrier
  s_add_u32 s62, s58, 88064
  s_sub_u32 s3, s62, 352256
  s_min_u32 s62, s62, s3
  s_add_u32 s62, s62, 1056768
  s_add_u32 m0, s43, 3072
  s_nop 0
  buffer_load_dwordx4 v251, s[64:67], s62 offen offset:0 lds
  buffer_load_dwordx4 v250, s[64:67], s62 offen offset:1024 lds
  buffer_load_dwordx4 v249, s[64:67], s62 offen offset:2048 lds
  ds_read_b64_tr_b16 a[192:193], v241 offset:6144
  ds_read_b64_tr_b16 a[194:195], v241 offset:6912
  ds_read_b64_tr_b16 a[196:197], v240 offset:6144
  ds_read_b64_tr_b16 a[198:199], v240 offset:6912
  ds_read_b64_tr_b16 a[200:201], v239 offset:6144
  ds_read_b64_tr_b16 a[202:203], v239 offset:6912
  ds_read_b64_tr_b16 a[204:205], v238 offset:6144
  ds_read_b64_tr_b16 a[206:207], v238 offset:6912
  ds_read_b64_tr_b16 a[208:209], v237 offset:6144
  ds_read_b64_tr_b16 a[210:211], v237 offset:6912
  ds_read_b64_tr_b16 a[212:213], v236 offset:6144
  ds_read_b64_tr_b16 a[214:215], v236 offset:6912
  buffer_load_dword v253, v247, s[32:35], 0 offen sc1
  s_waitcnt vmcnt(13) lgkmcnt(0)
  s_barrier
  s_add_u32 s62, s58, 176128
  s_sub_u32 s3, s62, 352256
  s_min_u32 s62, s62, s3
  s_add_u32 s62, s62, 1056768
  s_add_u32 m0, s43, 6144
  s_nop 0
  buffer_load_dwordx4 v251, s[64:67], s62 offen offset:0 lds
  buffer_load_dwordx4 v250, s[64:67], s62 offen offset:1024 lds
  buffer_load_dwordx4 v249, s[64:67], s62 offen offset:2048 lds
  ds_read_b64_tr_b16 a[216:217], v241 offset:9216
  ds_read_b64_tr_b16 a[218:219], v241 offset:9984
  ds_read_b64_tr_b16 a[220:221], v240 offset:9216
  ds_read_b64_tr_b16 a[222:223], v240 offset:9984
  ds_read_b64_tr_b16 a[224:225], v239 offset:9216
  ds_read_b64_tr_b16 a[226:227], v239 offset:9984
  ds_read_b64_tr_b16 a[228:229], v238 offset:9216
  ds_read_b64_tr_b16 a[230:231], v238 offset:9984
  ds_read_b64_tr_b16 a[232:233], v237 offset:9216
  ds_read_b64_tr_b16 a[234:235], v237 offset:9984
  ds_read_b64_tr_b16 a[236:237], v236 offset:9216
  ds_read_b64_tr_b16 a[238:239], v236 offset:9984
  s_waitcnt lgkmcnt(0)
  s_barrier
  s_add_u32 s62, s58, 264192
  s_sub_u32 s3, s62, 352256
  s_min_u32 s62, s62, s3
  s_add_u32 s62, s62, 1056768
  s_add_u32 m0, s43, 9216
  s_nop 0
  buffer_load_dwordx4 v251, s[64:67], s62 offen offset:0 lds
  buffer_load_dwordx4 v250, s[64:67], s62 offen offset:1024 lds
  buffer_load_dwordx4 v249, s[64:67], s62 offen offset:2048 lds
  s_waitcnt vmcnt(6)
  v_cmp_ne_u32 vcc, s42, v253
  s_cbranch_vccnz POLL_5
POLLOK_6:
  s_add_u32 s57, s59, 0
  s_and_b32 s57, s57, 0x1ffff
  buffer_load_dwordx4 v[4:7], v243, s[68:71], s57 offen sc1
  s_add_u32 s58, s59, 16384
  s_and_b32 s58, s58, 0x1ffff
  buffer_load_dwordx4 v[8:11], v243, s[68:71], s58 offen sc1
  s_add_u32 s60, s59, 32768
  s_and_b32 s60, s60, 0x1ffff
  buffer_load_dwordx4 v[12:15], v243, s[68:71], s60 offen sc1
  s_add_u32 s61, s59, 49152
  s_and_b32 s61, s61, 0x1ffff
  buffer_load_dwordx4 v[16:19], v243, s[68:71], s61 offen sc1
  s_add_u32 s68, s68, 131072
  s_addc_u32 s69, s69, 0
  buffer_load_dwordx4 v[20:23], v243, s[68:71], s57 offen sc1
  buffer_load_dwordx4 v[24:27], v243, s[68:71], s58 offen sc1
  s_sub_u32 s68, s68, 131072
  s_subb_u32 s69, s69, 0
  s_add_u32 s62, s59, 65536
  s_and_b32 s62, s62, 0x1ffff
  buffer_load_dwordx4 v[44:47], v243, s[68:71], s62 offen sc1
  s_add_u32 s64, s59, 81920
  s_and_b32 s64, s64, 0x1ffff
  buffer_load_dwordx4 v[48:51], v243, s[68:71], s64 offen sc1
  s_add_u32 s65, s59, 98304
  s_and_b32 s65, s65, 0x1ffff
  buffer_load_dwordx4 v[132:135], v243, s[68:71], s65 offen sc1
  s_add_u32 s66, s59, 114688
  s_and_b32 s66, s66, 0x1ffff
  buffer_load_dwordx4 v[136:139], v243, s[68:71], s66 offen sc1
  s_add_u32 s68, s68, 131072
  s_addc_u32 s69, s69, 0
  buffer_load_dwordx4 v[140:143], v243, s[68:71], s60 offen sc1
  buffer_load_dwordx4 v[144:147], v243, s[68:71], s61 offen sc1
  s_add_u32 s68, s68, 131072
  s_addc_u32 s69, s69, 0
  buffer_load_dwordx4 v[148:151], v243, s[68:71], s57 offen sc1
  buffer_load_dwordx4 v[152:155], v243, s[68:71], s58 offen sc1
  s_sub_u32 s68, s68, 131072
  s_subb_u32 s69, s69, 0
  buffer_load_dwordx4 v[156:159], v243, s[68:71], s62 offen sc1
  buffer_load_dwordx4 v[160:163], v243, s[68:71], s64 offen sc1
  s_waitcnt vmcnt(15)
  v_mfma_f32_32x32x16_bf16 v[116:131], a[8:11], v[4:7], 0
  s_lshr_b32 s44, s27, 1
  s_lshl_b32 s44, s44, 3
  s_and_b32 s45, s40, 7
  v_mfma_f32_32x32x16_bf16 v[84:99], a[4:7], v[4:7], 0
  s_add_u32 s75, s44, s45
  s_and_b32 s44, s27, 1
  s_lshl_b32 s44, s44, 2
  v_mfma_f32_32x32x16_bf16 v[52:67], a[0:3], v[4:7], 0
  s_lshr_b32 s46, s40, 3
  s_and_b32 s47, s40, 1
  s_waitcnt vmcnt(14)
  v_mfma_f32_32x32x16_bf16 v[116:131], a[20:23], v[8:11], v[116:131]
  buffer_load_dwordx4 v[4:7], v243, s[68:71], s65 offen sc1
  s_lshl_b32 s47, s47, 1
  s_xor_b32 s47, s47, s46
  v_mfma_f32_32x32x16_bf16 v[84:99], a[16:19], v[8:11], v[84:99]
  s_add_u32 s76, s44, s47
  s_mul_i32 s45, s45, 3
  s_and_b32 s46, s46, 1
  v_mfma_f32_32x32x16_bf16 v[52:67], a[12:15], v[8:11], v[52:67]
  s_mul_i32 s46, s46, 11
  s_add_u32 s45, s45, s46
  s_sub_u32 s46, s45, 22
  s_waitcnt vmcnt(14)
  v_mfma_f32_32x32x16_bf16 v[116:131], a[32:35], v[12:15], v[116:131]
  buffer_load_dwordx4 v[8:11], v243, s[68:71], s66 offen sc1
  s_min_u32 s45, s45, s46
  s_lshl_b32 s77, s45, 14
  v_mfma_f32_32x32x16_bf16 v[84:99], a[28:31], v[12:15], v[84:99]
  s_lshl_b32 s78, s45, 16
  s_mul_i32 s44, s26, 1441792
  s_lshl_b32 s45, s75, 7
  v_mfma_f32_32x32x16_bf16 v[52:67], a[24:27], v[12:15], v[52:67]
  s_add_u32 s44, s44, s45
  s_add_u32 s80, s16, s44
  s_addc_u32 s81, s17, 0
  s_sub_u32 s82, 0x560000, s44
  s_waitcnt vmcnt(14)
  v_mfma_f32_32x32x16_bf16 v[116:131], a[44:47], v[16:19], v[116:131]
  s_add_u32 s68, s68, 131072
  s_addc_u32 s69, s69, 0
  buffer_load_dwordx4 v[12:15], v243, s[68:71], s60 offen sc1
  s_mov_b32 s83, 0x20000
  s_mul_i32 s44, s26, 360448
  v_mfma_f32_32x32x16_bf16 v[84:99], a[40:43], v[16:19], v[84:99]
  s_lshl_b32 s45, s76, 10
  s_add_u32 s44, s44, s45
  s_add_u32 s84, s36, s44
  s_addc_u32 s85, s37, 0
  v_mfma_f32_32x32x16_bf16 v[52:67], a[36:39], v[16:19], v[52:67]
  s_sub_u32 s86, 0x158000, s44
  s_mov_b32 s87, 0x20000
  v_lshrrev_b32 v242, 2, v255
  s_waitcnt vmcnt(14)
  v_mfma_f32_32x32x16_bf16 v[116:131], a[56:59], v[20:23], v[116:131]
  buffer_load_dwordx4 v[16:19], v243, s[68:71], s61 offen sc1
  v_and_b32 v242, 4, v242
  v_xor_b32 v242, v242, v255
  v_mfma_f32_32x32x16_bf16 v[84:99], a[52:55], v[20:23], v[84:99]
  v_and_b32 v242, 7, v242
  v_lshlrev_b32 v242, 4, v242
  v_lshrrev_b32 v235, 3, v255
  v_mfma_f32_32x32x16_bf16 v[52:67], a[48:51], v[20:23], v[52:67]
  v_lshl_add_u32 v248, v235, 12, v242
  v_add_u32 v247, 31744, v248
  v_lshl_add_u32 v234, v235, 10, v242
  s_waitcnt vmcnt(14)
  v_mfma_f32_32x32x16_bf16 v[116:131], a[68:71], v[24:27], v[116:131]
  s_add_u32 s68, s68, 131072
  s_addc_u32 s69, s69, 0
  buffer_load_dwordx4 v[20:23], v243, s[68:71], s57 offen sc1
  v_add_u32 v233, 7168, v234
  s_lshl_b32 s44, s26, 17
  v_mfma_f32_32x32x16_bf16 v[84:99], a[64:67], v[24:27], v[84:99]
  s_lshl_b32 s45, s76, 7
  s_add_u32 s44, s44, s45
  s_add_u32 s88, s8, s44
  s_addc_u32 s89, s9, 0
  v_mfma_f32_32x32x16_bf16 v[52:67], a[60:63], v[24:27], v[52:67]
  s_sub_u32 s90, 0x80000, s44
  s_mov_b32 s91, 0x20000
  s_lshr_b32 s79, s40, 3
  s_waitcnt vmcnt(14)
  v_mfma_f32_32x32x16_bf16 v[116:131], a[80:83], v[44:47], v[116:131]
  buffer_load_dwordx4 v[24:27], v243, s[68:71], s58 offen sc1
  s_lshl_b32 s79, s79, 1
  s_add_u32 s79, s79, s40
  v_mfma_f32_32x32x16_bf16 v[84:99], a[76:79], v[44:47], v[84:99]
  v_lshrrev_b32 v242, 5, v255
  v_lshlrev_b32 v242, 9, v242
  v_bfe_u32 v235, v255, 2, 2
  v_mfma_f32_32x32x16_bf16 v[52:67], a[72:75], v[44:47], v[52:67]
  v_lshl_add_u32 v242, v235, 7, v242
  v_bfe_u32 v235, v255, 4, 1
  v_lshl_add_u32 v242, v235, 5, v242
  s_waitcnt vmcnt(14)
  v_mfma_f32_32x32x16_bf16 v[116:131], a[92:95], v[48:51], v[116:131]
  s_sub_u32 s68, s68, 131072
  s_subb_u32 s69, s69, 0
  buffer_load_dwordx4 v[44:47], v243, s[68:71], s62 offen sc1
  v_and_b32 v235, 3, v255
  v_lshl_add_u32 v242, v235, 3, v242
  v_mfma_f32_32x32x16_bf16 v[84:99], a[88:91], v[48:51], v[84:99]
  v_bfe_u32 v235, v255, 3, 1
  v_lshl_add_u32 v242, v235, 6, v242
  v_add_u32 v242, s43, v242
  v_mfma_f32_32x32x16_bf16 v[52:67], a[84:87], v[48:51], v[52:67]
  s_and_b32 s44, s26, 1
  s_lshl_b32 s44, s44, 6
  v_xor_b32 v232, s44, v242
  s_waitcnt vmcnt(14)
  v_mfma_f32_32x32x16_bf16 v[116:131], a[104:107], v[132:135], v[116:131]
  buffer_load_dwordx4 v[48:51], v243, s[68:71], s64 offen sc1
  v_xor_b32 v231, 64, v232
  s_lshr_b32 s44, s26, 1
  v_mfma_f32_32x32x16_bf16 v[84:99], a[100:103], v[132:135], v[84:99]
  s_lshl_b32 s44, s44, 6
  v_xor_b32 v242, s44, v242
  v_xor_b32 v235, 64, v242
  v_mfma_f32_32x32x16_bf16 v[52:67], a[96:99], v[132:135], v[52:67]
  v_add_u32 v252, s43, v254
  s_xor_b32 s44, s26, 1
  s_mul_i32 s44, s44, 40960
  s_waitcnt vmcnt(14)
  v_mfma_f32_32x32x16_bf16 v[116:131], a[116:119], v[136:139], v[116:131]
  buffer_load_dwordx4 v[132:135], v243, s[68:71], s65 offen sc1
  v_add_u32 v253, s44, v254
  v_mov_b32 v203, s42
  v_mfma_f32_32x32x16_bf16 v[84:99], a[112:115], v[136:139], v[84:99]
  v_mov_b32 v207, s42
  v_mov_b32 v211, s42
  v_mov_b32 v215, s42
  v_mfma_f32_32x32x16_bf16 v[52:67], a[108:111], v[136:139], v[52:67]
  s_lshl_b32 s74, s2, 2
  s_add_u32 s74, s74, s26
  s_xor_b32 s67, s74, 4
  s_waitcnt vmcnt(14)
  v_mfma_f32_32x32x16_bf16 v[116:131], a[128:131], v[140:143], v[116:131]
  buffer_load_dwordx4 v[136:139], v243, s[68:71], s66 offen sc1
  s_lshl_b32 s74, s74, 12
  s_add_u32 s74, s74, 0x800000
  v_mfma_f32_32x32x16_bf16 v[84:99], a[124:127], v[140:143], v[84:99]
  s_lshl_b32 s67, s67, 12
  s_add_u32 s67, s67, 0x800000
  s_mul_i32 s44, s26, 240306
  v_mfma_f32_32x32x16_bf16 v[52:67], a[120:123], v[140:143], v[52:67]
  s_lshr_b32 s44, s44, 16
  s_mul_i32 s45, s26, 22
  s_add_u32 s45, s45, 21
  s_waitcnt vmcnt(14)
  v_mfma_f32_32x32x16_bf16 v[116:131], a[140:143], v[144:147], v[116:131]
  s_add_u32 s68, s68, 131072
  s_addc_u32 s69, s69, 0
  buffer_load_dwordx4 v[140:143], v243, s[68:71], s60 offen sc1
  s_min_u32 s45, s45, 85
  s_mul_i32 s45, s45, 10923
  v_mfma_f32_32x32x16_bf16 v[84:99], a[136:139], v[144:147], v[84:99]
  s_lshr_b32 s45, s45, 16
  v_bfe_u32 v230, v255, 2, 3
  v_add_u32 v230, s44, v230
  v_mfma_f32_32x32x16_bf16 v[52:67], a[132:135], v[144:147], v[52:67]
  v_min_u32 v230, s45, v230
  v_lshrrev_b32 v229, 2, v230
  v_and_b32 v230, 3, v230
  s_waitcnt vmcnt(14)
  v_mfma_f32_32x32x16_bf16 v[116:131], a[152:155], v[148:151], v[116:131]
  buffer_load_dwordx4 v[144:147], v243, s[68:71], s61 offen sc1
  v_lshlrev_b32 v230, 2, v230
  v_lshl_add_u32 v230, v229, 5, v230
  v_mfma_f32_32x32x16_bf16 v[84:99], a[148:151], v[148:151], v[84:99]
  v_bfe_u32 v229, v255, 1, 1
  v_lshl_add_u32 v230, v229, 4, v230
  v_and_b32 v229, 1, v255
  v_mfma_f32_32x32x16_bf16 v[52:67], a[144:147], v[148:151], v[52:67]
  v_lshl_add_u32 v230, v229, 7, v230
  s_and_b32 s44, s76, 1
  s_lshl_b32 s44, s44, 8
  s_waitcnt vmcnt(14)
  v_mfma_f32_32x32x16_bf16 v[116:131], a[164:167], v[152:155], v[116:131]
  buffer_load_dwordx4 v[148:151], v243, s[68:71], s62 offen sc1
  s_lshr_b32 s45, s76, 1
  s_add_u32 s44, s44, s45
  v_mfma_f32_32x32x16_bf16 v[84:99], a[160:163], v[152:155], v[84:99]
  v_add_u32 v230, s44, v230
  v_lshlrev_b32 v230, 5, v230
  v_add_u32 v230, 0x620000, v230
  v_mfma_f32_32x32x16_bf16 v[52:67], a[156:159], v[152:155], v[52:67]
  v_and_b32 v229, 3, v255
  v_lshlrev_b32 v229, 8, v229
  s_lshr_b32 s44, s75, 1
  s_waitcnt vmcnt(14)
  v_mfma_f32_32x32x16_bf16 v[116:131], a[176:179], v[156:159], v[116:131]
  buffer_load_dwordx4 v[152:155], v243, s[68:71], s64 offen sc1
  s_lshl_b32 s44, s44, 2
  s_add_u32 s44, s44, s26
  v_mfma_f32_32x32x16_bf16 v[84:99], a[172:175], v[156:159], v[84:99]
  s_lshl_b32 s44, s44, 3
  s_and_b32 s45, s75, 1
  s_add_u32 s44, s44, s45
  v_mfma_f32_32x32x16_bf16 v[52:67], a[168:171], v[156:159], v[52:67]
  s_lshl_b32 s44, s44, 7
  s_add_u32 s44, s44, 0x680000
  v_add_u32 v229, s44, v229
  s_waitcnt vmcnt(14)
  v_mfma_f32_32x32x16_bf16 v[116:131], a[188:191], v[160:163], v[116:131]
  buffer_load_dwordx4 v[156:159], v243, s[68:71], s65 offen sc1
  s_lshl_b32 s44, s26, 19
  s_lshl_b32 s45, s75, 11
  v_mfma_f32_32x32x16_bf16 v[84:99], a[184:187], v[160:163], v[84:99]
  s_add_u32 s44, s44, s45
  s_lshr_b32 s45, s26, 1
  s_lshl_b32 s45, s45, 10
  v_mfma_f32_32x32x16_bf16 v[52:67], a[180:183], v[160:163], v[52:67]
  s_add_u32 s44, s44, s45
  s_add_u32 s44, s44, 0x400000
  v_add_u32 v228, s44, v254
  s_waitcnt vmcnt(14)
  s_barrier
  v_mfma_f32_32x32x16_bf16 v[116:131], a[200:203], v[4:7], v[116:131]
  buffer_load_dwordx4 v[160:163], v243, s[68:71], s66 offen sc1
  v_xor_b32 v227, 1024, v228
  s_mul_i32 s44, s26, 240306
  v_mfma_f32_32x32x16_bf16 v[84:99], a[196:199], v[4:7], v[84:99]
  s_lshr_b32 s44, s44, 16
  s_mul_i32 s45, s26, 22
  s_add_u32 s45, s45, 21
  v_mfma_f32_32x32x16_bf16 v[52:67], a[192:195], v[4:7], v[52:67]
  s_min_u32 s45, s45, 85
  s_mul_i32 s45, s45, 10923
  s_lshr_b32 s45, s45, 16
  s_waitcnt vmcnt(14)
  v_mfma_f32_32x32x16_bf16 v[116:131], a[212:215], v[8:11], v[116:131]
  s_sub_u32 s68, s68, 393216
  s_subb_u32 s69, s69, 0
  buffer_load_dwordx4 v[4:7], v244, s[68:71], s57 offen sc1
  v_bfe_u32 v226, v255, 2, 3
  v_add_u32 v226, s44, v226
  v_mfma_f32_32x32x16_bf16 v[84:99], a[208:211], v[8:11], v[84:99]
  v_min_u32 v226, s45, v226
  v_mul_u32_u24 v226, 6, v226
  v_bfe_u32 v225, v255, 1, 1
  v_mfma_f32_32x32x16_bf16 v[52:67], a[204:207], v[8:11], v[52:67]
  v_mad_u32_u24 v226, v225, 3, v226
  v_add_u32 v226, 2, v226
  v_lshlrev_b32 v226, 14, v226
  s_waitcnt vmcnt(14)
  v_mfma_f32_32x32x16_bf16 v[116:131], a[224:227], v[12:15], v[116:131]
  ds_read_b64_tr_b16 v[164:165], v241 offset:12288
  ds_read_b64_tr_b16 v[166:167], v241 offset:13056
  ds_read_b64_tr_b16 v[168:169], v240 offset:12288
  v_mfma_f32_32x32x16_bf16 v[84:99], a[220:223], v[12:15], v[84:99]
  ds_read_b64_tr_b16 v[170:171], v240 offset:13056
  ds_read_b64_tr_b16 v[172:173], v239 offset:12288
  ds_read_b64_tr_b16 v[174:175], v239 offset:13056
  v_mfma_f32_32x32x16_bf16 v[52:67], a[216:219], v[12:15], v[52:67]
  buffer_load_dwordx4 v[8:11], v244, s[68:71], s58 offen sc1
  v_and_b32 v225, 1, v255
  v_lshl_add_u32 v226, v225, 9, v226
  s_waitcnt vmcnt(14)
  v_mfma_f32_32x32x16_bf16 v[116:131], a[236:239], v[16:19], v[116:131]
  ds_read_b64_tr_b16 v[176:177], v238 offset:12288
  ds_read_b64_tr_b16 v[178:179], v238 offset:13056
  ds_read_b64_tr_b16 v[180:181], v237 offset:12288
  v_mfma_f32_32x32x16_bf16 v[84:99], a[232:235], v[16:19], v[84:99]
  ds_read_b64_tr_b16 v[182:183], v237 offset:13056
  ds_read_b64_tr_b16 v[184:185], v236 offset:12288
  ds_read_b64_tr_b16 v[186:187], v236 offset:13056
  v_mfma_f32_32x32x16_bf16 v[52:67], a[228:231], v[16:19], v[52:67]
  buffer_load_dwordx4 v[12:15], v244, s[68:71], s60 offen sc1
  s_lshl_b32 s44, s76, 10
  v_add_u32 v226, s44, v226
  s_waitcnt vmcnt(14) lgkmcnt(6)
  v_mfma_f32_32x32x16_bf16 v[116:131], v[172:175], v[20:23], v[116:131]
  ds_read_b64_tr_b16 v[188:189], v241 offset:15360
  ds_read_b64_tr_b16 v[190:191], v241 offset:16128
  ds_read_b64_tr_b16 v[192:193], v240 offset:15360
  v_mfma_f32_32x32x16_bf16 v[84:99], v[168:171], v[20:23], v[84:99]
  ds_read_b64_tr_b16 v[194:195], v240 offset:16128
  ds_read_b64_tr_b16 v[196:197], v239 offset:15360
  v_mfma_f32_32x32x16_bf16 v[52:67], v[164:167], v[20:23], v[52:67]
  ds_read_b64_tr_b16 v[198:199], v239 offset:16128
  buffer_load_dwordx4 v[16:19], v244, s[68:71], s61 offen sc1
  s_waitcnt vmcnt(14) lgkmcnt(6)
  v_mfma_f32_32x32x16_bf16 v[116:131], v[184:187], v[24:27], v[116:131]
  ds_read_b64_tr_b16 v[164:165], v238 offset:15360
  ds_read_b64_tr_b16 v[166:167], v238 offset:16128
  ds_read_b64_tr_b16 v[168:169], v237 offset:15360
  v_mfma_f32_32x32x16_bf16 v[84:99], v[180:183], v[24:27], v[84:99]
  ds_read_b64_tr_b16 v[170:171], v237 offset:16128
  ds_read_b64_tr_b16 v[172:173], v236 offset:15360
  v_mfma_f32_32x32x16_bf16 v[52:67], v[176:179], v[24:27], v[52:67]
  ds_read_b64_tr_b16 v[174:175], v236 offset:16128
  s_add_u32 s68, s68, 131072
  s_addc_u32 s69, s69, 0
  buffer_load_dwordx4 v[20:23], v244, s[68:71], s57 offen sc1
  s_waitcnt vmcnt(14) lgkmcnt(6)
  v_mfma_f32_32x32x16_bf16 v[116:131], v[196:199], v[44:47], v[116:131]
  ds_read_b64_tr_b16 v[176:177], v241 offset:0
  ds_read_b64_tr_b16 v[178:179], v241 offset:768
  ds_read_b64_tr_b16 v[180:181], v240 offset:0
  v_mfma_f32_32x32x16_bf16 v[84:99], v[192:195], v[44:47], v[84:99]
  ds_read_b64_tr_b16 v[182:183], v240 offset:768
  ds_read_b64_tr_b16 v[184:185], v239 offset:0
  v_mfma_f32_32x32x16_bf16 v[52:67], v[188:191], v[44:47], v[52:67]
  ds_read_b64_tr_b16 v[186:187], v239 offset:768
  buffer_load_dwordx4 v[24:27], v244, s[68:71], s58 offen sc1
  s_waitcnt vmcnt(14) lgkmcnt(6)
  v_mfma_f32_32x32x16_bf16 v[116:131], v[172:175], v[48:51], v[116:131]
  ds_read_b64_tr_b16 v[188:189], v238 offset:0
  ds_read_b64_tr_b16 v[190:191], v238 offset:768
  ds_read_b64_tr_b16 v[192:193], v237 offset:0
  v_mfma_f32_32x32x16_bf16 v[84:99], v[168:171], v[48:51], v[84:99]
  ds_read_b64_tr_b16 v[194:195], v237 offset:768
  ds_read_b64_tr_b16 v[196:197], v236 offset:0
  v_mfma_f32_32x32x16_bf16 v[52:67], v[164:167], v[48:51], v[52:67]
  ds_read_b64_tr_b16 v[198:199], v236 offset:768
  s_sub_u32 s68, s68, 131072
  s_subb_u32 s69, s69, 0
  buffer_load_dwordx4 v[44:47], v244, s[68:71], s62 offen sc1
  s_waitcnt vmcnt(14) lgkmcnt(6)
  v_mfma_f32_32x32x16_bf16 v[116:131], v[184:187], v[132:135], v[116:131]
  ds_read_b64_tr_b16 v[164:165], v241 offset:3072
  ds_read_b64_tr_b16 v[166:167], v241 offset:3840
  ds_read_b64_tr_b16 v[168:169], v240 offset:3072
  v_mfma_f32_32x32x16_bf16 v[84:99], v[180:183], v[132:135], v[84:99]
  ds_read_b64_tr_b16 v[170:171], v240 offset:3840
  ds_read_b64_tr_b16 v[172:173], v239 offset:3072
  v_mfma_f32_32x32x16_bf16 v[52:67], v[176:179], v[132:135], v[52:67]
  ds_read_b64_tr_b16 v[174:175], v239 offset:3840
  buffer_load_dwordx4 v[48:51], v244, s[68:71], s64 offen sc1
  s_waitcnt vmcnt(14) lgkmcnt(6)
  v_mfma_f32_32x32x16_bf16 v[116:131], v[196:199], v[136:139], v[116:131]
  ds_read_b64_tr_b16 v[176:177], v238 offset:3072
  ds_read_b64_tr_b16 v[178:179], v238 offset:3840
  ds_read_b64_tr_b16 v[180:181], v237 offset:3072
  v_mfma_f32_32x32x16_bf16 v[84:99], v[192:195], v[136:139], v[84:99]
  ds_read_b64_tr_b16 v[182:183], v237 offset:3840
  ds_read_b64_tr_b16 v[184:185], v236 offset:3072
  v_mfma_f32_32x32x16_bf16 v[52:67], v[188:191], v[136:139], v[52:67]
  ds_read_b64_tr_b16 v[186:187], v236 offset:3840
  buffer_load_dwordx4 v[132:135], v244, s[68:71], s65 offen sc1
  s_waitcnt vmcnt(14) lgkmcnt(6)
  v_mfma_f32_32x32x16_bf16 v[116:131], v[172:175], v[140:143], v[116:131]
  ds_read_b64_tr_b16 v[188:189], v241 offset:6144
  ds_read_b64_tr_b16 v[190:191], v241 offset:6912
  ds_read_b64_tr_b16 v[192:193], v240 offset:6144
  v_mfma_f32_32x32x16_bf16 v[84:99], v[168:171], v[140:143], v[84:99]
  ds_read_b64_tr_b16 v[194:195], v240 offset:6912
  ds_read_b64_tr_b16 v[196:197], v239 offset:6144
  v_mfma_f32_32x32x16_bf16 v[52:67], v[164:167], v[140:143], v[52:67]
  ds_read_b64_tr_b16 v[198:199], v239 offset:6912
  buffer_load_dwordx4 v[136:139], v244, s[68:71], s66 offen sc1
  s_waitcnt vmcnt(14) lgkmcnt(6)
  v_mfma_f32_32x32x16_bf16 v[116:131], v[184:187], v[144:147], v[116:131]
  ds_read_b64_tr_b16 v[164:165], v238 offset:6144
  ds_read_b64_tr_b16 v[166:167], v238 offset:6912
  ds_read_b64_tr_b16 v[168:169], v237 offset:6144
  v_mfma_f32_32x32x16_bf16 v[84:99], v[180:183], v[144:147], v[84:99]
  ds_read_b64_tr_b16 v[170:171], v237 offset:6912
  ds_read_b64_tr_b16 v[172:173], v236 offset:6144
  v_mfma_f32_32x32x16_bf16 v[52:67], v[176:179], v[144:147], v[52:67]
  ds_read_b64_tr_b16 v[174:175], v236 offset:6912
  s_add_u32 s68, s68, 131072
  s_addc_u32 s69, s69, 0
  buffer_load_dwordx4 v[140:143], v244, s[68:71], s60 offen sc1
  s_waitcnt vmcnt(14) lgkmcnt(6)
  v_mfma_f32_32x32x16_bf16 v[116:131], v[196:199], v[148:151], v[116:131]
  ds_read_b64_tr_b16 v[176:177], v241 offset:9216
  ds_read_b64_tr_b16 v[178:179], v241 offset:9984
  ds_read_b64_tr_b16 v[180:181], v240 offset:9216
  v_mfma_f32_32x32x16_bf16 v[84:99], v[192:195], v[148:151], v[84:99]
  ds_read_b64_tr_b16 v[182:183], v240 offset:9984
  ds_read_b64_tr_b16 v[184:185], v239 offset:9216
  v_mfma_f32_32x32x16_bf16 v[52:67], v[188:191], v[148:151], v[52:67]
  ds_read_b64_tr_b16 v[186:187], v239 offset:9984
  buffer_load_dwordx4 v[144:147], v244, s[68:71], s61 offen sc1
  s_waitcnt vmcnt(14) lgkmcnt(6)
  v_mfma_f32_32x32x16_bf16 v[116:131], v[172:175], v[152:155], v[116:131]
  ds_read_b64_tr_b16 v[188:189], v238 offset:9216
  ds_read_b64_tr_b16 v[190:191], v238 offset:9984
  ds_read_b64_tr_b16 v[192:193], v237 offset:9216
  v_mfma_f32_32x32x16_bf16 v[84:99], v[168:171], v[152:155], v[84:99]
  ds_read_b64_tr_b16 v[194:195], v237 offset:9984
  ds_read_b64_tr_b16 v[196:197], v236 offset:9216
  v_mfma_f32_32x32x16_bf16 v[52:67], v[164:167], v[152:155], v[52:67]
  ds_read_b64_tr_b16 v[198:199], v236 offset:9984
  s_add_u32 s68, s68, 262144
  s_addc_u32 s69, s69, 0
  buffer_load_dwordx4 v[148:151], v244, s[68:71], s57 offen sc1
  s_waitcnt vmcnt(14) lgkmcnt(6)
  v_mfma_f32_32x32x16_bf16 v[116:131], v[184:187], v[156:159], v[116:131]
  buffer_load_dwordx4 v[152:155], v244, s[68:71], s58 offen sc1
  v_mfma_f32_32x32x16_bf16 v[84:99], v[180:183], v[156:159], v[84:99]
  v_mfma_f32_32x32x16_bf16 v[52:67], v[176:179], v[156:159], v[52:67]
  s_waitcnt vmcnt(14) lgkmcnt(0)
  v_mfma_f32_32x32x16_bf16 v[116:131], v[196:199], v[160:163], v[116:131]
  s_sub_u32 s68, s68, 131072
  s_subb_u32 s69, s69, 0
  buffer_load_dwordx4 v[156:159], v244, s[68:71], s62 offen sc1
  v_mfma_f32_32x32x16_bf16 v[84:99], v[192:195], v[160:163], v[84:99]
  v_mfma_f32_32x32x16_bf16 v[52:67], v[188:191], v[160:163], v[52:67]
  s_waitcnt vmcnt(14)
  v_mfma_f32_32x32x16_bf16 v[100:115], a[8:11], v[4:7], 0
  buffer_load_dwordx4 v[160:163], v244, s[68:71], s64 offen sc1
  v_mfma_f32_32x32x16_bf16 v[68:83], a[4:7], v[4:7], v[68:83]
  v_mfma_f32_32x32x16_bf16 v[28:43], a[0:3], v[4:7], v[28:43]
  s_waitcnt vmcnt(14)
  v_mfma_f32_32x32x16_bf16 v[100:115], a[20:23], v[8:11], v[100:115]
  buffer_load_dwordx4 v[4:7], v244, s[68:71], s65 offen sc1
  ds_write_b128 v253, v[124:127] offset:38912
  v_mfma_f32_32x32x16_bf16 v[68:83], a[16:19], v[8:11], v[68:83]
  ds_write_b128 v253, v[128:131] offset:39936
  v_mfma_f32_32x32x16_bf16 v[28:43], a[12:15], v[8:11], v[28:43]
  ds_write_b128 v253, v[116:119] offset:36864
  s_waitcnt vmcnt(14)
  v_mfma_f32_32x32x16_bf16 v[100:115], a[32:35], v[12:15], v[100:115]
  buffer_load_dwordx4 v[8:11], v244, s[68:71], s66 offen sc1
  ds_write_b128 v253, v[120:123] offset:37888
  v_mfma_f32_32x32x16_bf16 v[68:83], a[28:31], v[12:15], v[68:83]
  ds_write_b128 v253, v[92:95] offset:34816
  ds_write_b128 v253, v[96:99] offset:35840
  v_mfma_f32_32x32x16_bf16 v[28:43], a[24:27], v[12:15], v[28:43]
  s_add_u32 s92, s78, 0
  s_sub_u32 s3, s92, 1441792
  s_min_u32 s92, s92, s3
  s_add_u32 m0, s43, 18432
  s_nop 0
  buffer_load_dwordx4 v248, s[80:83], s92 offen lds
  s_add_u32 m0, s43, 18432
  s_nop 0
  buffer_load_dwordx4 v247, s[80:83], s92 offen offset:1024 lds
  s_waitcnt vmcnt(16)
  v_mfma_f32_32x32x16_bf16 v[100:115], a[44:47], v[16:19], v[100:115]
  s_add_u32 s68, s68, 131072
  s_addc_u32 s69, s69, 0
  buffer_load_dwordx4 v[12:15], v244, s[68:71], s60 offen sc1
  v_mfma_f32_32x32x16_bf16 v[68:83], a[40:43], v[16:19], v[68:83]
  v_mfma_f32_32x32x16_bf16 v[28:43], a[36:39], v[16:19], v[28:43]
  s_waitcnt vmcnt(16)
  s_waitcnt lgkmcnt(0)
  s_barrier
  v_mfma_f32_32x32x16_bf16 v[100:115], a[56:59], v[20:23], v[100:115]
  ds_read_b128 v[92:95], v252 offset:34816
  ds_read_b128 v[96:99], v252 offset:35840
  ds_read_b128 v[116:119], v252 offset:36864
  ds_read_b128 v[120:123], v252 offset:37888
  v_mfma_f32_32x32x16_bf16 v[68:83], a[52:55], v[20:23], v[68:83]
  ds_read_b128 v[124:127], v252 offset:38912
  ds_read_b128 v[128:131], v252 offset:39936
  v_mfma_f32_32x32x16_bf16 v[28:43], a[48:51], v[20:23], v[28:43]
  buffer_load_dwordx4 v[16:19], v244, s[68:71], s61 offen sc1
  s_add_u32 s92, s78, 65536
  s_sub_u32 s3, s92, 1441792
  s_min_u32 s92, s92, s3
  s_add_u32 m0, s43, 20480
  s_nop 0
  buffer_load_dwordx4 v248, s[80:83], s92 offen lds
  s_add_u32 m0, s43, 20480
  s_nop 0
  buffer_load_dwordx4 v247, s[80:83], s92 offen offset:1024 lds
  s_waitcnt vmcnt(18)
  v_mfma_f32_32x32x16_bf16 v[100:115], a[68:71], v[24:27], v[100:115]
  buffer_load_dwordx4 v[20:23], v244, s[68:71], s62 offen sc1
  v_mfma_f32_32x32x16_bf16 v[68:83], a[64:67], v[24:27], v[68:83]
  v_mfma_f32_32x32x16_bf16 v[28:43], a[60:63], v[24:27], v[28:43]
  s_waitcnt vmcnt(18)
  v_mfma_f32_32x32x16_bf16 v[100:115], a[80:83], v[44:47], v[100:115]
  buffer_load_dwordx4 v[24:27], v244, s[68:71], s64 offen sc1
  s_waitcnt lgkmcnt(0)
  v_add_f32 v52, v52, v92
  v_add_f32 v53, v53, v93
  v_add_f32 v54, v54, v94
  v_mfma_f32_32x32x16_bf16 v[68:83], a[76:79], v[44:47], v[68:83]
  v_add_f32 v55, v55, v95
  v_add_f32 v56, v56, v96
  v_add_f32 v57, v57, v97
  v_add_f32 v58, v58, v98
  v_add_f32 v59, v59, v99
  v_mfma_f32_32x32x16_bf16 v[28:43], a[72:75], v[44:47], v[28:43]
  v_cvt_pk_bf16_f32 v200, v52, v53
  v_cvt_pk_bf16_f32 v201, v54, v55
  s_add_u32 s92, s78, 131072
  s_sub_u32 s3, s92, 1441792
  s_min_u32 s92, s92, s3
  s_add_u32 m0, s43, 22528
  s_nop 0
  buffer_load_dwordx4 v248, s[80:83], s92 offen lds
  s_add_u32 m0, s43, 22528
  s_nop 0
  buffer_load_dwordx4 v247, s[80:83], s92 offen offset:1024 lds
  s_waitcnt vmcnt(20)
  v_mfma_f32_32x32x16_bf16 v[100:115], a[92:95], v[48:51], v[100:115]
  buffer_load_dwordx4 v[44:47], v244, s[68:71], s65 offen sc1
  v_cvt_pk_bf16_f32 v202, v56, v57
  buffer_store_dwordx4 v[200:203], v254, s[32:35], s67 offen offset:0 sc1
  v_cvt_pk_bf16_f32 v204, v58, v59
  v_mfma_f32_32x32x16_bf16 v[68:83], a[88:91], v[48:51], v[68:83]
  v_add_f32 v60, v60, v116
  v_add_f32 v61, v61, v117
  v_add_f32 v62, v62, v118
  v_add_f32 v63, v63, v119
  v_mfma_f32_32x32x16_bf16 v[28:43], a[84:87], v[48:51], v[28:43]
  v_add_f32 v64, v64, v120
  v_add_f32 v65, v65, v121
  v_add_f32 v66, v66, v122
  v_add_f32 v67, v67, v123
  s_waitcnt vmcnt(21)
  v_mfma_f32_32x32x16_bf16 v[100:115], a[104:107], v[132:135], v[100:115]
  buffer_load_dwordx4 v[48:51], v244, s[68:71], s66 offen sc1
  v_cvt_pk_bf16_f32 v205, v60, v61
  v_cvt_pk_bf16_f32 v206, v62, v63
  buffer_store_dwordx4 v[204:207], v254, s[32:35], s67 offen offset:1024 sc1
  v_cvt_pk_bf16_f32 v208, v64, v65
  v_mfma_f32_32x32x16_bf16 v[68:83], a[100:103], v[132:135], v[68:83]
  v_cvt_pk_bf16_f32 v209, v66, v67
  v_add_f32 v84, v84, v124
  v_add_f32 v85, v85, v125
  v_add_f32 v86, v86, v126
  v_add_f32 v87, v87, v127
  v_mfma_f32_32x32x16_bf16 v[28:43], a[96:99], v[132:135], v[28:43]
  v_add_f32 v88, v88, v128
  v_add_f32 v89, v89, v129
  s_add_u32 s92, s78, 196608
  s_sub_u32 s3, s92, 1441792
  s_min_u32 s92, s92, s3
  s_add_u32 m0, s43, 24576
  s_nop 0
  buffer_load_dwordx4 v248, s[80:83], s92 offen lds
  s_add_u32 m0, s43, 24576
  s_nop 0
  buffer_load_dwordx4 v247, s[80:83], s92 offen offset:1024 lds
  s_waitcnt vmcnt(24)
  v_mfma_f32_32x32x16_bf16 v[100:115], a[116:119], v[136:139], v[100:115]
  s_sub_u32 s68, s68, 131072
  s_subb_u32 s69, s69, 0
  buffer_load_dwordx4 v[132:135], v244, s[68:71], s57 offen sc1
  v_add_f32 v90, v90, v130
  v_add_f32 v91, v91, v131
  v_mfma_f32_32x32x16_bf16 v[68:83], a[112:115], v[136:139], v[68:83]
  v_cvt_pk_bf16_f32 v210, v84, v85
  buffer_store_dwordx4 v[208:211], v254, s[32:35], s67 offen offset:2048 sc1
  v_cvt_pk_bf16_f32 v212, v86, v87
  v_mfma_f32_32x32x16_bf16 v[28:43], a[108:111], v[136:139], v[28:43]
  v_cvt_pk_bf16_f32 v213, v88, v89
  v_cvt_pk_bf16_f32 v214, v90, v91
  buffer_store_dwordx4 v[212:215], v254, s[32:35], s67 offen offset:3072 sc1
  s_waitcnt vmcnt(26)
  v_mfma_f32_32x32x16_bf16 v[100:115], a[128:131], v[140:143], v[100:115]
  ds_read_b64_tr_b16 v[164:165], v241 offset:12288
  ds_read_b64_tr_b16 v[166:167], v241 offset:13056
  ds_read_b64_tr_b16 v[168:169], v240 offset:12288
  v_mfma_f32_32x32x16_bf16 v[68:83], a[124:127], v[140:143], v[68:83]
  ds_read_b64_tr_b16 v[170:171], v240 offset:13056
  ds_read_b64_tr_b16 v[172:173], v239 offset:12288
  ds_read_b64_tr_b16 v[174:175], v239 offset:13056
  v_mfma_f32_32x32x16_bf16 v[28:43], a[120:123], v[140:143], v[28:43]
  buffer_load_dwordx4 v[136:139], v244, s[68:71], s58 offen sc1
  s_add_u32 s92, s78, 262144
  s_sub_u32 s3, s92, 1441792
  s_min_u32 s92, s92, s3
  s_add_u32 m0, s43, 34816
  s_nop 0
  buffer_load_dwordx4 v248, s[80:83], s92 offen lds
  s_add_u32 m0, s43, 34816
  s_nop 0
  buffer_load_dwordx4 v247, s[80:83], s92 offen offset:1024 lds
  s_waitcnt vmcnt(28)
  v_mfma_f32_32x32x16_bf16 v[100:115], a[140:143], v[144:147], v[100:115]
  ds_read_b64_tr_b16 v[176:177], v238 offset:12288
  ds_read_b64_tr_b16 v[178:179], v238 offset:13056
  ds_read_b64_tr_b16 v[180:181], v237 offset:12288
  v_mfma_f32_32x32x16_bf16 v[68:83], a[136:139], v[144:147], v[68:83]
  ds_read_b64_tr_b16 v[182:183], v237 offset:13056
  ds_read_b64_tr_b16 v[184:185], v236 offset:12288
  v_mfma_f32_32x32x16_bf16 v[28:43], a[132:135], v[144:147], v[28:43]
  ds_read_b64_tr_b16 v[186:187], v236 offset:13056
  s_sub_u32 s68, s68, 131072
  s_subb_u32 s69, s69, 0
  buffer_load_dwordx4 v[140:143], v244, s[68:71], s62 offen sc1
  s_waitcnt vmcnt(28) lgkmcnt(6)
  v_mfma_f32_32x32x16_bf16 v[100:115], v[172:175], v[148:151], v[100:115]
  ds_read_b64_tr_b16 v[188:189], v241 offset:15360
  ds_read_b64_tr_b16 v[190:191], v241 offset:16128
  ds_read_b64_tr_b16 v[192:193], v240 offset:15360
  v_mfma_f32_32x32x16_bf16 v[68:83], v[168:171], v[148:151], v[68:83]
  ds_read_b64_tr_b16 v[194:195], v240 offset:16128
  ds_read_b64_tr_b16 v[196:197], v239 offset:15360
  ds_read_b64_tr_b16 v[198:199], v239 offset:16128
  v_mfma_f32_32x32x16_bf16 v[28:43], v[164:167], v[148:151], v[28:43]
  buffer_load_dwordx4 v[144:147], v244, s[68:71], s64 offen sc1
  s_add_u32 s92, s78, 327680
  s_sub_u32 s3, s92, 1441792
  s_min_u32 s92, s92, s3
  s_add_u32 m0, s43, 36864
  s_nop 0
  buffer_load_dwordx4 v248, s[80:83], s92 offen lds
  s_add_u32 m0, s43, 36864
  s_nop 0
  buffer_load_dwordx4 v247, s[80:83], s92 offen offset:1024 lds
  s_waitcnt vmcnt(30) lgkmcnt(6)
  v_mfma_f32_32x32x16_bf16 v[100:115], v[184:187], v[152:155], v[100:115]
  ds_read_b64_tr_b16 v[164:165], v238 offset:15360
  ds_read_b64_tr_b16 v[166:167], v238 offset:16128
  ds_read_b64_tr_b16 v[168:169], v237 offset:15360
  v_mfma_f32_32x32x16_bf16 v[68:83], v[180:183], v[152:155], v[68:83]
  ds_read_b64_tr_b16 v[170:171], v237 offset:16128
  ds_read_b64_tr_b16 v[172:173], v236 offset:15360
  v_mfma_f32_32x32x16_bf16 v[28:43], v[176:179], v[152:155], v[28:43]
  ds_read_b64_tr_b16 v[174:175], v236 offset:16128
  buffer_load_dwordx4 v[148:151], v244, s[68:71], s65 offen sc1
  s_waitcnt vmcnt(30) lgkmcnt(6)
  v_mfma_f32_32x32x16_bf16 v[100:115], v[196:199], v[156:159], v[100:115]
  ds_read_b64_tr_b16 v[176:177], v241 offset:0
  ds_read_b64_tr_b16 v[178:179], v241 offset:768
  ds_read_b64_tr_b16 v[180:181], v240 offset:0
  v_mfma_f32_32x32x16_bf16 v[68:83], v[192:195], v[156:159], v[68:83]
  ds_read_b64_tr_b16 v[182:183], v240 offset:768
  ds_read_b64_tr_b16 v[184:185], v239 offset:0
  ds_read_b64_tr_b16 v[186:187], v239 offset:768
  v_mfma_f32_32x32x16_bf16 v[28:43], v[188:191], v[156:159], v[28:43]
  buffer_load_dwordx4 v[152:155], v244, s[68:71], s66 offen sc1
  s_add_u32 s92, s78, 393216
  s_sub_u32 s3, s92, 1441792
  s_min_u32 s92, s92, s3
  s_add_u32 m0, s43, 38912
  s_nop 0
  buffer_load_dwordx4 v248, s[80:83], s92 offen lds
  s_add_u32 m0, s43, 38912
  s_nop 0
  buffer_load_dwordx4 v247, s[80:83], s92 offen offset:1024 lds
  s_waitcnt vmcnt(32) lgkmcnt(6)
  v_mfma_f32_32x32x16_bf16 v[100:115], v[172:175], v[160:163], v[100:115]
  ds_read_b64_tr_b16 v[188:189], v238 offset:0
  ds_read_b64_tr_b16 v[190:191], v238 offset:768
  ds_read_b64_tr_b16 v[192:193], v237 offset:0
  v_mfma_f32_32x32x16_bf16 v[68:83], v[168:171], v[160:163], v[68:83]
  ds_read_b64_tr_b16 v[194:195], v237 offset:768
  ds_read_b64_tr_b16 v[196:197], v236 offset:0
  v_mfma_f32_32x32x16_bf16 v[28:43], v[164:167], v[160:163], v[28:43]
  ds_read_b64_tr_b16 v[198:199], v236 offset:768
  s_add_u32 s68, s68, 131072
  s_addc_u32 s69, s69, 0
  buffer_load_dwordx4 v[156:159], v244, s[68:71], s60 offen sc1
  s_waitcnt vmcnt(32) lgkmcnt(6)
  v_mfma_f32_32x32x16_bf16 v[100:115], v[184:187], v[4:7], v[100:115]
  ds_read_b64_tr_b16 v[164:165], v241 offset:3072
  ds_read_b64_tr_b16 v[166:167], v241 offset:3840
  ds_read_b64_tr_b16 v[168:169], v240 offset:3072
  v_mfma_f32_32x32x16_bf16 v[68:83], v[180:183], v[4:7], v[68:83]
  ds_read_b64_tr_b16 v[170:171], v240 offset:3840
  ds_read_b64_tr_b16 v[172:173], v239 offset:3072
  ds_read_b64_tr_b16 v[174:175], v239 offset:3840
  v_mfma_f32_32x32x16_bf16 v[28:43], v[176:179], v[4:7], v[28:43]
  buffer_load_dwordx4 v[160:163], v244, s[68:71], s61 offen sc1
  s_add_u32 s92, s78, 458752
  s_sub_u32 s3, s92, 1441792
  s_min_u32 s92, s92, s3
  s_add_u32 m0, s43, 26624
  s_nop 0
  buffer_load_dwordx4 v248, s[80:83], s92 offen lds
  s_add_u32 m0, s43, 26624
  s_nop 0
  buffer_load_dwordx4 v247, s[80:83], s92 offen offset:1024 lds
  s_waitcnt vmcnt(34) lgkmcnt(6)
  v_mfma_f32_32x32x16_bf16 v[100:115], v[196:199], v[8:11], v[100:115]
  ds_read_b64_tr_b16 v[176:177], v238 offset:3072
  ds_read_b64_tr_b16 v[178:179], v238 offset:3840
  ds_read_b64_tr_b16 v[180:181], v237 offset:3072
  v_mfma_f32_32x32x16_bf16 v[68:83], v[192:195], v[8:11], v[68:83]
  ds_read_b64_tr_b16 v[182:183], v237 offset:3840
  ds_read_b64_tr_b16 v[184:185], v236 offset:3072
  ds_read_b64_tr_b16 v[186:187], v236 offset:3840
  v_mfma_f32_32x32x16_bf16 v[28:43], v[188:191], v[8:11], v[28:43]
  s_add_u32 s92, s78, 524288
  s_sub_u32 s3, s92, 1441792
  s_min_u32 s92, s92, s3
  s_add_u32 m0, s43, 28672
  s_nop 0
  buffer_load_dwordx4 v248, s[80:83], s92 offen lds
  s_add_u32 m0, s43, 28672
  s_nop 0
  buffer_load_dwordx4 v247, s[80:83], s92 offen offset:1024 lds
  s_waitcnt vmcnt(33) lgkmcnt(6)
  v_mfma_f32_32x32x16_bf16 v[100:115], v[172:175], v[12:15], v[100:115]
  ds_read_b64_tr_b16 v[188:189], v241 offset:6144
  ds_read_b64_tr_b16 v[190:191], v241 offset:6912
  ds_read_b64_tr_b16 v[192:193], v240 offset:6144
  v_mfma_f32_32x32x16_bf16 v[68:83], v[168:171], v[12:15], v[68:83]
  ds_read_b64_tr_b16 v[194:195], v240 offset:6912
  ds_read_b64_tr_b16 v[196:197], v239 offset:6144
  ds_read_b64_tr_b16 v[198:199], v239 offset:6912
  v_mfma_f32_32x32x16_bf16 v[28:43], v[164:167], v[12:15], v[28:43]
  s_add_u32 s92, s78, 589824
  s_sub_u32 s3, s92, 1441792
  s_min_u32 s92, s92, s3
  s_add_u32 m0, s43, 30720
  s_nop 0
  buffer_load_dwordx4 v248, s[80:83], s92 offen lds
  s_add_u32 m0, s43, 30720
  s_nop 0
  buffer_load_dwordx4 v247, s[80:83], s92 offen offset:1024 lds
  s_waitcnt vmcnt(34) lgkmcnt(6)
  v_mfma_f32_32x32x16_bf16 v[100:115], v[184:187], v[16:19], v[100:115]
  ds_read_b64_tr_b16 v[164:165], v238 offset:6144
  ds_read_b64_tr_b16 v[166:167], v238 offset:6912
  ds_read_b64_tr_b16 v[168:169], v237 offset:6144
  v_mfma_f32_32x32x16_bf16 v[68:83], v[180:183], v[16:19], v[68:83]
  ds_read_b64_tr_b16 v[170:171], v237 offset:6912
  ds_read_b64_tr_b16 v[172:173], v236 offset:6144
  ds_read_b64_tr_b16 v[174:175], v236 offset:6912
  v_mfma_f32_32x32x16_bf16 v[28:43], v[176:179], v[16:19], v[28:43]
  s_add_u32 s92, s78, 655360
  s_sub_u32 s3, s92, 1441792
  s_min_u32 s92, s92, s3
  s_add_u32 m0, s43, 32768
  s_nop 0
  buffer_load_dwordx4 v248, s[80:83], s92 offen lds
  s_add_u32 m0, s43, 32768
  s_nop 0
  buffer_load_dwordx4 v247, s[80:83], s92 offen offset:1024 lds
  s_waitcnt vmcnt(33) lgkmcnt(6)
  v_mfma_f32_32x32x16_bf16 v[100:115], v[196:199], v[20:23], v[100:115]
  ds_read_b64_tr_b16 v[176:177], v241 offset:9216
  ds_read_b64_tr_b16 v[178:179], v241 offset:9984
  ds_read_b64_tr_b16 v[180:181], v240 offset:9216
  ds_read_b64_tr_b16 v[182:183], v240 offset:9984
  v_mfma_f32_32x32x16_bf16 v[68:83], v[192:195], v[20:23], v[68:83]
  ds_read_b64_tr_b16 v[184:185], v239 offset:9216
  ds_read_b64_tr_b16 v[186:187], v239 offset:9984
  ds_read_b64_tr_b16 a[0:1], v242 offset:18432
  ds_read_b64_tr_b16 a[2:3], v242 offset:19456
  v_mfma_f32_32x32x16_bf16 v[28:43], v[188:191], v[20:23], v[28:43]
  ds_read_b64_tr_b16 a[4:5], v235 offset:18432
  ds_read_b64_tr_b16 a[6:7], v235 offset:19456
  s_waitcnt lgkmcnt(0)
  s_add_u32 s92, s78, 720896
  s_sub_u32 s3, s92, 1441792
  s_min_u32 s92, s92, s3
  s_add_u32 m0, s43, 18432
  s_nop 0
  buffer_load_dwordx4 v248, s[80:83], s92 offen lds
  s_add_u32 m0, s43, 18432
  s_nop 0
  buffer_load_dwordx4 v247, s[80:83], s92 offen offset:1024 lds
  s_waitcnt vmcnt(34)
  v_mfma_f32_32x32x16_bf16 v[100:115], v[172:175], v[24:27], v[100:115]
  ds_read_b64_tr_b16 v[188:189], v238 offset:9216
  ds_read_b64_tr_b16 v[190:191], v238 offset:9984
  ds_read_b64_tr_b16 v[192:193], v237 offset:9216
  ds_read_b64_tr_b16 v[194:195], v237 offset:9984
  v_mfma_f32_32x32x16_bf16 v[68:83], v[168:171], v[24:27], v[68:83]
  ds_read_b64_tr_b16 v[196:197], v236 offset:9216
  ds_read_b64_tr_b16 v[198:199], v236 offset:9984
  ds_read_b64_tr_b16 a[8:9], v242 offset:20480
  ds_read_b64_tr_b16 a[10:11], v242 offset:21504
  v_mfma_f32_32x32x16_bf16 v[28:43], v[164:167], v[24:27], v[28:43]
  ds_read_b64_tr_b16 a[12:13], v235 offset:20480
  ds_read_b64_tr_b16 a[14:15], v235 offset:21504
  s_waitcnt lgkmcnt(0)
  s_add_u32 s92, s78, 786432
  s_sub_u32 s3, s92, 1441792
  s_min_u32 s92, s92, s3
  s_add_u32 m0, s43, 20480
  s_nop 0
  buffer_load_dwordx4 v248, s[80:83], s92 offen lds
  s_add_u32 m0, s43, 20480
  s_nop 0
  buffer_load_dwordx4 v247, s[80:83], s92 offen offset:1024 lds
  s_waitcnt vmcnt(33)
  v_mfma_f32_32x32x16_bf16 v[100:115], v[184:187], v[44:47], v[100:115]
  ds_read_b64_tr_b16 a[16:17], v242 offset:22528
  ds_read_b64_tr_b16 a[18:19], v242 offset:23552
  v_mfma_f32_32x32x16_bf16 v[68:83], v[180:183], v[44:47], v[68:83]
  ds_read_b64_tr_b16 a[20:21], v235 offset:22528
  ds_read_b64_tr_b16 a[22:23], v235 offset:23552
  v_mfma_f32_32x32x16_bf16 v[28:43], v[176:179], v[44:47], v[28:43]
  s_waitcnt lgkmcnt(0)
  s_add_u32 s92, s78, 851968
  s_sub_u32 s3, s92, 1441792
  s_min_u32 s92, s92, s3
  s_add_u32 m0, s43, 22528
  s_nop 0
  buffer_load_dwordx4 v248, s[80:83], s92 offen lds
  s_add_u32 m0, s43, 22528
  s_nop 0
  buffer_load_dwordx4 v247, s[80:83], s92 offen offset:1024 lds
  s_waitcnt vmcnt(33)
  v_mfma_f32_32x32x16_bf16 v[100:115], v[196:199], v[48:51], v[100:115]
  v_mfma_f32_32x32x16_bf16 v[68:83], v[192:195], v[48:51], v[68:83]
  v_mfma_f32_32x32x16_bf16 v[28:43], v[188:191], v[48:51], v[28:43]
  s_waitcnt vmcnt(29)
  s_barrier
  v_mfma_f32_32x32x16_bf16 v[100:115], a[152:155], v[132:135], v[100:115]
  v_mfma_f32_32x32x16_bf16 v[68:83], a[148:151], v[132:135], v[68:83]
  v_mfma_f32_32x32x16_bf16 v[28:43], a[144:147], v[132:135], v[28:43]
  s_waitcnt vmcnt(26)
  v_mfma_f32_32x32x16_bf16 v[100:115], a[164:167], v[136:139], v[100:115]
  v_mfma_f32_32x32x16_bf16 v[68:83], a[160:163], v[136:139], v[68:83]
  v_mfma_f32_32x32x16_bf16 v[28:43], a[156:159], v[136:139], v[28:43]
  s_waitcnt vmcnt(23)
  v_mfma_f32_32x32x16_bf16 v[100:115], a[176:179], v[140:143], v[100:115]
  v_mfma_f32_32x32x16_bf16 v[68:83], a[172:175], v[140:143], v[68:83]
  v_mfma_f32_32x32x16_bf16 v[28:43], a[168:171], v[140:143], v[28:43]
  s_waitcnt vmcnt(22)
  v_mfma_f32_32x32x16_bf16 v[100:115], a[188:191], v[144:147], v[100:115]
  v_mfma_f32_32x32x16_bf16 v[68:83], a[184:187], v[144:147], v[68:83]
  v_mfma_f32_32x32x16_bf16 v[28:43], a[180:183], v[144:147], v[28:43]
  s_waitcnt vmcnt(19)
  v_mfma_f32_32x32x16_bf16 v[100:115], a[200:203], v[148:151], v[100:115]
  buffer_load_dwordx4 v[116:119], v254, s[32:35], s74 offen offset:0 sc1
  buffer_load_dwordx4 v[120:123], v254, s[32:35], s74 offen offset:1024 sc1
  buffer_load_dwordx4 v[124:127], v254, s[32:35], s74 offen offset:2048 sc1
  v_mfma_f32_32x32x16_bf16 v[68:83], a[196:199], v[148:151], v[68:83]
  buffer_load_dwordx4 v[128:131], v254, s[32:35], s74 offen offset:3072 sc1
  s_waitcnt vmcnt(22)
  v_mfma_f32_32x32x16_bf16 v[100:115], a[212:215], v[152:155], v[100:115]
  v_mfma_f32_32x32x16_bf16 v[68:83], a[208:211], v[152:155], v[68:83]
  s_waitcnt vmcnt(19)
  v_mfma_f32_32x32x16_bf16 v[100:115], a[224:227], v[156:159], v[100:115]
  v_mfma_f32_32x32x16_bf16 v[68:83], a[220:223], v[156:159], v[68:83]
  s_waitcnt vmcnt(18)
  v_mfma_f32_32x32x16_bf16 v[100:115], a[236:239], v[160:163], v[100:115]
  v_mfma_f32_32x32x16_bf16 v[68:83], a[232:235], v[160:163], v[68:83]
  v_mfma_f32_32x32x16_bf16 v[28:43], a[192:195], v[148:151], v[28:43]
  v_mfma_f32_32x32x16_bf16 v[28:43], a[204:207], v[152:155], v[28:43]
  ds_write_b128 v253, v[108:111] offset:4096
  v_mfma_f32_32x32x16_bf16 v[28:43], a[216:219], v[156:159], v[28:43]
  ds_write_b128 v253, v[112:115] offset:5120
  v_mfma_f32_32x32x16_bf16 v[28:43], a[228:231], v[160:163], v[28:43]
  ds_write_b128 v253, v[100:103] offset:2048
  ds_write_b128 v253, v[104:107] offset:3072
  ds_write_b128 v253, v[76:79] offset:0
  ds_write_b128 v253, v[80:83] offset:1024
  s_waitcnt vmcnt(0)
  v_xor_b32 v52, s42, v119
  v_xor_b32 v53, s42, v123
  v_xor_b32 v54, s42, v127
  v_xor_b32 v55, s42, v131
  v_or3_b32 v52, v52, v53, v54
  v_or_b32 v52, v52, v55
  v_cmp_ne_u32 vcc, 0, v52
  s_cbranch_vccnz UCHK_7
UOK_8:
  v_lshlrev_b32 v52, 16, v116
  v_and_b32 v53, 0xffff0000, v116
  v_lshlrev_b32 v54, 16, v117
  v_and_b32 v55, 0xffff0000, v117
  v_lshlrev_b32 v56, 16, v118
  v_and_b32 v57, 0xffff0000, v118
  v_lshlrev_b32 v58, 16, v120
  v_and_b32 v59, 0xffff0000, v120
  v_pk_add_f32 v[28:29], v[28:29], v[52:53]
  v_pk_add_f32 v[30:31], v[30:31], v[54:55]
  v_pk_add_f32 v[32:33], v[32:33], v[56:57]
  v_pk_add_f32 v[34:35], v[34:35], v[58:59]
  v_lshlrev_b32 v52, 16, v121
  v_and_b32 v53, 0xffff0000, v121
  v_lshlrev_b32 v54, 16, v122
  v_and_b32 v55, 0xffff0000, v122
  v_lshlrev_b32 v56, 16, v124
  v_and_b32 v57, 0xffff0000, v124
  v_lshlrev_b32 v58, 16, v125
  v_and_b32 v59, 0xffff0000, v125
  v_pk_add_f32 v[36:37], v[36:37], v[52:53]
  v_pk_add_f32 v[38:39], v[38:39], v[54:55]
  v_pk_add_f32 v[40:41], v[40:41], v[56:57]
  v_pk_add_f32 v[42:43], v[42:43], v[58:59]
  v_lshlrev_b32 v52, 16, v126
  v_and_b32 v53, 0xffff0000, v126
  v_lshlrev_b32 v54, 16, v128
  v_and_b32 v55, 0xffff0000, v128
  v_lshlrev_b32 v56, 16, v129
  v_and_b32 v57, 0xffff0000, v129
  v_lshlrev_b32 v58, 16, v130
  v_and_b32 v59, 0xffff0000, v130
  v_pk_add_f32 v[68:69], v[68:69], v[52:53]
  v_pk_add_f32 v[70:71], v[70:71], v[54:55]
  v_pk_add_f32 v[72:73], v[72:73], v[56:57]
  v_pk_add_f32 v[74:75], v[74:75], v[58:59]
  s_waitcnt lgkmcnt(0)
  s_barrier
  ds_read_b128 v[76:79], v252 offset:0
  ds_read_b128 v[80:83], v252 offset:1024
  ds_read_b128 v[100:103], v252 offset:2048
  ds_read_b128 v[104:107], v252 offset:3072
  ds_read_b128 v[108:111], v252 offset:4096
  ds_read_b128 v[112:115], v252 offset:5120
  s_add_u32 s92, s78, 917504
  s_sub_u32 s3, s92, 1441792
  s_min_u32 s92, s92, s3
  s_add_u32 m0, s43, 6144
  s_nop 0
  buffer_load_dwordx4 v248, s[80:83], s92 offen lds
  buffer_load_dwordx4 v247, s[80:83], s92 offen offset:1024 lds
  s_add_u32 s92, s78, 983040
  s_sub_u32 s3, s92, 1441792
  s_min_u32 s92, s92, s3
  s_add_u32 m0, s43, 8192
  s_nop 0
  buffer_load_dwordx4 v248, s[80:83], s92 offen lds
  buffer_load_dwordx4 v247, s[80:83], s92 offen offset:1024 lds
  s_mov_b32 s50, 0xbdd2d3e8
  v_mov_b32 v250, 0xc0135761
  s_waitcnt lgkmcnt(4)
  v_pk_add_f32 v[28:29], v[28:29], v[76:77]
  v_pk_add_f32 v[30:31], v[30:31], v[78:79]
  v_pk_add_f32 v[32:33], v[32:33], v[80:81]
  v_pk_add_f32 v[34:35], v[34:35], v[82:83]
  v_pk_mul_f32 v[52:53], v[28:29], v[28:29]
  v_pk_mul_f32 v[54:55], v[30:31], v[30:31]
  v_pk_mul_f32 v[56:57], v[32:33], v[32:33]
  v_pk_mul_f32 v[58:59], v[34:35], v[34:35]
  v_pk_fma_f32 v[52:53], v[52:53], s[50:51], v[250:251] op_sel_hi:[1,0,0]
  v_pk_fma_f32 v[54:55], v[54:55], s[50:51], v[250:251] op_sel_hi:[1,0,0]
  v_pk_fma_f32 v[56:57], v[56:57], s[50:51], v[250:251] op_sel_hi:[1,0,0]
  v_pk_fma_f32 v[58:59], v[58:59], s[50:51], v[250:251] op_sel_hi:[1,0,0]
  v_pk_mul_f32 v[52:53], v[52:53], v[28:29]
  v_pk_mul_f32 v[54:55], v[54:55], v[30:31]
  v_pk_mul_f32 v[56:57], v[56:57], v[32:33]
  v_pk_mul_f32 v[58:59], v[58:59], v[34:35]
  v_exp_f32 v52, v52
  v_exp_f32 v53, v53
  v_exp_f32 v54, v54
  v_exp_f32 v55, v55
  v_exp_f32 v56, v56
  v_exp_f32 v57, v57
  v_exp_f32 v58, v58
  v_exp_f32 v59, v59
  v_pk_add_f32 v[52:53], v[52:53], 1.0 op_sel_hi:[1,0]
  v_pk_add_f32 v[54:55], v[54:55], 1.0 op_sel_hi:[1,0]
  v_pk_add_f32 v[56:57], v[56:57], 1.0 op_sel_hi:[1,0]
  v_pk_add_f32 v[58:59], v[58:59], 1.0 op_sel_hi:[1,0]
  v_rcp_f32 v52, v52
  v_rcp_f32 v53, v53
  v_rcp_f32 v54, v54
  v_rcp_f32 v55, v55
  v_rcp_f32 v56, v56
  v_rcp_f32 v57, v57
  v_rcp_f32 v58, v58
  v_rcp_f32 v59, v59
  v_pk_mul_f32 v[28:29], v[28:29], v[52:53]
  v_pk_mul_f32 v[30:31], v[30:31], v[54:55]
  v_pk_mul_f32 v[32:33], v[32:33], v[56:57]
  v_pk_mul_f32 v[34:35], v[34:35], v[58:59]
  v_cvt_pk_bf16_f32 v28, v28, v29
  v_cvt_pk_bf16_f32 v29, v30, v31
  v_cvt_pk_bf16_f32 v30, v32, v33
  v_cvt_pk_bf16_f32 v31, v34, v35
  buffer_store_dwordx4 v[28:31], v244, s[36:39], s63 offen sc1
  s_waitcnt lgkmcnt(2)
  v_pk_add_f32 v[36:37], v[36:37], v[100:101]
  v_pk_add_f32 v[38:39], v[38:39], v[102:103]
  v_pk_add_f32 v[40:41], v[40:41], v[104:105]
  v_pk_add_f32 v[42:43], v[42:43], v[106:107]
  v_pk_mul_f32 v[52:53], v[36:37], v[36:37]
  v_pk_mul_f32 v[54:55], v[38:39], v[38:39]
  v_pk_mul_f32 v[56:57], v[40:41], v[40:41]
  v_pk_mul_f32 v[58:59], v[42:43], v[42:43]
  v_pk_fma_f32 v[52:53], v[52:53], s[50:51], v[250:251] op_sel_hi:[1,0,0]
  v_pk_fma_f32 v[54:55], v[54:55], s[50:51], v[250:251] op_sel_hi:[1,0,0]
  v_pk_fma_f32 v[56:57], v[56:57], s[50:51], v[250:251] op_sel_hi:[1,0,0]
  v_pk_fma_f32 v[58:59], v[58:59], s[50:51], v[250:251] op_sel_hi:[1,0,0]
  v_pk_mul_f32 v[52:53], v[52:53], v[36:37]
  v_pk_mul_f32 v[54:55], v[54:55], v[38:39]
  v_pk_mul_f32 v[56:57], v[56:57], v[40:41]
  v_pk_mul_f32 v[58:59], v[58:59], v[42:43]
  v_exp_f32 v52, v52
  v_exp_f32 v53, v53
  v_exp_f32 v54, v54
  v_exp_f32 v55, v55
  v_exp_f32 v56, v56
  v_exp_f32 v57, v57
  v_exp_f32 v58, v58
  v_exp_f32 v59, v59
  v_pk_add_f32 v[52:53], v[52:53], 1.0 op_sel_hi:[1,0]
  v_pk_add_f32 v[54:55], v[54:55], 1.0 op_sel_hi:[1,0]
  v_pk_add_f32 v[56:57], v[56:57], 1.0 op_sel_hi:[1,0]
  v_pk_add_f32 v[58:59], v[58:59], 1.0 op_sel_hi:[1,0]
  v_rcp_f32 v52, v52
  v_rcp_f32 v53, v53
  v_rcp_f32 v54, v54
  v_rcp_f32 v55, v55
  v_rcp_f32 v56, v56
  v_rcp_f32 v57, v57
  v_rcp_f32 v58, v58
  v_rcp_f32 v59, v59
  v_pk_mul_f32 v[36:37], v[36:37], v[52:53]
  v_pk_mul_f32 v[38:39], v[38:39], v[54:55]
  v_pk_mul_f32 v[40:41], v[40:41], v[56:57]
  v_pk_mul_f32 v[42:43], v[42:43], v[58:59]
  v_cvt_pk_bf16_f32 v36, v36, v37
  v_cvt_pk_bf16_f32 v37, v38, v39
  v_cvt_pk_bf16_f32 v38, v40, v41
  v_cvt_pk_bf16_f32 v39, v42, v43
  buffer_store_dwordx4 v[36:39], v244, s[36:39], s72 offen sc1
  s_waitcnt lgkmcnt(0)
  v_pk_add_f32 v[68:69], v[68:69], v[108:109]
  v_pk_add_f32 v[70:71], v[70:71], v[110:111]
  v_pk_add_f32 v[72:73], v[72:73], v[112:113]
  v_pk_add_f32 v[74:75], v[74:75], v[114:115]
  v_pk_mul_f32 v[52:53], v[68:69], v[68:69]
  v_pk_mul_f32 v[54:55], v[70:71], v[70:71]
  v_pk_mul_f32 v[56:57], v[72:73], v[72:73]
  v_pk_mul_f32 v[58:59], v[74:75], v[74:75]
  v_pk_fma_f32 v[52:53], v[52:53], s[50:51], v[250:251] op_sel_hi:[1,0,0]
  v_pk_fma_f32 v[54:55], v[54:55], s[50:51], v[250:251] op_sel_hi:[1,0,0]
  v_pk_fma_f32 v[56:57], v[56:57], s[50:51], v[250:251] op_sel_hi:[1,0,0]
  v_pk_fma_f32 v[58:59], v[58:59], s[50:51], v[250:251] op_sel_hi:[1,0,0]
  v_pk_mul_f32 v[52:53], v[52:53], v[68:69]
  v_pk_mul_f32 v[54:55], v[54:55], v[70:71]
  v_pk_mul_f32 v[56:57], v[56:57], v[72:73]
  v_pk_mul_f32 v[58:59], v[58:59], v[74:75]
  v_exp_f32 v52, v52
  v_exp_f32 v53, v53
  v_exp_f32 v54, v54
  v_exp_f32 v55, v55
  v_exp_f32 v56, v56
  v_exp_f32 v57, v57
  v_exp_f32 v58, v58
  v_exp_f32 v59, v59
  v_pk_add_f32 v[52:53], v[52:53], 1.0 op_sel_hi:[1,0]
  v_pk_add_f32 v[54:55], v[54:55], 1.0 op_sel_hi:[1,0]
  v_pk_add_f32 v[56:57], v[56:57], 1.0 op_sel_hi:[1,0]
  v_pk_add_f32 v[58:59], v[58:59], 1.0 op_sel_hi:[1,0]
  v_rcp_f32 v52, v52
  v_rcp_f32 v53, v53
  v_rcp_f32 v54, v54
  v_rcp_f32 v55, v55
  v_rcp_f32 v56, v56
  v_rcp_f32 v57, v57
  v_rcp_f32 v58, v58
  v_rcp_f32 v59, v59
  v_pk_mul_f32 v[68:69], v[68:69], v[52:53]
  v_pk_mul_f32 v[70:71], v[70:71], v[54:55]
  v_pk_mul_f32 v[72:73], v[72:73], v[56:57]
  v_pk_mul_f32 v[74:75], v[74:75], v[58:59]
  v_cvt_pk_bf16_f32 v68, v68, v69
  v_cvt_pk_bf16_f32 v69, v70, v71
  v_cvt_pk_bf16_f32 v70, v72, v73
  v_cvt_pk_bf16_f32 v71, v74, v75
  buffer_store_dwordx4 v[68:71], v244, s[36:39], s73 offen sc1
  buffer_load_dword v249, v230, s[32:35], 0 offen sc1
  v_and_b32 v241, 31, v255
  v_lshrrev_b32 v243, 5, v255
  v_lshlrev_b32 v243, 4, v243
  v_lshl_add_u32 v243, v241, 10, v243
  v_lshlrev_b32 v241, 1, v241
  s_lshr_b32 s56, s26, 1
  s_lshl_b32 s57, s75, 1
  s_add_u32 s56, s56, s57
  s_lshl_b32 s57, s56, 6
  s_lshl_b32 s56, s56, 9
  s_and_b32 s68, s26, 1
  s_add_u32 s56, s56, s68
  s_lshl_b32 s68, s76, 1
  s_add_u32 s56, s56, s68
  s_lshl_b32 s56, s56, 6
  s_mov_b32 s68, s18
  s_mov_b32 s69, s19
  s_mov_b32 s70, 0x1000
  s_mov_b32 s71, 0x20000
  buffer_load_dwordx4 v[4:7], v243, s[28:31], s56 offen
  buffer_load_dwordx4 v[8:11], v243, s[28:31], s56 offen offset:32
  buffer_load_ushort v241, v241, s[68:71], s57 offen
  s_add_u32 s92, s78, 1048576
  s_sub_u32 s3, s92, 1441792
  s_min_u32 s92, s92, s3
  s_add_u32 m0, s43, 0
  s_nop 0
  buffer_load_dwordx4 v248, s[80:83], s92 offen lds
  buffer_load_dwordx4 v247, s[80:83], s92 offen offset:1024 lds
  s_add_u32 s92, s78, 1114112
  s_sub_u32 s3, s92, 1441792
  s_min_u32 s92, s92, s3
  s_add_u32 m0, s43, 2048
  s_nop 0
  buffer_load_dwordx4 v248, s[80:83], s92 offen lds
  buffer_load_dwordx4 v247, s[80:83], s92 offen offset:1024 lds
  s_add_u32 s92, s78, 1179648
  s_sub_u32 s3, s92, 1441792
  s_min_u32 s92, s92, s3
  s_add_u32 m0, s43, 4096
  s_nop 0
  buffer_load_dwordx4 v248, s[80:83], s92 offen lds
  buffer_load_dwordx4 v247, s[80:83], s92 offen offset:1024 lds
  s_add_u32 s92, s78, 1245184
  s_sub_u32 s3, s92, 1441792
  s_min_u32 s92, s92, s3
  s_add_u32 m0, s43, 10240
  s_nop 0
  buffer_load_dwordx4 v248, s[80:83], s92 offen lds
  buffer_load_dwordx4 v247, s[80:83], s92 offen offset:1024 lds
  s_waitcnt vmcnt(11)
  v_cmp_ne_u32 vcc, s42, v249
  s_cbranch_vccnz POLL_9
POLLOK_10:
  s_add_u32 s92, s78, 1310720
  s_sub_u32 s3, s92, 1441792
  s_min_u32 s92, s92, s3
  s_add_u32 m0, s43, 12288
  s_nop 0
  buffer_load_dwordx4 v248, s[80:83], s92 offen lds
  buffer_load_dwordx4 v247, s[80:83], s92 offen offset:1024 lds
  s_add_u32 s92, s78, 1376256
  s_sub_u32 s3, s92, 1441792
  s_min_u32 s92, s92, s3
  s_add_u32 m0, s43, 14336
  s_nop 0
  buffer_load_dwordx4 v248, s[80:83], s92 offen lds
  buffer_load_dwordx4 v247, s[80:83], s92 offen offset:1024 lds
  s_add_u32 s92, s79, 0
  s_and_b32 s92, s92, 7
  s_lshl_b32 s92, s92, 14
  s_add_u32 m0, s43, 16384
  s_nop 0
  buffer_load_dwordx4 v234, s[88:91], s92 offen lds
  buffer_load_dwordx4 v233, s[88:91], s92 offen offset:1024 lds
  ds_read_b64_tr_b16 a[24:25], v242 offset:24576
  ds_read_b64_tr_b16 a[26:27], v242 offset:25600
  ds_read_b64_tr_b16 a[28:29], v235 offset:24576
  ds_read_b64_tr_b16 a[30:31], v235 offset:25600
  s_waitcnt lgkmcnt(0)
  s_add_u32 s92, s79, 1
  s_and_b32 s92, s92, 7
  s_lshl_b32 s92, s92, 14
  s_add_u32 m0, s43, 24576
  s_nop 0
  buffer_load_dwordx4 v234, s[88:91], s92 offen lds
  buffer_load_dwordx4 v233, s[88:91], s92 offen offset:1024 lds
  ds_read_b64_tr_b16 a[32:33], v242 offset:34816
  ds_read_b64_tr_b16 a[34:35], v242 offset:35840
  ds_read_b64_tr_b16 a[36:37], v235 offset:34816
  ds_read_b64_tr_b16 a[38:39], v235 offset:35840
  s_waitcnt lgkmcnt(0)
  s_add_u32 s92, s79, 2
  s_and_b32 s92, s92, 7
  s_lshl_b32 s92, s92, 14
  s_add_u32 m0, s43, 34816
  s_nop 0
  buffer_load_dwordx4 v234, s[88:91], s92 offen lds
  buffer_load_dwordx4 v233, s[88:91], s92 offen offset:1024 lds
  ds_read_b64_tr_b16 a[40:41], v242 offset:36864
  ds_read_b64_tr_b16 a[42:43], v242 offset:37888
  ds_read_b64_tr_b16 a[44:45], v235 offset:36864
  ds_read_b64_tr_b16 a[46:47], v235 offset:37888
  s_waitcnt lgkmcnt(0)
  s_add_u32 s92, s79, 3
  s_and_b32 s92, s92, 7
  s_lshl_b32 s92, s92, 14
  s_add_u32 m0, s43, 36864
  s_nop 0
  buffer_load_dwordx4 v234, s[88:91], s92 offen lds
  buffer_load_dwordx4 v233, s[88:91], s92 offen offset:1024 lds
  ds_read_b64_tr_b16 a[48:49], v242 offset:38912
  ds_read_b64_tr_b16 a[50:51], v242 offset:39936
  ds_read_b64_tr_b16 a[52:53], v235 offset:38912
  ds_read_b64_tr_b16 a[54:55], v235 offset:39936
  s_waitcnt lgkmcnt(0)
  s_add_u32 s92, s79, 4
  s_and_b32 s92, s92, 7
  s_lshl_b32 s92, s92, 14
  s_add_u32 m0, s43, 38912
  s_nop 0
  buffer_load_dwordx4 v234, s[88:91], s92 offen lds
  buffer_load_dwordx4 v233, s[88:91], s92 offen offset:1024 lds
  ds_read_b64_tr_b16 a[56:57], v242 offset:26624
  ds_read_b64_tr_b16 a[58:59], v242 offset:27648
  ds_read_b64_tr_b16 a[60:61], v235 offset:26624
  ds_read_b64_tr_b16 a[62:63], v235 offset:27648
  s_waitcnt lgkmcnt(0)
  s_add_u32 s92, s79, 5
  s_and_b32 s92, s92, 7
  s_lshl_b32 s92, s92, 14
  s_add_u32 m0, s43, 26624
  s_nop 0
  buffer_load_dwordx4 v234, s[88:91], s92 offen lds
  buffer_load_dwordx4 v233, s[88:91], s92 offen offset:1024 lds
  ds_read_b64_tr_b16 a[64:65], v242 offset:28672
  ds_read_b64_tr_b16 a[66:67], v242 offset:29696
  ds_read_b64_tr_b16 a[68:69], v235 offset:28672
  ds_read_b64_tr_b16 a[70:71], v235 offset:29696
  s_waitcnt lgkmcnt(0)
  s_add_u32 s92, s79, 6
  s_and_b32 s92, s92, 7
  s_lshl_b32 s92, s92, 14
  s_add_u32 m0, s43, 28672
  s_nop 0
  buffer_load_dwordx4 v234, s[88:91], s92 offen lds
  buffer_load_dwordx4 v233, s[88:91], s92 offen offset:1024 lds
  ds_read_b64_tr_b16 a[72:73], v242 offset:30720
  ds_read_b64_tr_b16 a[74:75], v242 offset:31744
  ds_read_b64_tr_b16 a[76:77], v235 offset:30720
  ds_read_b64_tr_b16 a[78:79], v235 offset:31744
  s_waitcnt lgkmcnt(0)
  s_add_u32 s92, s79, 7
  s_and_b32 s92, s92, 7
  s_lshl_b32 s92, s92, 14
  s_add_u32 m0, s43, 30720
  s_nop 0
  buffer_load_dwordx4 v234, s[88:91], s92 offen lds
  buffer_load_dwordx4 v233, s[88:91], s92 offen offset:1024 lds
  buffer_load_dword v253, v226, s[36:39], 0 offen sc1
  s_waitcnt vmcnt(29)
  v_lshlrev_b32 v241, 16, v241
  v_lshlrev_b32 v12, 16, v4
  v_and_b32 v13, 0xffff0000, v4
  v_lshlrev_b32 v14, 16, v5
  v_and_b32 v15, 0xffff0000, v5
  v_lshlrev_b32 v16, 16, v6
  v_and_b32 v17, 0xffff0000, v6
  v_lshlrev_b32 v18, 16, v7
  v_and_b32 v19, 0xffff0000, v7
  v_lshlrev_b32 v20, 16, v8
  v_and_b32 v21, 0xffff0000, v8
  v_lshlrev_b32 v22, 16, v9
  v_and_b32 v23, 0xffff0000, v9
  v_lshlrev_b32 v24, 16, v10
  v_and_b32 v25, 0xffff0000, v10
  v_lshlrev_b32 v26, 16, v11
  v_and_b32 v27, 0xffff0000, v11
  v_add_f32 v12, v12, v241
  v_add_f32 v13, v13, v241
  v_add_f32 v14, v14, v241
  v_add_f32 v15, v15, v241
  v_add_f32 v16, v16, v241
  v_add_f32 v17, v17, v241
  v_add_f32 v18, v18, v241
  v_add_f32 v19, v19, v241
  v_add_f32 v20, v20, v241
  v_add_f32 v21, v21, v241
  v_add_f32 v22, v22, v241
  v_add_f32 v23, v23, v241
  v_add_f32 v24, v24, v241
  v_add_f32 v25, v25, v241
  v_add_f32 v26, v26, v241
  v_add_f32 v27, v27, v241
  v_permlane32_swap_b32 v12, v16
  v_permlane32_swap_b32 v13, v17
  v_permlane32_swap_b32 v14, v18
  v_permlane32_swap_b32 v15, v19
  v_permlane32_swap_b32 v20, v24
  v_permlane32_swap_b32 v21, v25
  v_permlane32_swap_b32 v22, v26
  v_permlane32_swap_b32 v23, v27
  s_mov_b32 s12, s20
  s_mov_b32 s13, s21
  s_mov_b32 s14, 0x200000
  s_mov_b32 s15, 0x20000
  s_waitcnt vmcnt(0)
  v_cmp_eq_u32 vcc, -1, v253
  s_cbranch_vccnz POLL_11
POLLOK_12:
  s_add_u32 s57, s77, 0
  s_sub_u32 s3, s57, 360448
  s_min_u32 s57, s57, s3
  buffer_load_dwordx4 v[4:7], v246, s[84:87], s57 offen sc1
  buffer_load_dwordx4 v[8:11], v245, s[84:87], s57 offen sc1
  s_add_u32 s58, s77, 16384
  s_sub_u32 s3, s58, 360448
  s_min_u32 s58, s58, s3
  buffer_load_dwordx4 v[76:79], v246, s[84:87], s58 offen sc1
  buffer_load_dwordx4 v[80:83], v245, s[84:87], s58 offen sc1
  s_add_u32 s59, s77, 32768
  s_sub_u32 s3, s59, 360448
  s_min_u32 s59, s59, s3
  buffer_load_dwordx4 v[84:87], v246, s[84:87], s59 offen sc1
  buffer_load_dwordx4 v[88:91], v245, s[84:87], s59 offen sc1
  s_add_u32 s60, s77, 49152
  s_sub_u32 s3, s60, 360448
  s_min_u32 s60, s60, s3
  buffer_load_dwordx4 v[92:95], v246, s[84:87], s60 offen sc1
  buffer_load_dwordx4 v[96:99], v245, s[84:87], s60 offen sc1
  s_add_u32 s61, s77, 65536
  s_sub_u32 s3, s61, 360448
  s_min_u32 s61, s61, s3
  buffer_load_dwordx4 v[100:103], v246, s[84:87], s61 offen sc1
  buffer_load_dwordx4 v[104:107], v245, s[84:87], s61 offen sc1
  s_add_u32 s62, s77, 81920
  s_sub_u32 s3, s62, 360448
  s_min_u32 s62, s62, s3
  buffer_load_dwordx4 v[108:111], v246, s[84:87], s62 offen sc1
  buffer_load_dwordx4 v[112:115], v245, s[84:87], s62 offen sc1
  s_waitcnt vmcnt(10)
  v_max3_u32 v252, v4, v5, v6
  v_max3_u32 v252, v252, v7, v8
  v_max3_u32 v252, v252, v9, v10
  v_max_u32 v252, v252, v11
  v_cmp_eq_u32 vcc, -1, v252
  s_cbranch_vccnz CHK_13
CHKOK_14:
  v_mfma_f32_32x32x16_bf16 v[60:75], v[8:11], a[4:7], 0
  v_mfma_f32_32x32x16_bf16 v[44:59], v[8:11], a[0:3], 0
  ds_read_b64_tr_b16 a[80:81], v242 offset:32768
  ds_read_b64_tr_b16 a[82:83], v242 offset:33792
  ds_read_b64_tr_b16 a[84:85], v235 offset:32768
  ds_read_b64_tr_b16 a[86:87], v235 offset:33792
  v_mfma_f32_32x32x16_bf16 v[28:43], v[4:7], a[4:7], 0
  s_waitcnt vmcnt(8)
  v_max3_u32 v252, v76, v77, v78
  v_max3_u32 v252, v252, v79, v80
  v_max3_u32 v252, v252, v81, v82
  v_max_u32 v252, v252, v83
  v_cmp_eq_u32 vcc, -1, v252
  v_mfma_f32_32x32x16_bf16 v[12:27], v[4:7], a[0:3], v[12:27]
  s_cbranch_vccnz CHK_15
CHKOK_16:
  v_mfma_f32_32x32x16_bf16 v[60:75], v[80:83], a[12:15], v[60:75]
  s_add_u32 s57, s77, 98304
  s_sub_u32 s3, s57, 360448
  s_min_u32 s57, s57, s3
  buffer_load_dwordx4 v[4:7], v246, s[84:87], s57 offen sc1
  buffer_load_dwordx4 v[8:11], v245, s[84:87], s57 offen sc1
  v_mfma_f32_32x32x16_bf16 v[44:59], v[80:83], a[8:11], v[44:59]
  ds_read_b64_tr_b16 a[0:1], v242 offset:18432
  ds_read_b64_tr_b16 a[2:3], v242 offset:19456
  ds_read_b64_tr_b16 a[4:5], v235 offset:18432
  ds_read_b64_tr_b16 a[6:7], v235 offset:19456
  v_mfma_f32_32x32x16_bf16 v[28:43], v[76:79], a[12:15], v[28:43]
  s_waitcnt vmcnt(8)
  v_max3_u32 v252, v84, v85, v86
  v_max3_u32 v252, v252, v87, v88
  v_max3_u32 v252, v252, v89, v90
  v_max_u32 v252, v252, v91
  v_cmp_eq_u32 vcc, -1, v252
  v_mfma_f32_32x32x16_bf16 v[12:27], v[76:79], a[8:11], v[12:27]
  s_cbranch_vccnz CHK_17
CHKOK_18:
  v_mfma_f32_32x32x16_bf16 v[60:75], v[88:91], a[20:23], v[60:75]
  s_add_u32 s58, s77, 114688
  s_sub_u32 s3, s58, 360448
  s_min_u32 s58, s58, s3
  buffer_load_dwordx4 v[76:79], v246, s[84:87], s58 offen sc1
  buffer_load_dwordx4 v[80:83], v245, s[84:87], s58 offen sc1
  v_mfma_f32_32x32x16_bf16 v[44:59], v[88:91], a[16:19], v[44:59]
  ds_read_b64_tr_b16 a[8:9], v242 offset:20480
  ds_read_b64_tr_b16 a[10:11], v242 offset:21504
  ds_read_b64_tr_b16 a[12:13], v235 offset:20480
  ds_read_b64_tr_b16 a[14:15], v235 offset:21504
  v_mfma_f32_32x32x16_bf16 v[28:43], v[84:87], a[20:23], v[28:43]
  s_waitcnt vmcnt(8)
  v_max3_u32 v252, v92, v93, v94
  v_max3_u32 v252, v252, v95, v96
  v_max3_u32 v252, v252, v97, v98
  v_max_u32 v252, v252, v99
  v_cmp_eq_u32 vcc, -1, v252
  v_mfma_f32_32x32x16_bf16 v[12:27], v[84:87], a[16:19], v[12:27]
  s_cbranch_vccnz CHK_19
CHKOK_20:
  v_mfma_f32_32x32x16_bf16 v[60:75], v[96:99], a[28:31], v[60:75]
  s_add_u32 s59, s77, 131072
  s_sub_u32 s3, s59, 360448
  s_min_u32 s59, s59, s3
  buffer_load_dwordx4 v[84:87], v246, s[84:87], s59 offen sc1
  buffer_load_dwordx4 v[88:91], v245, s[84:87], s59 offen sc1
  v_mfma_f32_32x32x16_bf16 v[44:59], v[96:99], a[24:27], v[44:59]
  ds_read_b64_tr_b16 a[16:17], v242 offset:22528
  ds_read_b64_tr_b16 a[18:19], v242 offset:23552
  ds_read_b64_tr_b16 a[20:21], v235 offset:22528
  ds_read_b64_tr_b16 a[22:23], v235 offset:23552
  v_mfma_f32_32x32x16_bf16 v[28:43], v[92:95], a[28:31], v[28:43]
  s_waitcnt vmcnt(8)
  v_max3_u32 v252, v100, v101, v102
  v_max3_u32 v252, v252, v103, v104
  v_max3_u32 v252, v252, v105, v106
  v_max_u32 v252, v252, v107
  v_cmp_eq_u32 vcc, -1, v252
  v_mfma_f32_32x32x16_bf16 v[12:27], v[92:95], a[24:27], v[12:27]
  s_cbranch_vccnz CHK_21
CHKOK_22:
  v_mfma_f32_32x32x16_bf16 v[60:75], v[104:107], a[36:39], v[60:75]
  s_add_u32 s60, s77, 147456
  s_sub_u32 s3, s60, 360448
  s_min_u32 s60, s60, s3
  buffer_load_dwordx4 v[92:95], v246, s[84:87], s60 offen sc1
  buffer_load_dwordx4 v[96:99], v245, s[84:87], s60 offen sc1
  v_mfma_f32_32x32x16_bf16 v[44:59], v[104:107], a[32:35], v[44:59]
  ds_read_b64_tr_b16 a[24:25], v242 offset:6144
  ds_read_b64_tr_b16 a[26:27], v242 offset:7168
  ds_read_b64_tr_b16 a[28:29], v235 offset:6144
  ds_read_b64_tr_b16 a[30:31], v235 offset:7168
  v_mfma_f32_32x32x16_bf16 v[28:43], v[100:103], a[36:39], v[28:43]
  s_waitcnt vmcnt(8)
  v_max3_u32 v252, v108, v109, v110
  v_max3_u32 v252, v252, v111, v112
  v_max3_u32 v252, v252, v113, v114
  v_max_u32 v252, v252, v115
  v_cmp_eq_u32 vcc, -1, v252
  v_mfma_f32_32x32x16_bf16 v[12:27], v[100:103], a[32:35], v[12:27]
  s_cbranch_vccnz CHK_23
CHKOK_24:
  v_mfma_f32_32x32x16_bf16 v[60:75], v[112:115], a[44:47], v[60:75]
  s_add_u32 s61, s77, 163840
  s_sub_u32 s3, s61, 360448
  s_min_u32 s61, s61, s3
  buffer_load_dwordx4 v[100:103], v246, s[84:87], s61 offen sc1
  buffer_load_dwordx4 v[104:107], v245, s[84:87], s61 offen sc1
  v_mfma_f32_32x32x16_bf16 v[44:59], v[112:115], a[40:43], v[44:59]
  ds_read_b64_tr_b16 a[32:33], v242 offset:8192
  ds_read_b64_tr_b16 a[34:35], v242 offset:9216
  ds_read_b64_tr_b16 a[36:37], v235 offset:8192
  ds_read_b64_tr_b16 a[38:39], v235 offset:9216
  v_mfma_f32_32x32x16_bf16 v[28:43], v[108:111], a[44:47], v[28:43]
  s_waitcnt vmcnt(8)
  v_max3_u32 v252, v4, v5, v6
  v_max3_u32 v252, v252, v7, v8
  v_max3_u32 v252, v252, v9, v10
  v_max_u32 v252, v252, v11
  v_cmp_eq_u32 vcc, -1, v252
  v_mfma_f32_32x32x16_bf16 v[12:27], v[108:111], a[40:43], v[12:27]
  s_cbranch_vccnz CHK_25
CHKOK_26:
  v_mfma_f32_32x32x16_bf16 v[60:75], v[8:11], a[52:55], v[60:75]
  s_add_u32 s62, s77, 180224
  s_sub_u32 s3, s62, 360448
  s_min_u32 s62, s62, s3
  buffer_load_dwordx4 v[108:111], v246, s[84:87], s62 offen sc1
  buffer_load_dwordx4 v[112:115], v245, s[84:87], s62 offen sc1
  v_mfma_f32_32x32x16_bf16 v[44:59], v[8:11], a[48:51], v[44:59]
  ds_read_b64_tr_b16 a[40:41], v242 offset:0
  ds_read_b64_tr_b16 a[42:43], v242 offset:1024
  ds_read_b64_tr_b16 a[44:45], v235 offset:0
  ds_read_b64_tr_b16 a[46:47], v235 offset:1024
  v_mfma_f32_32x32x16_bf16 v[28:43], v[4:7], a[52:55], v[28:43]
  s_waitcnt vmcnt(8)
  v_max3_u32 v252, v76, v77, v78
  v_max3_u32 v252, v252, v79, v80
  v_max3_u32 v252, v252, v81, v82
  v_max_u32 v252, v252, v83
  v_cmp_eq_u32 vcc, -1, v252
  v_mfma_f32_32x32x16_bf16 v[12:27], v[4:7], a[48:51], v[12:27]
  s_cbranch_vccnz CHK_27
CHKOK_28:
  v_mfma_f32_32x32x16_bf16 v[60:75], v[80:83], a[60:63], v[60:75]
  s_add_u32 s57, s77, 196608
  s_sub_u32 s3, s57, 360448
  s_min_u32 s57, s57, s3
  buffer_load_dwordx4 v[4:7], v246, s[84:87], s57 offen sc1
  buffer_load_dwordx4 v[8:11], v245, s[84:87], s57 offen sc1
  v_mfma_f32_32x32x16_bf16 v[44:59], v[80:83], a[56:59], v[44:59]
  ds_read_b64_tr_b16 a[48:49], v242 offset:2048
  ds_read_b64_tr_b16 a[50:51], v242 offset:3072
  ds_read_b64_tr_b16 a[52:53], v235 offset:2048
  ds_read_b64_tr_b16 a[54:55], v235 offset:3072
  v_mfma_f32_32x32x16_bf16 v[28:43], v[76:79], a[60:63], v[28:43]
  s_waitcnt vmcnt(8)
  v_max3_u32 v252, v84, v85, v86
  v_max3_u32 v252, v252, v87, v88
  v_max3_u32 v252, v252, v89, v90
  v_max_u32 v252, v252, v91
  v_cmp_eq_u32 vcc, -1, v252
  v_mfma_f32_32x32x16_bf16 v[12:27], v[76:79], a[56:59], v[12:27]
  s_cbranch_vccnz CHK_29
CHKOK_30:
  v_mfma_f32_32x32x16_bf16 v[60:75], v[88:91], a[68:71], v[60:75]
  s_add_u32 s58, s77, 212992
  s_sub_u32 s3, s58, 360448
  s_min_u32 s58, s58, s3
  buffer_load_dwordx4 v[76:79], v246, s[84:87], s58 offen sc1
  buffer_load_dwordx4 v[80:83], v245, s[84:87], s58 offen sc1
  v_mfma_f32_32x32x16_bf16 v[44:59], v[88:91], a[64:67], v[44:59]
  ds_read_b64_tr_b16 a[56:57], v242 offset:4096
  ds_read_b64_tr_b16 a[58:59], v242 offset:5120
  ds_read_b64_tr_b16 a[60:61], v235 offset:4096
  ds_read_b64_tr_b16 a[62:63], v235 offset:5120
  v_mfma_f32_32x32x16_bf16 v[28:43], v[84:87], a[68:71], v[28:43]
  s_waitcnt vmcnt(8)
  v_max3_u32 v252, v92, v93, v94
  v_max3_u32 v252, v252, v95, v96
  v_max3_u32 v252, v252, v97, v98
  v_max_u32 v252, v252, v99
  v_cmp_eq_u32 vcc, -1, v252
  v_mfma_f32_32x32x16_bf16 v[12:27], v[84:87], a[64:67], v[12:27]
  s_cbranch_vccnz CHK_31
CHKOK_32:
  v_mfma_f32_32x32x16_bf16 v[60:75], v[96:99], a[76:79], v[60:75]
  s_add_u32 s59, s77, 229376
  s_sub_u32 s3, s59, 360448
  s_min_u32 s59, s59, s3
  buffer_load_dwordx4 v[84:87], v246, s[84:87], s59 offen sc1
  buffer_load_dwordx4 v[88:91], v245, s[84:87], s59 offen sc1
  v_mfma_f32_32x32x16_bf16 v[44:59], v[96:99], a[72:75], v[44:59]
  ds_read_b64_tr_b16 a[64:65], v242 offset:10240
  ds_read_b64_tr_b16 a[66:67], v242 offset:11264
  ds_read_b64_tr_b16 a[68:69], v235 offset:10240
  ds_read_b64_tr_b16 a[70:71], v235 offset:11264
  v_mfma_f32_32x32x16_bf16 v[28:43], v[92:95], a[76:79], v[28:43]
  s_waitcnt vmcnt(8)
  v_max3_u32 v252, v100, v101, v102
  v_max3_u32 v252, v252, v103, v104
  v_max3_u32 v252, v252, v105, v106
  v_max_u32 v252, v252, v107
  v_cmp_eq_u32 vcc, -1, v252
  v_mfma_f32_32x32x16_bf16 v[12:27], v[92:95], a[72:75], v[12:27]
  s_cbranch_vccnz CHK_33
CHKOK_34:
  s_waitcnt lgkmcnt(15)
  v_mfma_f32_32x32x16_bf16 v[60:75], v[104:107], a[84:87], v[60:75]
  s_add_u32 s60, s77, 245760
  s_sub_u32 s3, s60, 360448
  s_min_u32 s60, s60, s3
  buffer_load_dwordx4 v[92:95], v246, s[84:87], s60 offen sc1
  buffer_load_dwordx4 v[96:99], v245, s[84:87], s60 offen sc1
  v_mfma_f32_32x32x16_bf16 v[44:59], v[104:107], a[80:83], v[44:59]
  ds_read_b64_tr_b16 a[72:73], v242 offset:12288
  ds_read_b64_tr_b16 a[74:75], v242 offset:13312
  ds_read_b64_tr_b16 a[76:77], v235 offset:12288
  ds_read_b64_tr_b16 a[78:79], v235 offset:13312
  v_mfma_f32_32x32x16_bf16 v[28:43], v[100:103], a[84:87], v[28:43]
  s_waitcnt vmcnt(8)
  v_max3_u32 v252, v108, v109, v110
  v_max3_u32 v252, v252, v111, v112
  v_max3_u32 v252, v252, v113, v114
  v_max_u32 v252, v252, v115
  v_cmp_eq_u32 vcc, -1, v252
  v_mfma_f32_32x32x16_bf16 v[12:27], v[100:103], a[80:83], v[12:27]
  s_cbranch_vccnz CHK_35
CHKOK_36:
  v_mfma_f32_32x32x16_bf16 v[60:75], v[112:115], a[4:7], v[60:75]
  s_add_u32 s61, s77, 262144
  s_sub_u32 s3, s61, 360448
  s_min_u32 s61, s61, s3
  buffer_load_dwordx4 v[100:103], v246, s[84:87], s61 offen sc1
  buffer_load_dwordx4 v[104:107], v245, s[84:87], s61 offen sc1
  v_mfma_f32_32x32x16_bf16 v[44:59], v[112:115], a[0:3], v[44:59]
  ds_read_b64_tr_b16 a[80:81], v242 offset:14336
  ds_read_b64_tr_b16 a[82:83], v242 offset:15360
  ds_read_b64_tr_b16 a[84:85], v235 offset:14336
  ds_read_b64_tr_b16 a[86:87], v235 offset:15360
  v_mfma_f32_32x32x16_bf16 v[28:43], v[108:111], a[4:7], v[28:43]
  s_waitcnt vmcnt(8)
  v_max3_u32 v252, v4, v5, v6
  v_max3_u32 v252, v252, v7, v8
  v_max3_u32 v252, v252, v9, v10
  v_max_u32 v252, v252, v11
  v_cmp_eq_u32 vcc, -1, v252
  v_mfma_f32_32x32x16_bf16 v[12:27], v[108:111], a[0:3], v[12:27]
  s_cbranch_vccnz CHK_37
CHKOK_38:
  v_mfma_f32_32x32x16_bf16 v[60:75], v[8:11], a[12:15], v[60:75]
  s_add_u32 s62, s77, 278528
  s_sub_u32 s3, s62, 360448
  s_min_u32 s62, s62, s3
  buffer_load_dwordx4 v[108:111], v246, s[84:87], s62 offen sc1
  buffer_load_dwordx4 v[112:115], v245, s[84:87], s62 offen sc1
  buffer_load_dword v253, v229, s[32:35], 0 offen sc1
  v_mfma_f32_32x32x16_bf16 v[44:59], v[8:11], a[8:11], v[44:59]
  ds_read_b64_tr_b16 a[0:1], v232 offset:16384
  ds_read_b64_tr_b16 a[2:3], v232 offset:17408
  ds_read_b64_tr_b16 a[4:5], v231 offset:16384
  ds_read_b64_tr_b16 a[6:7], v231 offset:17408
  v_mfma_f32_32x32x16_bf16 v[28:43], v[4:7], a[12:15], v[28:43]
  s_waitcnt vmcnt(9)
  v_max3_u32 v252, v76, v77, v78
  v_max3_u32 v252, v252, v79, v80
  v_max3_u32 v252, v252, v81, v82
  v_max_u32 v252, v252, v83
  v_cmp_eq_u32 vcc, -1, v252
  v_mfma_f32_32x32x16_bf16 v[12:27], v[4:7], a[8:11], v[12:27]
  s_cbranch_vccnz CHK_39
CHKOK_40:
  v_mfma_f32_32x32x16_bf16 v[60:75], v[80:83], a[20:23], v[60:75]
  s_add_u32 s57, s77, 294912
  s_sub_u32 s3, s57, 360448
  s_min_u32 s57, s57, s3
  buffer_load_dwordx4 v[4:7], v246, s[84:87], s57 offen sc1
  buffer_load_dwordx4 v[8:11], v245, s[84:87], s57 offen sc1
  v_mfma_f32_32x32x16_bf16 v[44:59], v[80:83], a[16:19], v[44:59]
  ds_read_b64_tr_b16 a[8:9], v232 offset:24576
  ds_read_b64_tr_b16 a[10:11], v232 offset:25600
  ds_read_b64_tr_b16 a[12:13], v231 offset:24576
  ds_read_b64_tr_b16 a[14:15], v231 offset:25600
  v_mfma_f32_32x32x16_bf16 v[28:43], v[76:79], a[20:23], v[28:43]
  s_waitcnt vmcnt(9)
  v_max3_u32 v252, v84, v85, v86
  v_max3_u32 v252, v252, v87, v88
  v_max3_u32 v252, v252, v89, v90
  v_max_u32 v252, v252, v91
  v_cmp_eq_u32 vcc, -1, v252
  v_mfma_f32_32x32x16_bf16 v[12:27], v[76:79], a[16:19], v[12:27]
  s_cbranch_vccnz CHK_41
CHKOK_42:
  v_mfma_f32_32x32x16_bf16 v[60:75], v[88:91], a[28:31], v[60:75]
  s_add_u32 s58, s77, 311296
  s_sub_u32 s3, s58, 360448
  s_min_u32 s58, s58, s3
  buffer_load_dwordx4 v[76:79], v246, s[84:87], s58 offen sc1
  buffer_load_dwordx4 v[80:83], v245, s[84:87], s58 offen sc1
  v_mfma_f32_32x32x16_bf16 v[44:59], v[88:91], a[24:27], v[44:59]
  ds_read_b64_tr_b16 a[16:17], v232 offset:34816
  ds_read_b64_tr_b16 a[18:19], v232 offset:35840
  ds_read_b64_tr_b16 a[20:21], v231 offset:34816
  ds_read_b64_tr_b16 a[22:23], v231 offset:35840
  v_mfma_f32_32x32x16_bf16 v[28:43], v[84:87], a[28:31], v[28:43]
  s_waitcnt vmcnt(9)
  v_max3_u32 v252, v92, v93, v94
  v_max3_u32 v252, v252, v95, v96
  v_max3_u32 v252, v252, v97, v98
  v_max_u32 v252, v252, v99
  v_cmp_eq_u32 vcc, -1, v252
  v_mfma_f32_32x32x16_bf16 v[12:27], v[84:87], a[24:27], v[12:27]
  s_cbranch_vccnz CHK_43
CHKOK_44:
  v_mfma_f32_32x32x16_bf16 v[60:75], v[96:99], a[36:39], v[60:75]
  s_add_u32 s59, s77, 327680
  s_sub_u32 s3, s59, 360448
  s_min_u32 s59, s59, s3
  buffer_load_dwordx4 v[84:87], v246, s[84:87], s59 offen sc1
  buffer_load_dwordx4 v[88:91], v245, s[84:87], s59 offen sc1
  v_mfma_f32_32x32x16_bf16 v[44:59], v[96:99], a[32:35], v[44:59]
  ds_read_b64_tr_b16 a[24:25], v232 offset:36864
  ds_read_b64_tr_b16 a[26:27], v232 offset:37888
  ds_read_b64_tr_b16 a[28:29], v231 offset:36864
  ds_read_b64_tr_b16 a[30:31], v231 offset:37888
  v_mfma_f32_32x32x16_bf16 v[28:43], v[92:95], a[36:39], v[28:43]
  s_waitcnt vmcnt(9)
  v_max3_u32 v252, v100, v101, v102
  v_max3_u32 v252, v252, v103, v104
  v_max3_u32 v252, v252, v105, v106
  v_max_u32 v252, v252, v107
  v_cmp_eq_u32 vcc, -1, v252
  v_mfma_f32_32x32x16_bf16 v[12:27], v[92:95], a[32:35], v[12:27]
  s_cbranch_vccnz CHK_45
CHKOK_46:
  s_waitcnt lgkmcnt(15)
  v_mfma_f32_32x32x16_bf16 v[60:75], v[104:107], a[44:47], v[60:75]
  s_add_u32 s60, s77, 344064
  s_sub_u32 s3, s60, 360448
  s_min_u32 s60, s60, s3
  buffer_load_dwordx4 v[92:95], v246, s[84:87], s60 offen sc1
  buffer_load_dwordx4 v[96:99], v245, s[84:87], s60 offen sc1
  v_mfma_f32_32x32x16_bf16 v[44:59], v[104:107], a[40:43], v[44:59]
  ds_read_b64_tr_b16 a[32:33], v232 offset:38912
  ds_read_b64_tr_b16 a[34:35], v232 offset:39936
  ds_read_b64_tr_b16 a[36:37], v231 offset:38912
  ds_read_b64_tr_b16 a[38:39], v231 offset:39936
  v_mfma_f32_32x32x16_bf16 v[28:43], v[100:103], a[44:47], v[28:43]
  s_waitcnt vmcnt(9)
  v_max3_u32 v252, v108, v109, v110
  v_max3_u32 v252, v252, v111, v112
  v_max3_u32 v252, v252, v113, v114
  v_max_u32 v252, v252, v115
  v_cmp_eq_u32 vcc, -1, v252
  v_mfma_f32_32x32x16_bf16 v[12:27], v[100:103], a[40:43], v[12:27]
  s_cbranch_vccnz CHK_47
CHKOK_48:
  v_mfma_f32_32x32x16_bf16 v[60:75], v[112:115], a[52:55], v[60:75]
  s_waitcnt vmcnt(8)
  v_cmp_ne_u32 vcc, s42, v253
  s_cbranch_vccnz POLL_51
POLLOK_52:
  s_add_u32 s61, s79, 0
  s_and_b32 s61, s61, 7
  s_lshl_b32 s61, s61, 16
  buffer_load_dwordx4 v[100:103], v228, s[32:35], s61 offen sc1
  buffer_load_dwordx4 v[104:107], v227, s[32:35], s61 offen sc1
  v_mfma_f32_32x32x16_bf16 v[44:59], v[112:115], a[48:51], v[44:59]
  ds_read_b64_tr_b16 a[40:41], v232 offset:26624
  ds_read_b64_tr_b16 a[42:43], v232 offset:27648
  ds_read_b64_tr_b16 a[44:45], v231 offset:26624
  ds_read_b64_tr_b16 a[46:47], v231 offset:27648
  v_mfma_f32_32x32x16_bf16 v[28:43], v[108:111], a[52:55], v[28:43]
  s_waitcnt vmcnt(8)
  v_max3_u32 v252, v4, v5, v6
  v_max3_u32 v252, v252, v7, v8
  v_max3_u32 v252, v252, v9, v10
  v_max_u32 v252, v252, v11
  v_cmp_eq_u32 vcc, -1, v252
  v_mfma_f32_32x32x16_bf16 v[12:27], v[108:111], a[48:51], v[12:27]
  s_cbranch_vccnz CHK_49
CHKOK_50:
  v_mfma_f32_32x32x16_bf16 v[60:75], v[8:11], a[60:63], v[60:75]
  s_add_u32 s62, s79, 1
  s_and_b32 s62, s62, 7
  s_lshl_b32 s62, s62, 16
  buffer_load_dwordx4 v[108:111], v228, s[32:35], s62 offen sc1
  buffer_load_dwordx4 v[112:115], v227, s[32:35], s62 offen sc1
  v_mfma_f32_32x32x16_bf16 v[44:59], v[8:11], a[56:59], v[44:59]
  ds_read_b64_tr_b16 a[48:49], v232 offset:28672
  ds_read_b64_tr_b16 a[50:51], v232 offset:29696
  ds_read_b64_tr_b16 a[52:53], v231 offset:28672
  ds_read_b64_tr_b16 a[54:55], v231 offset:29696
  v_mfma_f32_32x32x16_bf16 v[28:43], v[4:7], a[60:63], v[28:43]
  s_waitcnt vmcnt(8)
  v_max3_u32 v252, v76, v77, v78
  v_max3_u32 v252, v252, v79, v80
  v_max3_u32 v252, v252, v81, v82
  v_max_u32 v252, v252, v83
  v_cmp_eq_u32 vcc, -1, v252
  v_mfma_f32_32x32x16_bf16 v[12:27], v[4:7], a[56:59], v[12:27]
  s_cbranch_vccnz CHK_53
CHKOK_54:
  v_mfma_f32_32x32x16_bf16 v[60:75], v[80:83], a[68:71], v[60:75]
  s_add_u32 s57, s79, 2
  s_and_b32 s57, s57, 7
  s_lshl_b32 s57, s57, 16
  buffer_load_dwordx4 v[4:7], v228, s[32:35], s57 offen sc1
  buffer_load_dwordx4 v[8:11], v227, s[32:35], s57 offen sc1
  v_mfma_f32_32x32x16_bf16 v[44:59], v[80:83], a[64:67], v[44:59]
  ds_read_b64_tr_b16 a[56:57], v232 offset:30720
  ds_read_b64_tr_b16 a[58:59], v232 offset:31744
  ds_read_b64_tr_b16 a[60:61], v231 offset:30720
  ds_read_b64_tr_b16 a[62:63], v231 offset:31744
  v_mfma_f32_32x32x16_bf16 v[28:43], v[76:79], a[68:71], v[28:43]
  s_waitcnt vmcnt(8)
  v_max3_u32 v252, v84, v85, v86
  v_max3_u32 v252, v252, v87, v88
  v_max3_u32 v252, v252, v89, v90
  v_max_u32 v252, v252, v91
  v_cmp_eq_u32 vcc, -1, v252
  v_mfma_f32_32x32x16_bf16 v[12:27], v[76:79], a[64:67], v[12:27]
  s_cbranch_vccnz CHK_55
CHKOK_56:
  v_mfma_f32_32x32x16_bf16 v[60:75], v[88:91], a[76:79], v[60:75]
  s_add_u32 s58, s79, 3
  s_and_b32 s58, s58, 7
  s_lshl_b32 s58, s58, 16
  buffer_load_dwordx4 v[76:79], v228, s[32:35], s58 offen sc1
  buffer_load_dwordx4 v[80:83], v227, s[32:35], s58 offen sc1
  v_mfma_f32_32x32x16_bf16 v[44:59], v[88:91], a[72:75], v[44:59]
  v_mfma_f32_32x32x16_bf16 v[28:43], v[84:87], a[76:79], v[28:43]
  s_waitcnt vmcnt(8)
  v_max3_u32 v252, v92, v93, v94
  v_max3_u32 v252, v252, v95, v96
  v_max3_u32 v252, v252, v97, v98
  v_max_u32 v252, v252, v99
  v_cmp_eq_u32 vcc, -1, v252
  v_mfma_f32_32x32x16_bf16 v[12:27], v[84:87], a[72:75], v[12:27]
  s_cbranch_vccnz CHK_57
CHKOK_58:
  v_mfma_f32_32x32x16_bf16 v[60:75], v[96:99], a[84:87], v[60:75]
  s_add_u32 s59, s79, 4
  s_and_b32 s59, s59, 7
  s_lshl_b32 s59, s59, 16
  buffer_load_dwordx4 v[84:87], v228, s[32:35], s59 offen sc1
  buffer_load_dwordx4 v[88:91], v227, s[32:35], s59 offen sc1
  v_mfma_f32_32x32x16_bf16 v[44:59], v[96:99], a[80:83], v[44:59]
  v_mfma_f32_32x32x16_bf16 v[28:43], v[92:95], a[84:87], v[28:43]
  s_waitcnt vmcnt(8)
  v_mfma_f32_32x32x16_bf16 v[12:27], v[92:95], a[80:83], v[12:27]
  s_waitcnt lgkmcnt(15)
  v_mfma_f32_32x32x16_bf16 v[60:75], a[4:7], v[104:107], v[60:75]
  s_add_u32 s60, s79, 5
  s_and_b32 s60, s60, 7
  s_lshl_b32 s60, s60, 16
  buffer_load_dwordx4 v[92:95], v228, s[32:35], s60 offen sc1
  buffer_load_dwordx4 v[96:99], v227, s[32:35], s60 offen sc1
  v_mfma_f32_32x32x16_bf16 v[44:59], a[4:7], v[100:103], v[44:59]
  v_mfma_f32_32x32x16_bf16 v[28:43], a[0:3], v[104:107], v[28:43]
  s_waitcnt vmcnt(8)
  v_mfma_f32_32x32x16_bf16 v[12:27], a[0:3], v[100:103], v[12:27]
  v_mfma_f32_32x32x16_bf16 v[60:75], a[12:15], v[112:115], v[60:75]
  s_add_u32 s61, s79, 6
  s_and_b32 s61, s61, 7
  s_lshl_b32 s61, s61, 16
  buffer_load_dwordx4 v[100:103], v228, s[32:35], s61 offen sc1
  buffer_load_dwordx4 v[104:107], v227, s[32:35], s61 offen sc1
  v_mfma_f32_32x32x16_bf16 v[44:59], a[12:15], v[108:111], v[44:59]
  v_mfma_f32_32x32x16_bf16 v[28:43], a[8:11], v[112:115], v[28:43]
  s_waitcnt vmcnt(8)
  v_mfma_f32_32x32x16_bf16 v[12:27], a[8:11], v[108:111], v[12:27]
  v_mfma_f32_32x32x16_bf16 v[60:75], a[20:23], v[8:11], v[60:75]
  s_add_u32 s62, s79, 7
  s_and_b32 s62, s62, 7
  s_lshl_b32 s62, s62, 16
  buffer_load_dwordx4 v[108:111], v228, s[32:35], s62 offen sc1
  buffer_load_dwordx4 v[112:115], v227, s[32:35], s62 offen sc1
  v_mfma_f32_32x32x16_bf16 v[44:59], a[20:23], v[4:7], v[44:59]
  v_mfma_f32_32x32x16_bf16 v[28:43], a[16:19], v[8:11], v[28:43]
  s_waitcnt vmcnt(8)
  v_mfma_f32_32x32x16_bf16 v[12:27], a[16:19], v[4:7], v[12:27]
  v_mfma_f32_32x32x16_bf16 v[60:75], a[28:31], v[80:83], v[60:75]
  v_mfma_f32_32x32x16_bf16 v[44:59], a[28:31], v[76:79], v[44:59]
  v_mfma_f32_32x32x16_bf16 v[28:43], a[24:27], v[80:83], v[28:43]
  s_waitcnt vmcnt(6)
  v_mfma_f32_32x32x16_bf16 v[12:27], a[24:27], v[76:79], v[12:27]
  s_waitcnt lgkmcnt(12)
  v_mfma_f32_32x32x16_bf16 v[60:75], a[36:39], v[88:91], v[60:75]
  v_mfma_f32_32x32x16_bf16 v[44:59], a[36:39], v[84:87], v[44:59]
  v_mfma_f32_32x32x16_bf16 v[28:43], a[32:35], v[88:91], v[28:43]
  s_waitcnt vmcnt(4)
  v_mfma_f32_32x32x16_bf16 v[12:27], a[32:35], v[84:87], v[12:27]
  s_waitcnt lgkmcnt(8)
  v_mfma_f32_32x32x16_bf16 v[60:75], a[44:47], v[96:99], v[60:75]
  v_mfma_f32_32x32x16_bf16 v[44:59], a[44:47], v[92:95], v[44:59]
  v_mfma_f32_32x32x16_bf16 v[28:43], a[40:43], v[96:99], v[28:43]
  s_waitcnt vmcnt(2)
  v_mfma_f32_32x32x16_bf16 v[12:27], a[40:43], v[92:95], v[12:27]
  s_waitcnt lgkmcnt(4)
  v_mfma_f32_32x32x16_bf16 v[60:75], a[52:55], v[104:107], v[60:75]
  v_mfma_f32_32x32x16_bf16 v[44:59], a[52:55], v[100:103], v[44:59]
  v_mfma_f32_32x32x16_bf16 v[28:43], a[48:51], v[104:107], v[28:43]
  s_waitcnt vmcnt(0)
  v_mfma_f32_32x32x16_bf16 v[12:27], a[48:51], v[100:103], v[12:27]
  s_waitcnt lgkmcnt(0)
  v_mfma_f32_32x32x16_bf16 v[60:75], a[60:63], v[112:115], v[60:75]
  v_mfma_f32_32x32x16_bf16 v[44:59], a[60:63], v[108:111], v[44:59]
  v_mfma_f32_32x32x16_bf16 v[28:43], a[56:59], v[112:115], v[28:43]
  v_mfma_f32_32x32x16_bf16 v[12:27], a[56:59], v[108:111], v[12:27]
  v_add_u32 v253, s43, v254
  s_xor_b32 s44, s26, 1
  s_mul_i32 s44, s44, 40960
  v_add_u32 v251, s44, v254
  s_xor_b32 s44, s26, 2
  s_mul_i32 s44, s44, 40960
  v_add_u32 v250, s44, v254
  s_xor_b32 s44, s26, 3
  s_mul_i32 s44, s44, 40960
  v_add_u32 v249, s44, v254
  ds_write_b128 v253, v[44:47] offset:18432
  ds_write_b128 v253, v[48:51] offset:19456
  ds_write_b128 v253, v[52:55] offset:20480
  ds_write_b128 v253, v[56:59] offset:21504
  ds_write_b128 v253, v[28:31] offset:22528
  ds_write_b128 v253, v[32:35] offset:23552
  ds_write_b128 v253, v[36:39] offset:24576
  ds_write_b128 v253, v[40:43] offset:25600
  ds_write_b128 v253, v[60:63] offset:26624
  ds_write_b128 v253, v[64:67] offset:27648
  ds_write_b128 v253, v[68:71] offset:28672
  ds_write_b128 v253, v[72:75] offset:29696
  s_waitcnt lgkmcnt(0)
  s_barrier
  ds_read_b128 v[44:47], v251 offset:18432
  ds_read_b128 v[48:51], v251 offset:19456
  ds_read_b128 v[52:55], v251 offset:20480
  ds_read_b128 v[56:59], v251 offset:21504
  ds_read_b128 v[28:31], v250 offset:22528
  ds_read_b128 v[32:35], v250 offset:23552
  ds_read_b128 v[36:39], v250 offset:24576
  ds_read_b128 v[40:43], v250 offset:25600
  ds_read_b128 v[60:63], v249 offset:26624
  ds_read_b128 v[64:67], v249 offset:27648
  ds_read_b128 v[68:71], v249 offset:28672
  ds_read_b128 v[72:75], v249 offset:29696
  s_waitcnt lgkmcnt(8)
  v_pk_add_f32 v[12:13], v[12:13], v[44:45]
  v_pk_add_f32 v[14:15], v[14:15], v[46:47]
  v_pk_add_f32 v[16:17], v[16:17], v[48:49]
  v_pk_add_f32 v[18:19], v[18:19], v[50:51]
  v_pk_add_f32 v[20:21], v[20:21], v[52:53]
  v_pk_add_f32 v[22:23], v[22:23], v[54:55]
  v_pk_add_f32 v[24:25], v[24:25], v[56:57]
  v_pk_add_f32 v[26:27], v[26:27], v[58:59]
  s_waitcnt lgkmcnt(4)
  v_pk_add_f32 v[12:13], v[12:13], v[28:29]
  v_pk_add_f32 v[14:15], v[14:15], v[30:31]
  v_pk_add_f32 v[16:17], v[16:17], v[32:33]
  v_pk_add_f32 v[18:19], v[18:19], v[34:35]
  v_pk_add_f32 v[20:21], v[20:21], v[36:37]
  v_pk_add_f32 v[22:23], v[22:23], v[38:39]
  v_pk_add_f32 v[24:25], v[24:25], v[40:41]
  v_pk_add_f32 v[26:27], v[26:27], v[42:43]
  s_waitcnt lgkmcnt(0)
  v_pk_add_f32 v[12:13], v[12:13], v[60:61]
  v_pk_add_f32 v[14:15], v[14:15], v[62:63]
  v_pk_add_f32 v[16:17], v[16:17], v[64:65]
  v_pk_add_f32 v[18:19], v[18:19], v[66:67]
  v_pk_add_f32 v[20:21], v[20:21], v[68:69]
  v_pk_add_f32 v[22:23], v[22:23], v[70:71]
  v_pk_add_f32 v[24:25], v[24:25], v[72:73]
  v_pk_add_f32 v[26:27], v[26:27], v[74:75]
  v_cvt_pk_bf16_f32 v12, v12, v13
  v_cvt_pk_bf16_f32 v13, v14, v15
  v_cvt_pk_bf16_f32 v14, v16, v17
  v_cvt_pk_bf16_f32 v15, v18, v19
  v_cvt_pk_bf16_f32 v20, v20, v21
  v_cvt_pk_bf16_f32 v21, v22, v23
  v_cvt_pk_bf16_f32 v22, v24, v25
  v_cvt_pk_bf16_f32 v23, v26, v27
  v_permlane32_swap_b32 v12, v14
  v_permlane32_swap_b32 v13, v15
  v_permlane32_swap_b32 v20, v22
  v_permlane32_swap_b32 v21, v23
  buffer_store_dwordx4 v[12:15], v243, s[12:15], s56 offen offset:0
  buffer_store_dwordx4 v[20:23], v243, s[12:15], s56 offen offset:32
  s_endpgm
QBODY:
  s_mov_b32 s32, s24
  s_mov_b32 s33, s25
  s_mov_b32 s34, 0xb00000
  s_mov_b32 s35, 0x20000
  s_add_u32 s36, s24, 0x200000
  s_addc_u32 s37, s25, 0
  s_mov_b32 s38, 0x158000
  s_mov_b32 s39, 0x20000
  v_lshrrev_b32 v241, 5, v255
  v_and_b32 v243, 31, v255
  v_lshlrev_b32 v243, 4, v243
  v_lshl_add_u32 v243, v241, 13, v243
  s_and_b32 s44, s26, 1
  s_lshl_b32 s44, s44, 9
  v_add_u32 v243, s44, v243
  v_xor_b32 v242, 512, v243
  s_mov_b32 s28, s4
  s_mov_b32 s29, s5
  s_mov_b32 s30, 0x200000
  s_mov_b32 s31, 0x20000
  s_and_b32 s58, s26, 1
  s_lshr_b32 s59, s26, 1
  v_and_b32 v245, 31, v255
  v_lshlrev_b32 v244, 7, v245
  s_mul_i32 s44, s58, 81920
  v_add_u32 v244, s44, v244
  v_bfe_u32 v245, v255, 1, 3
  v_lshrrev_b32 v233, 5, v255
  v_xor_b32 v245, v245, v233
  s_lshl_b32 s44, s58, 1
  v_xor_b32 v245, s44, v245
  v_xor_b32 v241, 0, v245
  v_lshl_add_u32 v241, v241, 4, v244
  v_add_u32 v240, 40960, v241
  v_xor_b32 v239, 2, v245
  v_lshl_add_u32 v239, v239, 4, v244
  v_add_u32 v238, 40960, v239
  v_xor_b32 v237, 4, v245
  v_lshl_add_u32 v237, v237, 4, v244
  v_add_u32 v236, 40960, v237
  v_xor_b32 v235, 6, v245
  v_lshl_add_u32 v235, v235, 4, v244
  v_add_u32 v234, 40960, v235
  v_lshlrev_b32 v233, 10, v233
  v_bfe_u32 v245, v255, 2, 2
  v_lshl_add_u32 v233, v245, 7, v233
  v_bfe_u32 v245, v255, 4, 1
  v_lshl_add_u32 v233, v245, 5, v233
  v_xor_b32 v245, v245, v255
  v_and_b32 v245, 1, v245
  v_cmp_eq_u32 vcc, 0, v245
  v_mov_b32 v244, 0x3f803f80
  s_nop 0
  v_cndmask_b32 v16, 0, v244, vcc
  v_cndmask_b32 v17, 0, v244, vcc
  v_cndmask_b32 v18, 0, v244, vcc
  v_cndmask_b32 v19, 0, v244, vcc
  v_and_b32 v245, 3, v255
  v_lshl_add_u32 v233, v245, 3, v233
  v_bfe_u32 v245, v255, 3, 1
  v_xor_b32 v245, s59, v245
  v_lshl_add_u32 v233, v245, 6, v233
  s_mul_i32 s44, s58, 40960
  s_sub_u32 s45, 40960, s44
  v_add_u32 v232, s45, v233
  v_add_u32 v233, s44, v233
  v_add_u32 v231, 81920, v233
  v_add_u32 v230, 81920, v232
  v_mov_b32 v12, 0x3f803f80
  v_mov_b32 v13, 0x3f803f80
  v_mov_b32 v14, 0x3f803f80
  v_mov_b32 v15, 0x3f803f80
  v_lshrrev_b32 v245, 4, v255
  v_mul_u32_u24 v245, 40960, v245
  v_and_b32 v244, 15, v255
  v_lshl_add_u32 v245, v244, 4, v245
  s_mul_i32 s44, s26, 640
  s_add_u32 s44, s44, 10240
  v_add_u32 v245, s44, v245
  v_lshrrev_b32 v244, 2, v244
  v_mul_u32_u24 v244, 320, v244
  v_lshrrev_b32 v229, 4, v255
  v_lshl_add_u32 v244, v229, 5, v244
  v_and_b32 v229, 3, v255
  v_lshl_add_u32 v244, v229, 3, v244
  v_mul_u32_u24 v229, 40960, v229
  s_lshl_b32 s44, s26, 3
  s_add_u32 s44, s44, 15360
  v_add_u32 v229, s44, v229
  s_add_u32 s46, s43, 10240
  v_add_u32 v244, s46, v244
  s_waitcnt vmcnt(6)
  s_add_u32 m0, s43, 26624
  s_add_u32 s63, s62, 1024
  buffer_load_dwordx4 v247, s[68:71], s63 offen offset:0 lds
  buffer_load_dwordx4 v246, s[68:71], s63 offen offset:1024 lds
  v_lshlrev_b32 v20, 16, v4
  v_and_b32 v21, 0xffff0000, v4
  v_lshlrev_b32 v22, 16, v5
  v_and_b32 v23, 0xffff0000, v5
  v_lshlrev_b32 v24, 16, v6
  v_and_b32 v25, 0xffff0000, v6
  v_lshlrev_b32 v26, 16, v7
  v_and_b32 v27, 0xffff0000, v7
  v_lshlrev_b32 v28, 16, v8
  v_and_b32 v29, 0xffff0000, v8
  v_lshlrev_b32 v30, 16, v9
  v_and_b32 v31, 0xffff0000, v9
  v_lshlrev_b32 v32, 16, v10
  v_and_b32 v33, 0xffff0000, v10
  v_lshlrev_b32 v34, 16, v11
  v_and_b32 v35, 0xffff0000, v11
  v_pk_add_f32 v[36:37], v[20:21], v[22:23]
  v_pk_add_f32 v[38:39], v[24:25], v[26:27]
  v_pk_add_f32 v[40:41], v[28:29], v[30:31]
  v_pk_add_f32 v[42:43], v[32:33], v[34:35]
  v_pk_add_f32 v[36:37], v[36:37], v[38:39]
  v_pk_add_f32 v[40:41], v[40:41], v[42:43]
  v_add_f32 v36, v36, v37
  v_add_f32 v40, v40, v41
  s_nop 1
  v_permlane32_swap_b32 v36, v40
  v_add_f32 v36, v36, v40
  s_nop 1
  v_add_f32_dpp v36, v36, v36 row_shr:1 row_mask:0xf bank_mask:0xf bound_ctrl:0
  s_add_u32 m0, s43, 28672
  s_add_u32 s63, s62, 2048
  buffer_load_dwordx4 v247, s[68:71], s63 offen offset:0 lds
  buffer_load_dwordx4 v246, s[68:71], s63 offen offset:1024 lds
  v_add_f32_dpp v36, v36, v36 row_shr:2 row_mask:0xf bank_mask:0xf bound_ctrl:0
  s_nop 1
  v_add_f32_dpp v36, v36, v36 row_shr:4 row_mask:0xf bank_mask:0xf bound_ctrl:0
  s_nop 1
  v_add_f32_dpp v36, v36, v36 row_shr:8 row_mask:0xf bank_mask:0xf bound_ctrl:0
  s_nop 1
  v_add_f32_dpp v36, v36, v36 row_bcast:15 row_mask:0xa bank_mask:0xf
  v_mul_f32 v36, 0x3b000000, v36
  s_nop 0
  v_readlane_b32 s72, v36, 31
  v_readlane_b32 s73, v36, 63
  s_nop 1
  v_pk_add_f32 v[20:21], v[20:21], s[72:73] op_sel:[0,0] op_sel_hi:[1,0] neg_lo:[0,1] neg_hi:[0,1]
  v_pk_add_f32 v[22:23], v[22:23], s[72:73] op_sel:[0,0] op_sel_hi:[1,0] neg_lo:[0,1] neg_hi:[0,1]
  v_pk_add_f32 v[24:25], v[24:25], s[72:73] op_sel:[0,0] op_sel_hi:[1,0] neg_lo:[0,1] neg_hi:[0,1]
  v_pk_add_f32 v[26:27], v[26:27], s[72:73] op_sel:[0,0] op_sel_hi:[1,0] neg_lo:[0,1] neg_hi:[0,1]
  v_pk_add_f32 v[28:29], v[28:29], s[72:73] op_sel:[0,1] op_sel_hi:[1,1] neg_lo:[0,1] neg_hi:[0,1]
  v_pk_add_f32 v[30:31], v[30:31], s[72:73] op_sel:[0,1] op_sel_hi:[1,1] neg_lo:[0,1] neg_hi:[0,1]
  v_pk_add_f32 v[32:33], v[32:33], s[72:73] op_sel:[0,1] op_sel_hi:[1,1] neg_lo:[0,1] neg_hi:[0,1]
  v_pk_add_f32 v[34:35], v[34:35], s[72:73] op_sel:[0,1] op_sel_hi:[1,1] neg_lo:[0,1] neg_hi:[0,1]
  v_pk_mul_f32 v[36:37], v[20:21], v[20:21]
  v_pk_mul_f32 v[40:41], v[28:29], v[28:29]
  v_pk_fma_f32 v[36:37], v[22:23], v[22:23], v[36:37]
  v_pk_fma_f32 v[40:41], v[30:31], v[30:31], v[40:41]
  v_pk_fma_f32 v[36:37], v[24:25], v[24:25], v[36:37]
  v_pk_fma_f32 v[40:41], v[32:33], v[32:33], v[40:41]
  v_pk_fma_f32 v[36:37], v[26:27], v[26:27], v[36:37]
  v_pk_fma_f32 v[40:41], v[34:35], v[34:35], v[40:41]
  v_add_f32 v36, v36, v37
  v_add_f32 v40, v40, v41
  s_nop 1
  v_permlane32_swap_b32 v36, v40
  v_add_f32 v36, v36, v40
  s_add_u32 s61, s60, 1
  s_and_b32 s61, s61, 3
  s_mul_i32 s62, s61, 196608
  s_lshl_b32 s61, s61, 7
  s_add_u32 m0, s43, 30720
  s_nop 0
  buffer_load_dwordx4 v251, s[64:67], s61 offen offset:0 lds
  buffer_load_dwordx4 v250, s[64:67], s61 offen offset:1024 lds
  v_add_f32_dpp v36, v36, v36 row_shr:1 row_mask:0xf bank_mask:0xf bound_ctrl:0
  s_nop 1
  v_add_f32_dpp v36, v36, v36 row_shr:2 row_mask:0xf bank_mask:0xf bound_ctrl:0
  s_nop 1
  v_add_f32_dpp v36, v36, v36 row_shr:4 row_mask:0xf bank_mask:0xf bound_ctrl:0
  s_nop 1
  v_add_f32_dpp v36, v36, v36 row_shr:8 row_mask:0xf bank_mask:0xf bound_ctrl:0
  s_nop 1
  v_add_f32_dpp v36, v36, v36 row_bcast:15 row_mask:0xa bank_mask:0xf
  v_mul_f32 v36, 0x3b000000, v36
  v_mov_b32 v40, 0x3727c5ac
  v_add_f32 v37, v36, v40
  v_rsq_f32 v37, v37
  s_nop 0
  v_mul_f32 v38, v36, v37
  v_fma_f32 v38, v38, v37, v40
  v_rsq_f32 v38, v38
  s_nop 0
  v_mul_f32 v39, v38, v37
  v_mul_f32 v37, 0x3fb8aa3b, v37
  v_readlane_b32 s80, v39, 31
  v_readlane_b32 s81, v39, 63
  v_readlane_b32 s76, v37, 31
  v_readlane_b32 s77, v37, 63
  v_pk_mul_f32 v[20:21], v[20:21], s[80:81] op_sel:[0,0] op_sel_hi:[1,0]
  v_pk_mul_f32 v[22:23], v[22:23], s[80:81] op_sel:[0,0] op_sel_hi:[1,0]
  v_pk_mul_f32 v[24:25], v[24:25], s[80:81] op_sel:[0,0] op_sel_hi:[1,0]
  v_pk_mul_f32 v[26:27], v[26:27], s[80:81] op_sel:[0,0] op_sel_hi:[1,0]
  v_cvt_pk_bf16_f32 v4, v20, v21
  v_cvt_pk_bf16_f32 v5, v22, v23
  v_cvt_pk_bf16_f32 v6, v24, v25
  v_cvt_pk_bf16_f32 v7, v26, v27
  ds_write_b128 v245, v[4:7] offset:0
  buffer_load_dwordx4 v249, s[64:67], s61 offen offset:2048 lds
  buffer_load_dwordx4 v248, s[64:67], s61 offen offset:3072 lds
  v_pk_mul_f32 v[28:29], v[28:29], s[80:81] op_sel:[0,1] op_sel_hi:[1,1]
  v_pk_mul_f32 v[30:31], v[30:31], s[80:81] op_sel:[0,1] op_sel_hi:[1,1]
  v_pk_mul_f32 v[32:33], v[32:33], s[80:81] op_sel:[0,1] op_sel_hi:[1,1]
  v_pk_mul_f32 v[34:35], v[34:35], s[80:81] op_sel:[0,1] op_sel_hi:[1,1]
  v_cvt_pk_bf16_f32 v8, v28, v29
  v_cvt_pk_bf16_f32 v9, v30, v31
  v_cvt_pk_bf16_f32 v10, v32, v33
  v_cvt_pk_bf16_f32 v11, v34, v35
  ds_write_b128 v245, v[8:11] offset:320
  v_mov_b32 v38, s76
  v_mov_b32 v39, s77
  v_pk_mul_f32 v[36:37], v[38:39], s[72:73]
  ds_write_b64 v229, v[36:37] offset:0
  ds_write_b64 v229, v[38:39] offset:32
  v_mov_b32 v245, 0
  global_load_dword v41, v245, s[22:23] sc1
  s_lshl_b32 s44, s41, 13
  s_lshl_b32 s45, s26, 11
  s_add_u32 s44, s44, s45
  s_add_u32 s47, s44, 8192
  s_lshl_b32 s45, s41, 6
  s_add_u32 s45, s45, 0x610000
  s_waitcnt lgkmcnt(0)
  s_barrier
  ds_read_b64_tr_b16 v[20:21], v244 offset:0
  ds_read_b64_tr_b16 v[22:23], v244 offset:1280
  ds_read_b64_tr_b16 v[28:29], v244 offset:128
  ds_read_b64_tr_b16 v[30:31], v244 offset:1408
  v_add_u32 v244, s46, v254
  ds_read_b128 v[36:39], v244 offset:5120
  s_waitcnt lgkmcnt(3)
  buffer_store_dwordx4 v[20:23], v254, s[32:35], s44 offen offset:0 sc1
  s_waitcnt lgkmcnt(1)
  buffer_store_dwordx4 v[28:31], v254, s[32:35], s44 offen offset:1024 sc1
  s_waitcnt lgkmcnt(0)
  s_mov_b64 exec, 0xf
  buffer_store_dwordx4 v[36:39], v254, s[32:35], s45 offen sc1
  s_mov_b64 exec, -1
  s_and_b32 s44, s40, 31
  s_or_b32 s44, s44, s26
  s_cmp_lg_u32 s44, 0
  s_cbranch_scc1 NOZERO_59
  v_mov_b32 v24, 0
  v_mov_b32 v25, 0
  v_mov_b32 v26, 0
  v_mov_b32 v27, 0
  s_mul_i32 s44, s27, 4352
  s_add_u32 s44, s44, 0x600000
  buffer_store_dwordx4 v[24:27], v254, s[32:35], s44 offen offset:0 sc1
  buffer_store_dwordx4 v[24:27], v254, s[32:35], s44 offen offset:1024 sc1
  buffer_store_dwordx4 v[24:27], v254, s[32:35], s44 offen offset:2048 sc1
  buffer_store_dwordx4 v[24:27], v254, s[32:35], s44 offen offset:3072 sc1
  s_add_u32 s44, s44, 4096
  s_mov_b64 exec, 0xffff
  buffer_store_dwordx4 v[24:27], v254, s[32:35], s44 offen sc1
  s_mov_b64 exec, -1
NOZERO_59:
  v_mov_b32 v124, 0
  v_mov_b32 v125, 0
  v_mov_b32 v126, 0
  v_mov_b32 v127, 0
  v_mov_b32 v128, 0
  v_mov_b32 v129, 0
  v_mov_b32 v130, 0
  v_mov_b32 v131, 0
  v_mov_b32 v132, 0
  v_mov_b32 v133, 0
  v_mov_b32 v134, 0
  v_mov_b32 v135, 0
  s_add_u32 m0, s43, 34816
  s_add_u32 s63, s62, 0
  buffer_load_dwordx4 v247, s[68:71], s63 offen offset:0 lds
  buffer_load_dwordx4 v246, s[68:71], s63 offen offset:1024 lds
  s_add_u32 m0, s43, 36864
  s_add_u32 s63, s62, 1024
  buffer_load_dwordx4 v247, s[68:71], s63 offen offset:0 lds
  buffer_load_dwordx4 v246, s[68:71], s63 offen offset:1024 lds
  s_add_u32 m0, s43, 38912
  s_add_u32 s63, s62, 2048
  buffer_load_dwordx4 v247, s[68:71], s63 offen offset:0 lds
  buffer_load_dwordx4 v246, s[68:71], s63 offen offset:1024 lds
  s_waitcnt vmcnt(14)
  s_barrier
  ds_read_b128 v[4:7], v241 offset:20480
  ds_read_b64_tr_b16 v[144:145], v233 offset:24576
  ds_read_b64_tr_b16 v[146:147], v233 offset:25088
  ds_read_b64_tr_b16 v[148:149], v233 offset:26624
  ds_read_b64_tr_b16 v[150:151], v233 offset:27136
  ds_read_b64_tr_b16 v[152:153], v233 offset:28672
  ds_read_b64_tr_b16 v[154:155], v233 offset:29184
  ds_read_b128 v[8:11], v240 offset:20480
  s_waitcnt lgkmcnt(0)
  v_mfma_f32_32x32x16_bf16 v[20:35], v[144:147], v[4:7], 0
  ds_read_b128 v[136:139], v239 offset:20480
  ds_read_b64_tr_b16 v[156:157], v232 offset:24576
  ds_read_b64_tr_b16 v[158:159], v232 offset:25088
  v_mfma_f32_32x32x16_bf16 v[60:75], v[4:7], v[148:151], 0
  ds_read_b64_tr_b16 v[160:161], v232 offset:26624
  ds_read_b64_tr_b16 v[162:163], v232 offset:27136
  ds_read_b64_tr_b16 v[164:165], v232 offset:28672
  v_mfma_f32_32x32x16_bf16 v[92:107], v[4:7], v[152:155], 0
  ds_read_b64_tr_b16 v[166:167], v232 offset:29184
  ds_read_b128 v[140:143], v238 offset:20480
  v_mfma_f32_32x32x16_bf16 v[44:59], v[144:147], v[8:11], 0
  s_add_u32 s61, s60, 0
  s_and_b32 s61, s61, 3
  s_add_u32 s61, s61, 4
  s_mul_i32 s62, s61, 196608
  s_lshl_b32 s61, s61, 7
  s_add_u32 m0, s43, 0
  s_nop 0
  buffer_load_dwordx4 v251, s[64:67], s61 offen offset:0 lds
  v_mfma_f32_32x32x16_bf16 v[76:91], v[8:11], v[148:151], 0
  buffer_load_dwordx4 v250, s[64:67], s61 offen offset:1024 lds
  v_mfma_f32_32x32x16_bf16 v[108:123], v[8:11], v[152:155], 0
  buffer_load_dwordx4 v249, s[64:67], s61 offen offset:2048 lds
  v_mfma_f32_16x16x32_bf16 v[124:127], v[16:19], v[144:147], v[124:127]
  v_mfma_f32_16x16x32_bf16 v[128:131], v[16:19], v[148:151], v[128:131]
  v_mfma_f32_16x16x32_bf16 v[132:135], v[16:19], v[152:155], v[132:135]
  s_waitcnt lgkmcnt(0)
  v_mfma_f32_32x32x16_bf16 v[20:35], v[156:159], v[136:139], v[20:35]
  ds_read_b128 v[4:7], v237 offset:20480
  ds_read_b64_tr_b16 v[144:145], v231 offset:24576
  ds_read_b64_tr_b16 v[146:147], v231 offset:25088
  v_mfma_f32_32x32x16_bf16 v[60:75], v[136:139], v[160:163], v[60:75]
  ds_read_b64_tr_b16 v[148:149], v231 offset:26624
  ds_read_b64_tr_b16 v[150:151], v231 offset:27136
  ds_read_b64_tr_b16 v[152:153], v231 offset:28672
  v_mfma_f32_32x32x16_bf16 v[92:107], v[136:139], v[164:167], v[92:107]
  ds_read_b64_tr_b16 v[154:155], v231 offset:29184
  ds_read_b128 v[8:11], v236 offset:20480
  v_mfma_f32_32x32x16_bf16 v[44:59], v[156:159], v[140:143], v[44:59]
  buffer_load_dwordx4 v248, s[64:67], s61 offen offset:3072 lds
  v_mfma_f32_32x32x16_bf16 v[76:91], v[140:143], v[160:163], v[76:91]
  s_add_u32 m0, s43, 4096
  s_add_u32 s63, s62, 0
  buffer_load_dwordx4 v247, s[68:71], s63 offen offset:0 lds
  v_mfma_f32_32x32x16_bf16 v[108:123], v[140:143], v[164:167], v[108:123]
  buffer_load_dwordx4 v246, s[68:71], s63 offen offset:1024 lds
  s_waitcnt lgkmcnt(0)
  v_mfma_f32_32x32x16_bf16 v[20:35], v[144:147], v[4:7], v[20:35]
  ds_read_b128 v[136:139], v235 offset:20480
  ds_read_b64_tr_b16 v[156:157], v230 offset:24576
  ds_read_b64_tr_b16 v[158:159], v230 offset:25088
  v_mfma_f32_32x32x16_bf16 v[60:75], v[4:7], v[148:151], v[60:75]
  ds_read_b64_tr_b16 v[160:161], v230 offset:26624
  ds_read_b64_tr_b16 v[162:163], v230 offset:27136
  ds_read_b64_tr_b16 v[164:165], v230 offset:28672
  v_mfma_f32_32x32x16_bf16 v[92:107], v[4:7], v[152:155], v[92:107]
  ds_read_b64_tr_b16 v[166:167], v230 offset:29184
  ds_read_b128 v[140:143], v234 offset:20480
  v_mfma_f32_32x32x16_bf16 v[44:59], v[144:147], v[8:11], v[44:59]
  s_add_u32 m0, s43, 6144
  s_add_u32 s63, s62, 1024
  buffer_load_dwordx4 v247, s[68:71], s63 offen offset:0 lds
  v_mfma_f32_32x32x16_bf16 v[76:91], v[8:11], v[148:151], v[76:91]
  buffer_load_dwordx4 v246, s[68:71], s63 offen offset:1024 lds
  v_mfma_f32_32x32x16_bf16 v[108:123], v[8:11], v[152:155], v[108:123]
  s_add_u32 m0, s43, 8192
  s_add_u32 s63, s62, 2048
  buffer_load_dwordx4 v247, s[68:71], s63 offen offset:0 lds
  v_mfma_f32_16x16x32_bf16 v[124:127], v[16:19], v[144:147], v[124:127]
  v_mfma_f32_16x16x32_bf16 v[128:131], v[16:19], v[148:151], v[128:131]
  v_mfma_f32_16x16x32_bf16 v[132:135], v[16:19], v[152:155], v[132:135]
  s_waitcnt vmcnt(9) lgkmcnt(0)
  s_barrier
  v_mfma_f32_32x32x16_bf16 v[20:35], v[156:159], v[136:139], v[20:35]
  ds_read_b128 v[4:7], v241 offset:30720
  ds_read_b64_tr_b16 v[144:145], v233 offset:34816
  ds_read_b64_tr_b16 v[146:147], v233 offset:35328
  v_mfma_f32_32x32x16_bf16 v[60:75], v[136:139], v[160:163], v[60:75]
  ds_read_b64_tr_b16 v[148:149], v233 offset:36864
  ds_read_b64_tr_b16 v[150:151], v233 offset:37376
  ds_read_b64_tr_b16 v[152:153], v233 offset:38912
  v_mfma_f32_32x32x16_bf16 v[92:107], v[136:139], v[164:167], v[92:107]
  ds_read_b64_tr_b16 v[154:155], v233 offset:39424
  ds_read_b128 v[8:11], v240 offset:30720
  v_mfma_f32_32x32x16_bf16 v[44:59], v[156:159], v[140:143], v[44:59]
  buffer_load_dwordx4 v246, s[68:71], s63 offen offset:1024 lds
  v_mfma_f32_32x32x16_bf16 v[76:91], v[140:143], v[160:163], v[76:91]
  s_add_u32 s61, s60, 2
  s_and_b32 s61, s61, 3
  s_mul_i32 s62, s61, 196608
  s_lshl_b32 s61, s61, 7
  s_add_u32 m0, s43, 10240
  s_nop 0
  buffer_load_dwordx4 v251, s[64:67], s61 offen offset:0 lds
  v_mfma_f32_32x32x16_bf16 v[108:123], v[140:143], v[164:167], v[108:123]
  s_lshl_b32 s44, s26, 8
  s_add_u32 s44, s44, s41
  s_lshl_b32 s44, s44, 4
  s_add_u32 s44, s44, 0x620000
  s_waitcnt vmcnt(17)
  v_readfirstlane_b32 s42, v41
  s_cmp_eq_u32 s42, 0
  s_cbranch_scc1 TAG_60
TAGOK_61:
  v_mov_b32 v229, s42
  s_mov_b64 exec, 1
  buffer_store_dword v229, v245, s[32:35], s44 offen sc1
  s_mov_b64 exec, -1
  s_waitcnt lgkmcnt(0)
  v_mfma_f32_32x32x16_bf16 v[20:35], v[144:147], v[4:7], v[20:35]
  ds_read_b128 v[136:139], v239 offset:30720
  ds_read_b64_tr_b16 v[156:157], v232 offset:34816
  ds_read_b64_tr_b16 v[158:159], v232 offset:35328
  v_mfma_f32_32x32x16_bf16 v[60:75], v[4:7], v[148:151], v[60:75]
  ds_read_b64_tr_b16 v[160:161], v232 offset:36864
  ds_read_b64_tr_b16 v[162:163], v232 offset:37376
  ds_read_b64_tr_b16 v[164:165], v232 offset:38912
  v_mfma_f32_32x32x16_bf16 v[92:107], v[4:7], v[152:155], v[92:107]
  ds_read_b64_tr_b16 v[166:167], v232 offset:39424
  ds_read_b128 v[140:143], v238 offset:30720
  v_mfma_f32_32x32x16_bf16 v[44:59], v[144:147], v[8:11], v[44:59]
  buffer_load_dwordx4 v250, s[64:67], s61 offen offset:1024 lds
  buffer_load_dwordx4 v249, s[64:67], s61 offen offset:2048 lds
  buffer_load_dwordx4 v248, s[64:67], s61 offen offset:3072 lds
  s_lshr_b32 s44, s27, 1
  v_mfma_f32_32x32x16_bf16 v[76:91], v[8:11], v[148:151], v[76:91]
  s_lshl_b32 s44, s44, 3
  s_and_b32 s45, s40, 7
  s_add_u32 s73, s44, s45
  s_and_b32 s44, s27, 1
  v_mfma_f32_32x32x16_bf16 v[108:123], v[8:11], v[152:155], v[108:123]
  s_lshl_b32 s44, s44, 2
  s_lshr_b32 s46, s40, 3
  s_and_b32 s47, s40, 1
  s_lshl_b32 s47, s47, 1
  v_mfma_f32_16x16x32_bf16 v[124:127], v[16:19], v[144:147], v[124:127]
  v_mfma_f32_16x16x32_bf16 v[128:131], v[16:19], v[148:151], v[128:131]
  v_mfma_f32_16x16x32_bf16 v[132:135], v[16:19], v[152:155], v[132:135]
  s_waitcnt lgkmcnt(0)
  v_mfma_f32_32x32x16_bf16 v[20:35], v[156:159], v[136:139], v[20:35]
  ds_read_b128 v[4:7], v237 offset:30720
  ds_read_b64_tr_b16 v[144:145], v231 offset:34816
  ds_read_b64_tr_b16 v[146:147], v231 offset:35328
  v_mfma_f32_32x32x16_bf16 v[60:75], v[136:139], v[160:163], v[60:75]
  ds_read_b64_tr_b16 v[148:149], v231 offset:36864
  ds_read_b64_tr_b16 v[150:151], v231 offset:37376
  ds_read_b64_tr_b16 v[152:153], v231 offset:38912
  v_mfma_f32_32x32x16_bf16 v[92:107], v[136:139], v[164:167], v[92:107]
  ds_read_b64_tr_b16 v[154:155], v231 offset:39424
  ds_read_b128 v[8:11], v236 offset:30720
  v_mfma_f32_32x32x16_bf16 v[44:59], v[156:159], v[140:143], v[44:59]
  s_add_u32 m0, s43, 14336
  s_add_u32 s63, s62, 0
  buffer_load_dwordx4 v247, s[68:71], s63 offen offset:0 lds
  buffer_load_dwordx4 v246, s[68:71], s63 offen offset:1024 lds
  s_xor_b32 s47, s47, s46
  s_add_u32 s74, s44, s47
  v_mfma_f32_32x32x16_bf16 v[76:91], v[140:143], v[160:163], v[76:91]
  s_mul_i32 s45, s45, 3
  s_and_b32 s46, s46, 1
  s_mul_i32 s46, s46, 11
  s_add_u32 s45, s45, s46
  v_mfma_f32_32x32x16_bf16 v[108:123], v[140:143], v[164:167], v[108:123]
  s_sub_u32 s46, s45, 22
  s_min_u32 s45, s45, s46
  s_lshl_b32 s75, s45, 14
  s_waitcnt lgkmcnt(0)
  v_mfma_f32_32x32x16_bf16 v[20:35], v[144:147], v[4:7], v[20:35]
  ds_read_b128 v[136:139], v235 offset:30720
  ds_read_b64_tr_b16 v[156:157], v230 offset:34816
  ds_read_b64_tr_b16 v[158:159], v230 offset:35328
  v_mfma_f32_32x32x16_bf16 v[60:75], v[4:7], v[148:151], v[60:75]
  ds_read_b64_tr_b16 v[160:161], v230 offset:36864
  ds_read_b64_tr_b16 v[162:163], v230 offset:37376
  ds_read_b64_tr_b16 v[164:165], v230 offset:38912
  v_mfma_f32_32x32x16_bf16 v[92:107], v[4:7], v[152:155], v[92:107]
  ds_read_b64_tr_b16 v[166:167], v230 offset:39424
  ds_read_b128 v[140:143], v234 offset:30720
  v_mfma_f32_32x32x16_bf16 v[44:59], v[144:147], v[8:11], v[44:59]
  s_add_u32 m0, s43, 16384
  s_add_u32 s63, s62, 1024
  buffer_load_dwordx4 v247, s[68:71], s63 offen offset:0 lds
  buffer_load_dwordx4 v246, s[68:71], s63 offen offset:1024 lds
  s_add_u32 m0, s43, 18432
  s_add_u32 s63, s62, 2048
  buffer_load_dwordx4 v247, s[68:71], s63 offen offset:0 lds
  s_lshl_b32 s76, s45, 16
  v_mfma_f32_32x32x16_bf16 v[76:91], v[8:11], v[148:151], v[76:91]
  s_mul_i32 s44, s26, 1441792
  s_lshl_b32 s45, s73, 7
  s_add_u32 s44, s44, s45
  s_add_u32 s80, s16, s44
  s_addc_u32 s81, s17, 0
  v_mfma_f32_32x32x16_bf16 v[108:123], v[8:11], v[152:155], v[108:123]
  s_sub_u32 s82, 0x560000, s44
  s_mov_b32 s83, 0x20000
  s_mul_i32 s44, s26, 360448
  s_lshl_b32 s45, s74, 10
  v_mfma_f32_16x16x32_bf16 v[124:127], v[16:19], v[144:147], v[124:127]
  v_mfma_f32_16x16x32_bf16 v[128:131], v[16:19], v[148:151], v[128:131]
  v_mfma_f32_16x16x32_bf16 v[132:135], v[16:19], v[152:155], v[132:135]
  s_waitcnt vmcnt(10) lgkmcnt(0)
  s_barrier
  v_mfma_f32_32x32x16_bf16 v[20:35], v[156:159], v[136:139], v[20:35]
  ds_read_b128 v[4:7], v241 offset:0
  ds_read_b64_tr_b16 v[144:145], v233 offset:4096
  ds_read_b64_tr_b16 v[146:147], v233 offset:4608
  v_mfma_f32_32x32x16_bf16 v[60:75], v[136:139], v[160:163], v[60:75]
  ds_read_b64_tr_b16 v[148:149], v233 offset:6144
  ds_read_b64_tr_b16 v[150:151], v233 offset:6656
  ds_read_b64_tr_b16 v[152:153], v233 offset:8192
  v_mfma_f32_32x32x16_bf16 v[92:107], v[136:139], v[164:167], v[92:107]
  ds_read_b64_tr_b16 v[154:155], v233 offset:8704
  ds_read_b128 v[8:11], v240 offset:0
  v_mfma_f32_32x32x16_bf16 v[44:59], v[156:159], v[140:143], v[44:59]
  buffer_load_dwordx4 v246, s[68:71], s63 offen offset:1024 lds
  s_add_u32 s61, s60, 3
  s_and_b32 s61, s61, 3
  s_mul_i32 s62, s61, 196608
  s_lshl_b32 s61, s61, 7
  s_add_u32 m0, s43, 20480
  s_nop 0
  buffer_load_dwordx4 v251, s[64:67], s61 offen offset:0 lds
  s_add_u32 s44, s44, s45
  s_add_u32 s84, s36, s44
  s_addc_u32 s85, s37, 0
  v_mfma_f32_32x32x16_bf16 v[76:91], v[140:143], v[160:163], v[76:91]
  s_sub_u32 s86, 0x158000, s44
  s_mov_b32 s87, 0x20000
  v_lshrrev_b32 v245, 2, v255
  v_and_b32 v245, 4, v245
  v_mfma_f32_32x32x16_bf16 v[108:123], v[140:143], v[164:167], v[108:123]
  v_xor_b32 v245, v245, v255
  v_and_b32 v245, 7, v245
  v_lshlrev_b32 v245, 4, v245
  s_waitcnt lgkmcnt(0)
  v_mfma_f32_32x32x16_bf16 v[20:35], v[144:147], v[4:7], v[20:35]
  ds_read_b128 v[136:139], v239 offset:0
  ds_read_b64_tr_b16 v[156:157], v232 offset:4096
  ds_read_b64_tr_b16 v[158:159], v232 offset:4608
  v_mfma_f32_32x32x16_bf16 v[60:75], v[4:7], v[148:151], v[60:75]
  ds_read_b64_tr_b16 v[160:161], v232 offset:6144
  ds_read_b64_tr_b16 v[162:163], v232 offset:6656
  ds_read_b64_tr_b16 v[164:165], v232 offset:8192
  v_mfma_f32_32x32x16_bf16 v[92:107], v[4:7], v[152:155], v[92:107]
  ds_read_b64_tr_b16 v[166:167], v232 offset:8704
  ds_read_b128 v[140:143], v238 offset:0
  v_mfma_f32_32x32x16_bf16 v[44:59], v[144:147], v[8:11], v[44:59]
  buffer_load_dwordx4 v250, s[64:67], s61 offen offset:1024 lds
  buffer_load_dwordx4 v249, s[64:67], s61 offen offset:2048 lds
  buffer_load_dwordx4 v248, s[64:67], s61 offen offset:3072 lds
  v_lshrrev_b32 v244, 3, v255
  v_mfma_f32_32x32x16_bf16 v[76:91], v[8:11], v[148:151], v[76:91]
  v_lshl_add_u32 v253, v244, 12, v245
  v_add_u32 v252, 31744, v253
  v_lshl_add_u32 v229, v244, 10, v245
  v_add_u32 v228, 7168, v229
  v_mfma_f32_32x32x16_bf16 v[108:123], v[8:11], v[152:155], v[108:123]
  s_lshl_b32 s44, s26, 17
  s_lshl_b32 s45, s74, 7
  s_add_u32 s44, s44, s45
  s_add_u32 s88, s8, s44
  s_addc_u32 s89, s9, 0
  v_mfma_f32_16x16x32_bf16 v[124:127], v[16:19], v[144:147], v[124:127]
  v_mfma_f32_16x16x32_bf16 v[128:131], v[16:19], v[148:151], v[128:131]
  v_mfma_f32_16x16x32_bf16 v[132:135], v[16:19], v[152:155], v[132:135]
  s_waitcnt lgkmcnt(0)
  v_mfma_f32_32x32x16_bf16 v[20:35], v[156:159], v[136:139], v[20:35]
  ds_read_b128 v[4:7], v237 offset:0
  ds_read_b64_tr_b16 v[144:145], v231 offset:4096
  ds_read_b64_tr_b16 v[146:147], v231 offset:4608
  v_mfma_f32_32x32x16_bf16 v[60:75], v[136:139], v[160:163], v[60:75]
  ds_read_b64_tr_b16 v[148:149], v231 offset:6144
  ds_read_b64_tr_b16 v[150:151], v231 offset:6656
  ds_read_b64_tr_b16 v[152:153], v231 offset:8192
  v_mfma_f32_32x32x16_bf16 v[92:107], v[136:139], v[164:167], v[92:107]
  ds_read_b64_tr_b16 v[154:155], v231 offset:8704
  ds_read_b128 v[8:11], v236 offset:0
  v_mfma_f32_32x32x16_bf16 v[44:59], v[156:159], v[140:143], v[44:59]
  s_add_u32 m0, s43, 24576
  s_add_u32 s63, s62, 0
  buffer_load_dwordx4 v247, s[68:71], s63 offen offset:0 lds
  buffer_load_dwordx4 v246, s[68:71], s63 offen offset:1024 lds
  s_sub_u32 s90, 0x80000, s44
  s_mov_b32 s91, 0x20000
  v_mfma_f32_32x32x16_bf16 v[76:91], v[140:143], v[160:163], v[76:91]
  s_lshr_b32 s77, s40, 3
  s_lshl_b32 s77, s77, 1
  s_add_u32 s77, s77, s40
  v_lshrrev_b32 v245, 5, v255
  v_mfma_f32_32x32x16_bf16 v[108:123], v[140:143], v[164:167], v[108:123]
  v_lshlrev_b32 v245, 9, v245
  v_bfe_u32 v244, v255, 2, 2
  v_lshl_add_u32 v245, v244, 7, v245
  s_waitcnt lgkmcnt(0)
  v_mfma_f32_32x32x16_bf16 v[20:35], v[144:147], v[4:7], v[20:35]
  ds_read_b128 v[136:139], v235 offset:0
  ds_read_b64_tr_b16 v[156:157], v230 offset:4096
  ds_read_b64_tr_b16 v[158:159], v230 offset:4608
  v_mfma_f32_32x32x16_bf16 v[60:75], v[4:7], v[148:151], v[60:75]
  ds_read_b64_tr_b16 v[160:161], v230 offset:6144
  ds_read_b64_tr_b16 v[162:163], v230 offset:6656
  ds_read_b64_tr_b16 v[164:165], v230 offset:8192
  v_mfma_f32_32x32x16_bf16 v[92:107], v[4:7], v[152:155], v[92:107]
  ds_read_b64_tr_b16 v[166:167], v230 offset:8704
  ds_read_b128 v[140:143], v234 offset:0
  v_mfma_f32_32x32x16_bf16 v[44:59], v[144:147], v[8:11], v[44:59]
  s_add_u32 m0, s43, 26624
  s_add_u32 s63, s62, 1024
  buffer_load_dwordx4 v247, s[68:71], s63 offen offset:0 lds
  buffer_load_dwordx4 v246, s[68:71], s63 offen offset:1024 lds
  s_add_u32 m0, s43, 28672
  s_add_u32 s63, s62, 2048
  buffer_load_dwordx4 v247, s[68:71], s63 offen offset:0 lds
  v_bfe_u32 v244, v255, 4, 1
  v_mfma_f32_32x32x16_bf16 v[76:91], v[8:11], v[148:151], v[76:91]
  v_lshl_add_u32 v245, v244, 5, v245
  v_and_b32 v244, 3, v255
  v_lshl_add_u32 v245, v244, 3, v245
  v_bfe_u32 v244, v255, 3, 1
  v_mfma_f32_32x32x16_bf16 v[108:123], v[8:11], v[152:155], v[108:123]
  v_lshl_add_u32 v245, v244, 6, v245
  v_add_u32 v245, s43, v245
  s_and_b32 s44, s26, 1
  s_lshl_b32 s44, s44, 6
  v_mfma_f32_16x16x32_bf16 v[124:127], v[16:19], v[144:147], v[124:127]
  v_mfma_f32_16x16x32_bf16 v[128:131], v[16:19], v[148:151], v[128:131]
  v_mfma_f32_16x16x32_bf16 v[132:135], v[16:19], v[152:155], v[132:135]
  s_waitcnt vmcnt(9) lgkmcnt(0)
  s_barrier
  v_mfma_f32_32x32x16_bf16 v[20:35], v[156:159], v[136:139], v[20:35]
  ds_read_b128 v[4:7], v241 offset:10240
  ds_read_b64_tr_b16 v[144:145], v233 offset:14336
  ds_read_b64_tr_b16 v[146:147], v233 offset:14848
  v_mfma_f32_32x32x16_bf16 v[60:75], v[136:139], v[160:163], v[60:75]
  ds_read_b64_tr_b16 v[148:149], v233 offset:16384
  ds_read_b64_tr_b16 v[150:151], v233 offset:16896
  ds_read_b64_tr_b16 v[152:153], v233 offset:18432
  v_mfma_f32_32x32x16_bf16 v[92:107], v[136:139], v[164:167], v[92:107]
  ds_read_b64_tr_b16 v[154:155], v233 offset:18944
  ds_read_b128 v[8:11], v240 offset:10240
  v_mfma_f32_32x32x16_bf16 v[44:59], v[156:159], v[140:143], v[44:59]
  buffer_load_dwordx4 v246, s[68:71], s63 offen offset:1024 lds
  s_add_u32 s61, s60, 1
  s_and_b32 s61, s61, 3
  s_add_u32 s61, s61, 4
  s_mul_i32 s62, s61, 196608
  s_lshl_b32 s61, s61, 7
  s_add_u32 m0, s43, 30720
  s_nop 0
  buffer_load_dwordx4 v251, s[64:67], s61 offen offset:0 lds
  v_xor_b32 v227, s44, v245
  v_xor_b32 v226, 64, v227
  v_mfma_f32_32x32x16_bf16 v[76:91], v[140:143], v[160:163], v[76:91]
  s_lshr_b32 s44, s26, 1
  s_lshl_b32 s44, s44, 6
  v_xor_b32 v245, s44, v245
  v_xor_b32 v244, 64, v245
  v_mfma_f32_32x32x16_bf16 v[108:123], v[140:143], v[164:167], v[108:123]
  v_and_b32 v225, 15, v255
  s_lshl_b32 s44, s56, 4
  v_add_u32 v225, s44, v225
  s_waitcnt lgkmcnt(0)
  v_mfma_f32_32x32x16_bf16 v[20:35], v[144:147], v[4:7], v[20:35]
  ds_read_b128 v[136:139], v239 offset:10240
  ds_read_b64_tr_b16 v[156:157], v232 offset:14336
  ds_read_b64_tr_b16 v[158:159], v232 offset:14848
  v_mfma_f32_32x32x16_bf16 v[60:75], v[4:7], v[148:151], v[60:75]
  ds_read_b64_tr_b16 v[160:161], v232 offset:16384
  ds_read_b64_tr_b16 v[162:163], v232 offset:16896
  ds_read_b64_tr_b16 v[164:165], v232 offset:18432
  v_mfma_f32_32x32x16_bf16 v[92:107], v[4:7], v[152:155], v[92:107]
  ds_read_b64_tr_b16 v[166:167], v232 offset:18944
  ds_read_b128 v[140:143], v238 offset:10240
  v_mfma_f32_32x32x16_bf16 v[44:59], v[144:147], v[8:11], v[44:59]
  buffer_load_dwordx4 v250, s[64:67], s61 offen offset:1024 lds
  buffer_load_dwordx4 v249, s[64:67], s61 offen offset:2048 lds
  buffer_load_dwordx4 v248, s[64:67], s61 offen offset:3072 lds
  s_lshl_b32 s44, s57, 5
  v_mfma_f32_32x32x16_bf16 v[76:91], v[8:11], v[148:151], v[76:91]
  v_mov_b32 v224, s44
  v_cmp_gt_u32 vcc, 16, v255
  s_nop 1
  v_cndmask_b32 v225, v224, v225, vcc
  v_lshlrev_b32 v225, 4, v225
  v_mfma_f32_32x32x16_bf16 v[108:123], v[8:11], v[152:155], v[108:123]
  v_add_u32 v225, 0x620000, v225
  s_lshl_b32 s72, s56, 1
  s_add_u32 s72, s72, s58
  s_lshl_b32 s72, s72, 9
  v_mfma_f32_16x16x32_bf16 v[124:127], v[16:19], v[144:147], v[124:127]
  v_mfma_f32_16x16x32_bf16 v[128:131], v[16:19], v[148:151], v[128:131]
  v_mfma_f32_16x16x32_bf16 v[132:135], v[16:19], v[152:155], v[132:135]
  s_waitcnt lgkmcnt(0)
  v_mfma_f32_32x32x16_bf16 v[20:35], v[156:159], v[136:139], v[20:35]
  ds_read_b128 v[4:7], v237 offset:10240
  ds_read_b64_tr_b16 v[144:145], v231 offset:14336
  ds_read_b64_tr_b16 v[146:147], v231 offset:14848
  v_mfma_f32_32x32x16_bf16 v[60:75], v[136:139], v[160:163], v[60:75]
  ds_read_b64_tr_b16 v[148:149], v231 offset:16384
  ds_read_b64_tr_b16 v[150:151], v231 offset:16896
  ds_read_b64_tr_b16 v[152:153], v231 offset:18432
  v_mfma_f32_32x32x16_bf16 v[92:107], v[136:139], v[164:167], v[92:107]
  ds_read_b64_tr_b16 v[154:155], v231 offset:18944
  ds_read_b128 v[8:11], v236 offset:10240
  v_mfma_f32_32x32x16_bf16 v[44:59], v[156:159], v[140:143], v[44:59]
  s_add_u32 m0, s43, 34816
  s_add_u32 s63, s62, 0
  buffer_load_dwordx4 v247, s[68:71], s63 offen offset:0 lds
  buffer_load_dwordx4 v246, s[68:71], s63 offen offset:1024 lds
  s_add_u32 s72, s72, 0x610000
  s_add_u32 s44, s43, 38912
  v_mfma_f32_32x32x16_bf16 v[76:91], v[140:143], v[160:163], v[76:91]
  v_add_u32 v224, s44, v254
  v_and_b32 v223, 15, v255
  v_lshl_add_u32 v223, v223, 2, s44
  v_lshrrev_b32 v222, 5, v255
  v_mfma_f32_32x32x16_bf16 v[108:123], v[140:143], v[164:167], v[108:123]
  v_lshl_add_u32 v222, v222, 4, s44
  v_and_b32 v221, 31, v255
  v_lshl_add_u32 v221, v221, 2, s44
  s_waitcnt lgkmcnt(0)
  v_mfma_f32_32x32x16_bf16 v[20:35], v[144:147], v[4:7], v[20:35]
  ds_read_b128 v[136:139], v235 offset:10240
  ds_read_b64_tr_b16 v[156:157], v230 offset:14336
  ds_read_b64_tr_b16 v[158:159], v230 offset:14848
  v_mfma_f32_32x32x16_bf16 v[60:75], v[4:7], v[148:151], v[60:75]
  ds_read_b64_tr_b16 v[160:161], v230 offset:16384
  ds_read_b64_tr_b16 v[162:163], v230 offset:16896
  ds_read_b64_tr_b16 v[164:165], v230 offset:18432
  v_mfma_f32_32x32x16_bf16 v[92:107], v[4:7], v[152:155], v[92:107]
  ds_read_b64_tr_b16 v[166:167], v230 offset:18944
  ds_read_b128 v[140:143], v234 offset:10240
  v_mfma_f32_32x32x16_bf16 v[44:59], v[144:147], v[8:11], v[44:59]
  s_add_u32 m0, s43, 36864
  s_add_u32 s63, s62, 1024
  buffer_load_dwordx4 v247, s[68:71], s63 offen offset:0 lds
  buffer_load_dwordx4 v246, s[68:71], s63 offen offset:1024 lds
  s_add_u32 m0, s43, 38912
  s_add_u32 s63, s62, 2048
  buffer_load_dwordx4 v247, s[68:71], s63 offen offset:0 lds
  v_bfe_u32 v220, v255, 3, 2
  v_mfma_f32_32x32x16_bf16 v[76:91], v[8:11], v[148:151], v[76:91]
  v_lshlrev_b32 v220, 6, v220
  v_and_b32 v219, 7, v255
  v_lshl_add_u32 v220, v219, 2, v220
  v_add_u32 v220, s44, v220
  v_mfma_f32_32x32x16_bf16 v[108:123], v[8:11], v[152:155], v[108:123]
  s_xor_b32 s45, s26, 1
  s_sub_u32 s45, s45, s26
  s_mul_i32 s45, s45, 40960
  v_add_u32 v219, s45, v221
  v_mfma_f32_16x16x32_bf16 v[124:127], v[16:19], v[144:147], v[124:127]
  v_mfma_f32_16x16x32_bf16 v[128:131], v[16:19], v[148:151], v[128:131]
  v_mfma_f32_16x16x32_bf16 v[132:135], v[16:19], v[152:155], v[132:135]
  s_waitcnt vmcnt(9) lgkmcnt(0)
  s_barrier
  v_mfma_f32_32x32x16_bf16 v[20:35], v[156:159], v[136:139], v[20:35]
  ds_read_b128 v[4:7], v241 offset:20480
  ds_read_b64_tr_b16 v[144:145], v233 offset:24576
  ds_read_b64_tr_b16 v[146:147], v233 offset:25088
  v_mfma_f32_32x32x16_bf16 v[60:75], v[136:139], v[160:163], v[60:75]
  ds_read_b64_tr_b16 v[148:149], v233 offset:26624
  ds_read_b64_tr_b16 v[150:151], v233 offset:27136
  ds_read_b64_tr_b16 v[152:153], v233 offset:28672
  v_mfma_f32_32x32x16_bf16 v[92:107], v[136:139], v[164:167], v[92:107]
  ds_read_b64_tr_b16 v[154:155], v233 offset:29184
  ds_read_b128 v[8:11], v240 offset:20480
  v_mfma_f32_32x32x16_bf16 v[44:59], v[156:159], v[140:143], v[44:59]
  buffer_load_dwordx4 v246, s[68:71], s63 offen offset:1024 lds
  s_add_u32 s61, s60, 2
  s_and_b32 s61, s61, 3
  s_add_u32 s61, s61, 4
  s_mul_i32 s62, s61, 196608
  s_lshl_b32 s61, s61, 7
  s_add_u32 m0, s43, 0
  s_nop 0
  buffer_load_dwordx4 v251, s[64:67], s61 offen offset:0 lds
  v_add_u32 v218, s45, v222
  v_bfe_u32 v214, v255, 4, 1
  v_mfma_f32_32x32x16_bf16 v[76:91], v[140:143], v[160:163], v[76:91]
  v_mul_u32_u24 v214, 1088, v214
  v_lshrrev_b32 v213, 5, v255
  v_mul_u32_u24 v213, 272, v213
  v_add_u32 v214, v214, v213
  v_mfma_f32_32x32x16_bf16 v[108:123], v[140:143], v[164:167], v[108:123]
  s_mul_i32 s44, s58, 4352
  s_mul_i32 s45, s59, 2176
  s_add_u32 s44, s44, s45
  s_waitcnt lgkmcnt(0)
  v_mfma_f32_32x32x16_bf16 v[20:35], v[144:147], v[4:7], v[20:35]
  ds_read_b128 v[136:139], v239 offset:20480
  ds_read_b64_tr_b16 v[156:157], v232 offset:24576
  ds_read_b64_tr_b16 v[158:159], v232 offset:25088
  v_mfma_f32_32x32x16_bf16 v[60:75], v[4:7], v[148:151], v[60:75]
  ds_read_b64_tr_b16 v[160:161], v232 offset:26624
  ds_read_b64_tr_b16 v[162:163], v232 offset:27136
  ds_read_b64_tr_b16 v[164:165], v232 offset:28672
  v_mfma_f32_32x32x16_bf16 v[92:107], v[4:7], v[152:155], v[92:107]
  ds_read_b64_tr_b16 v[166:167], v232 offset:29184
  ds_read_b128 v[140:143], v238 offset:20480
  v_mfma_f32_32x32x16_bf16 v[44:59], v[144:147], v[8:11], v[44:59]
  buffer_load_dwordx4 v250, s[64:67], s61 offen offset:1024 lds
  buffer_load_dwordx4 v249, s[64:67], s61 offen offset:2048 lds
  buffer_load_dwordx4 v248, s[64:67], s61 offen offset:3072 lds
  v_add_u32 v214, s44, v214
  v_mfma_f32_32x32x16_bf16 v[76:91], v[8:11], v[148:151], v[76:91]
  v_and_b32 v213, 15, v255
  v_lshl_add_u32 v213, v213, 4, v214
  v_lshlrev_b32 v212, 2, v0
  s_mul_i32 s95, s57, 4352
  v_mfma_f32_32x32x16_bf16 v[108:123], v[8:11], v[152:155], v[108:123]
  s_add_u32 s95, s95, 0x600000
  s_lshl_b32 s79, s57, 1
  s_add_u32 s79, s79, s59
  s_lshl_b32 s79, s79, 17
  v_mfma_f32_16x16x32_bf16 v[124:127], v[16:19], v[144:147], v[124:127]
  v_mfma_f32_16x16x32_bf16 v[128:131], v[16:19], v[148:151], v[128:131]
  v_mfma_f32_16x16x32_bf16 v[132:135], v[16:19], v[152:155], v[132:135]
  s_waitcnt lgkmcnt(0)
  v_mfma_f32_32x32x16_bf16 v[20:35], v[156:159], v[136:139], v[20:35]
  ds_read_b128 v[4:7], v237 offset:20480
  ds_read_b64_tr_b16 v[144:145], v231 offset:24576
  ds_read_b64_tr_b16 v[146:147], v231 offset:25088
  v_mfma_f32_32x32x16_bf16 v[60:75], v[136:139], v[160:163], v[60:75]
  ds_read_b64_tr_b16 v[148:149], v231 offset:26624
  ds_read_b64_tr_b16 v[150:151], v231 offset:27136
  ds_read_b64_tr_b16 v[152:153], v231 offset:28672
  v_mfma_f32_32x32x16_bf16 v[92:107], v[136:139], v[164:167], v[92:107]
  ds_read_b64_tr_b16 v[154:155], v231 offset:29184
  ds_read_b128 v[8:11], v236 offset:20480
  v_mfma_f32_32x32x16_bf16 v[44:59], v[156:159], v[140:143], v[44:59]
  s_add_u32 m0, s43, 4096
  s_add_u32 s63, s62, 0
  buffer_load_dwordx4 v247, s[68:71], s63 offen offset:0 lds
  buffer_load_dwordx4 v246, s[68:71], s63 offen offset:1024 lds
  s_lshl_b32 s44, s56, 1
  s_add_u32 s44, s44, s58
  v_mfma_f32_32x32x16_bf16 v[76:91], v[140:143], v[160:163], v[76:91]
  s_lshl_b32 s44, s44, 11
  s_add_u32 s79, s79, s44
  s_add_u32 s79, s79, 0x400000
  s_add_u32 s92, s79, 0x10000
  v_mfma_f32_32x32x16_bf16 v[108:123], v[140:143], v[164:167], v[108:123]
  s_lshl_b32 s44, s57, 4
  s_add_u32 s44, s44, s56
  s_lshl_b32 s44, s44, 7
  s_waitcnt lgkmcnt(0)
  v_mfma_f32_32x32x16_bf16 v[20:35], v[144:147], v[4:7], v[20:35]
  ds_read_b128 v[136:139], v235 offset:20480
  ds_read_b64_tr_b16 v[156:157], v230 offset:24576
  ds_read_b64_tr_b16 v[158:159], v230 offset:25088
  v_mfma_f32_32x32x16_bf16 v[60:75], v[4:7], v[148:151], v[60:75]
  ds_read_b64_tr_b16 v[160:161], v230 offset:26624
  ds_read_b64_tr_b16 v[162:163], v230 offset:27136
  ds_read_b64_tr_b16 v[164:165], v230 offset:28672
  v_mfma_f32_32x32x16_bf16 v[92:107], v[4:7], v[152:155], v[92:107]
  ds_read_b64_tr_b16 v[166:167], v230 offset:29184
  ds_read_b128 v[140:143], v234 offset:20480
  v_mfma_f32_32x32x16_bf16 v[44:59], v[144:147], v[8:11], v[44:59]
  s_add_u32 m0, s43, 6144
  s_add_u32 s63, s62, 1024
  buffer_load_dwordx4 v247, s[68:71], s63 offen offset:0 lds
  buffer_load_dwordx4 v246, s[68:71], s63 offen offset:1024 lds
  s_add_u32 m0, s43, 8192
  s_add_u32 s63, s62, 2048
  buffer_load_dwordx4 v247, s[68:71], s63 offen offset:0 lds
  s_add_u32 s94, s44, 0x640000
  v_mfma_f32_32x32x16_bf16 v[76:91], v[8:11], v[148:151], v[76:91]
  s_lshl_b32 s45, s56, 3
  s_add_u32 s45, s45, s57
  s_lshl_b32 s45, s45, 2
  v_mfma_f32_32x32x16_bf16 v[108:123], v[8:11], v[152:155], v[108:123]
  s_add_u32 s45, s45, s26
  s_lshl_b32 s45, s45, 7
  s_add_u32 s93, s45, 0x680000
  v_mfma_f32_16x16x32_bf16 v[124:127], v[16:19], v[144:147], v[124:127]
  v_mfma_f32_16x16x32_bf16 v[128:131], v[16:19], v[148:151], v[128:131]
  v_mfma_f32_16x16x32_bf16 v[132:135], v[16:19], v[152:155], v[132:135]
  s_waitcnt vmcnt(9) lgkmcnt(0)
  s_barrier
  v_mfma_f32_32x32x16_bf16 v[20:35], v[156:159], v[136:139], v[20:35]
  ds_read_b128 v[4:7], v241 offset:30720
  ds_read_b64_tr_b16 v[144:145], v233 offset:34816
  ds_read_b64_tr_b16 v[146:147], v233 offset:35328
  v_mfma_f32_32x32x16_bf16 v[60:75], v[136:139], v[160:163], v[60:75]
  ds_read_b64_tr_b16 v[148:149], v233 offset:36864
  ds_read_b64_tr_b16 v[150:151], v233 offset:37376
  ds_read_b64_tr_b16 v[152:153], v233 offset:38912
  v_mfma_f32_32x32x16_bf16 v[92:107], v[136:139], v[164:167], v[92:107]
  ds_read_b64_tr_b16 v[154:155], v233 offset:39424
  ds_read_b128 v[8:11], v240 offset:30720
  v_mfma_f32_32x32x16_bf16 v[44:59], v[156:159], v[140:143], v[44:59]
  buffer_load_dwordx4 v246, s[68:71], s63 offen offset:1024 lds
  v_mfma_f32_32x32x16_bf16 v[76:91], v[140:143], v[160:163], v[76:91]
  s_add_u32 s61, s60, 3
  s_and_b32 s61, s61, 3
  s_add_u32 s61, s61, 4
  s_mul_i32 s62, s61, 196608
  s_lshl_b32 s61, s61, 7
  s_add_u32 m0, s43, 10240
  s_nop 0
  buffer_load_dwordx4 v251, s[64:67], s61 offen offset:0 lds
  v_mfma_f32_32x32x16_bf16 v[108:123], v[140:143], v[164:167], v[108:123]
  s_waitcnt lgkmcnt(0)
  v_mfma_f32_32x32x16_bf16 v[20:35], v[144:147], v[4:7], v[20:35]
  ds_read_b128 v[136:139], v239 offset:30720
  ds_read_b64_tr_b16 v[156:157], v232 offset:34816
  ds_read_b64_tr_b16 v[158:159], v232 offset:35328
  v_mfma_f32_32x32x16_bf16 v[60:75], v[4:7], v[148:151], v[60:75]
  ds_read_b64_tr_b16 v[160:161], v232 offset:36864
  ds_read_b64_tr_b16 v[162:163], v232 offset:37376
  ds_read_b64_tr_b16 v[164:165], v232 offset:38912
  v_mfma_f32_32x32x16_bf16 v[92:107], v[4:7], v[152:155], v[92:107]
  ds_read_b64_tr_b16 v[166:167], v232 offset:39424
  ds_read_b128 v[140:143], v238 offset:30720
  v_mfma_f32_32x32x16_bf16 v[44:59], v[144:147], v[8:11], v[44:59]
  buffer_load_dwordx4 v250, s[64:67], s61 offen offset:1024 lds
  v_mfma_f32_32x32x16_bf16 v[76:91], v[8:11], v[148:151], v[76:91]
  buffer_load_dwordx4 v249, s[64:67], s61 offen offset:2048 lds
  v_mfma_f32_32x32x16_bf16 v[108:123], v[8:11], v[152:155], v[108:123]
  buffer_load_dwordx4 v248, s[64:67], s61 offen offset:3072 lds
  v_mfma_f32_16x16x32_bf16 v[124:127], v[16:19], v[144:147], v[124:127]
  v_mfma_f32_16x16x32_bf16 v[128:131], v[16:19], v[148:151], v[128:131]
  v_mfma_f32_16x16x32_bf16 v[132:135], v[16:19], v[152:155], v[132:135]
  s_waitcnt lgkmcnt(0)
  v_mfma_f32_32x32x16_bf16 v[20:35], v[156:159], v[136:139], v[20:35]
  ds_read_b128 v[4:7], v237 offset:30720
  ds_read_b64_tr_b16 v[144:145], v231 offset:34816
  ds_read_b64_tr_b16 v[146:147], v231 offset:35328
  v_mfma_f32_32x32x16_bf16 v[60:75], v[136:139], v[160:163], v[60:75]
  ds_read_b64_tr_b16 v[148:149], v231 offset:36864
  ds_read_b64_tr_b16 v[150:151], v231 offset:37376
  ds_read_b64_tr_b16 v[152:153], v231 offset:38912
  v_mfma_f32_32x32x16_bf16 v[92:107], v[136:139], v[164:167], v[92:107]
  ds_read_b64_tr_b16 v[154:155], v231 offset:39424
  ds_read_b128 v[8:11], v236 offset:30720
  v_mfma_f32_32x32x16_bf16 v[44:59], v[156:159], v[140:143], v[44:59]
  s_add_u32 m0, s43, 14336
  s_add_u32 s63, s62, 0
  buffer_load_dwordx4 v247, s[68:71], s63 offen offset:0 lds
  v_mfma_f32_32x32x16_bf16 v[76:91], v[140:143], v[160:163], v[76:91]
  buffer_load_dwordx4 v246, s[68:71], s63 offen offset:1024 lds
  v_mfma_f32_32x32x16_bf16 v[108:123], v[140:143], v[164:167], v[108:123]
  s_waitcnt lgkmcnt(0)
  v_mfma_f32_32x32x16_bf16 v[20:35], v[144:147], v[4:7], v[20:35]
  ds_read_b128 v[136:139], v235 offset:30720
  ds_read_b64_tr_b16 v[156:157], v230 offset:34816
  ds_read_b64_tr_b16 v[158:159], v230 offset:35328
  v_mfma_f32_32x32x16_bf16 v[60:75], v[4:7], v[148:151], v[60:75]
  ds_read_b64_tr_b16 v[160:161], v230 offset:36864
  ds_read_b64_tr_b16 v[162:163], v230 offset:37376
  ds_read_b64_tr_b16 v[164:165], v230 offset:38912
  v_mfma_f32_32x32x16_bf16 v[92:107], v[4:7], v[152:155], v[92:107]
  ds_read_b64_tr_b16 v[166:167], v230 offset:39424
  ds_read_b128 v[140:143], v234 offset:30720
  v_mfma_f32_32x32x16_bf16 v[44:59], v[144:147], v[8:11], v[44:59]
  s_add_u32 m0, s43, 16384
  s_add_u32 s63, s62, 1024
  buffer_load_dwordx4 v247, s[68:71], s63 offen offset:0 lds
  v_mfma_f32_32x32x16_bf16 v[76:91], v[8:11], v[148:151], v[76:91]
  buffer_load_dwordx4 v246, s[68:71], s63 offen offset:1024 lds
  v_mfma_f32_32x32x16_bf16 v[108:123], v[8:11], v[152:155], v[108:123]
  s_add_u32 m0, s43, 18432
  s_add_u32 s63, s62, 2048
  buffer_load_dwordx4 v247, s[68:71], s63 offen offset:0 lds
  v_mfma_f32_16x16x32_bf16 v[124:127], v[16:19], v[144:147], v[124:127]
  v_mfma_f32_16x16x32_bf16 v[128:131], v[16:19], v[148:151], v[128:131]
  v_mfma_f32_16x16x32_bf16 v[132:135], v[16:19], v[152:155], v[132:135]
  s_waitcnt vmcnt(9) lgkmcnt(0)
  s_barrier
  v_mfma_f32_32x32x16_bf16 v[20:35], v[156:159], v[136:139], v[20:35]
  ds_read_b128 v[4:7], v241 offset:0
  ds_read_b64_tr_b16 v[144:145], v233 offset:4096
  ds_read_b64_tr_b16 v[146:147], v233 offset:4608
  v_mfma_f32_32x32x16_bf16 v[60:75], v[136:139], v[160:163], v[60:75]
  ds_read_b64_tr_b16 v[148:149], v233 offset:6144
  ds_read_b64_tr_b16 v[150:151], v233 offset:6656
  ds_read_b64_tr_b16 v[152:153], v233 offset:8192
  v_mfma_f32_32x32x16_bf16 v[92:107], v[136:139], v[164:167], v[92:107]
  ds_read_b64_tr_b16 v[154:155], v233 offset:8704
  ds_read_b128 v[8:11], v240 offset:0
  v_mfma_f32_32x32x16_bf16 v[44:59], v[156:159], v[140:143], v[44:59]
  buffer_load_dwordx4 v246, s[68:71], s63 offen offset:1024 lds
  v_mfma_f32_32x32x16_bf16 v[76:91], v[140:143], v[160:163], v[76:91]
  s_add_u32 s78, s76, 0
  s_sub_u32 s3, s78, 1441792
  s_min_u32 s78, s78, s3
  s_add_u32 m0, s43, 20480
  s_nop 0
  buffer_load_dwordx4 v253, s[80:83], s78 offen lds
  v_mfma_f32_32x32x16_bf16 v[108:123], v[140:143], v[164:167], v[108:123]
  s_add_u32 m0, s43, 20480
  s_nop 0
  buffer_load_dwordx4 v252, s[80:83], s78 offen offset:1024 lds
  s_waitcnt lgkmcnt(0)
  v_mfma_f32_32x32x16_bf16 v[20:35], v[144:147], v[4:7], v[20:35]
  ds_read_b128 v[136:139], v239 offset:0
  ds_read_b64_tr_b16 v[156:157], v232 offset:4096
  ds_read_b64_tr_b16 v[158:159], v232 offset:4608
  v_mfma_f32_32x32x16_bf16 v[60:75], v[4:7], v[148:151], v[60:75]
  ds_read_b64_tr_b16 v[160:161], v232 offset:6144
  ds_read_b64_tr_b16 v[162:163], v232 offset:6656
  ds_read_b64_tr_b16 v[164:165], v232 offset:8192
  v_mfma_f32_32x32x16_bf16 v[92:107], v[4:7], v[152:155], v[92:107]
  ds_read_b64_tr_b16 v[166:167], v232 offset:8704
  ds_read_b128 v[140:143], v238 offset:0
  v_mfma_f32_32x32x16_bf16 v[44:59], v[144:147], v[8:11], v[44:59]
  buffer_load_dword v211, v225, s[32:35], 0 offen sc1
  v_mfma_f32_32x32x16_bf16 v[76:91], v[8:11], v[148:151], v[76:91]
  s_add_u32 s78, s76, 65536
  s_sub_u32 s3, s78, 1441792
  s_min_u32 s78, s78, s3
  s_add_u32 m0, s43, 22528
  s_nop 0
  buffer_load_dwordx4 v253, s[80:83], s78 offen lds
  v_mfma_f32_32x32x16_bf16 v[108:123], v[8:11], v[152:155], v[108:123]
  s_add_u32 m0, s43, 22528
  s_nop 0
  buffer_load_dwordx4 v252, s[80:83], s78 offen offset:1024 lds
  v_mfma_f32_16x16x32_bf16 v[124:127], v[16:19], v[144:147], v[124:127]
  v_mfma_f32_16x16x32_bf16 v[128:131], v[16:19], v[148:151], v[128:131]
  v_mfma_f32_16x16x32_bf16 v[132:135], v[16:19], v[152:155], v[132:135]
  s_waitcnt lgkmcnt(0)
  v_mfma_f32_32x32x16_bf16 v[20:35], v[156:159], v[136:139], v[20:35]
  ds_read_b128 v[4:7], v237 offset:0
  ds_read_b64_tr_b16 v[144:145], v231 offset:4096
  ds_read_b64_tr_b16 v[146:147], v231 offset:4608
  v_mfma_f32_32x32x16_bf16 v[60:75], v[136:139], v[160:163], v[60:75]
  ds_read_b64_tr_b16 v[148:149], v231 offset:6144
  ds_read_b64_tr_b16 v[150:151], v231 offset:6656
  ds_read_b64_tr_b16 v[152:153], v231 offset:8192
  v_mfma_f32_32x32x16_bf16 v[92:107], v[136:139], v[164:167], v[92:107]
  ds_read_b64_tr_b16 v[154:155], v231 offset:8704
  ds_read_b128 v[8:11], v236 offset:0
  v_mfma_f32_32x32x16_bf16 v[44:59], v[156:159], v[140:143], v[44:59]
  s_add_u32 s78, s76, 131072
  s_sub_u32 s3, s78, 1441792
  s_min_u32 s78, s78, s3
  s_add_u32 m0, s43, 24576
  s_nop 0
  buffer_load_dwordx4 v253, s[80:83], s78 offen lds
  v_mfma_f32_32x32x16_bf16 v[76:91], v[140:143], v[160:163], v[76:91]
  s_add_u32 m0, s43, 24576
  s_nop 0
  buffer_load_dwordx4 v252, s[80:83], s78 offen offset:1024 lds
  v_mfma_f32_32x32x16_bf16 v[108:123], v[140:143], v[164:167], v[108:123]
  s_waitcnt lgkmcnt(0)
  v_mfma_f32_32x32x16_bf16 v[20:35], v[144:147], v[4:7], v[20:35]
  ds_read_b128 v[136:139], v235 offset:0
  ds_read_b64_tr_b16 v[156:157], v230 offset:4096
  ds_read_b64_tr_b16 v[158:159], v230 offset:4608
  v_mfma_f32_32x32x16_bf16 v[60:75], v[4:7], v[148:151], v[60:75]
  ds_read_b64_tr_b16 v[160:161], v230 offset:6144
  ds_read_b64_tr_b16 v[162:163], v230 offset:6656
  ds_read_b64_tr_b16 v[164:165], v230 offset:8192
  v_mfma_f32_32x32x16_bf16 v[92:107], v[4:7], v[152:155], v[92:107]
  ds_read_b64_tr_b16 v[166:167], v230 offset:8704
  ds_read_b128 v[140:143], v234 offset:0
  v_mfma_f32_32x32x16_bf16 v[44:59], v[144:147], v[8:11], v[44:59]
  s_add_u32 s78, s76, 196608
  s_sub_u32 s3, s78, 1441792
  s_min_u32 s78, s78, s3
  s_add_u32 m0, s43, 26624
  s_nop 0
  buffer_load_dwordx4 v253, s[80:83], s78 offen lds
  v_mfma_f32_32x32x16_bf16 v[76:91], v[8:11], v[148:151], v[76:91]
  s_add_u32 m0, s43, 26624
  s_nop 0
  buffer_load_dwordx4 v252, s[80:83], s78 offen offset:1024 lds
  v_mfma_f32_32x32x16_bf16 v[108:123], v[8:11], v[152:155], v[108:123]
  v_mfma_f32_16x16x32_bf16 v[124:127], v[16:19], v[144:147], v[124:127]
  v_mfma_f32_16x16x32_bf16 v[128:131], v[16:19], v[148:151], v[128:131]
  v_mfma_f32_16x16x32_bf16 v[132:135], v[16:19], v[152:155], v[132:135]
  s_waitcnt vmcnt(9) lgkmcnt(0)
  s_barrier
  v_mfma_f32_32x32x16_bf16 v[20:35], v[156:159], v[136:139], v[20:35]
  ds_read_b128 v[4:7], v241 offset:10240
  ds_read_b64_tr_b16 v[144:145], v233 offset:14336
  ds_read_b64_tr_b16 v[146:147], v233 offset:14848
  v_mfma_f32_32x32x16_bf16 v[60:75], v[136:139], v[160:163], v[60:75]
  ds_read_b64_tr_b16 v[148:149], v233 offset:16384
  ds_read_b64_tr_b16 v[150:151], v233 offset:16896
  ds_read_b64_tr_b16 v[152:153], v233 offset:18432
  v_mfma_f32_32x32x16_bf16 v[92:107], v[136:139], v[164:167], v[92:107]
  ds_read_b64_tr_b16 v[154:155], v233 offset:18944
  ds_read_b128 v[8:11], v240 offset:10240
  v_mfma_f32_32x32x16_bf16 v[44:59], v[156:159], v[140:143], v[44:59]
  s_add_u32 s78, s76, 262144
  s_sub_u32 s3, s78, 1441792
  s_min_u32 s78, s78, s3
  s_add_u32 m0, s43, 28672
  s_nop 0
  buffer_load_dwordx4 v253, s[80:83], s78 offen lds
  v_mfma_f32_32x32x16_bf16 v[76:91], v[140:143], v[160:163], v[76:91]
  s_add_u32 m0, s43, 28672
  s_nop 0
  buffer_load_dwordx4 v252, s[80:83], s78 offen offset:1024 lds
  v_mfma_f32_32x32x16_bf16 v[108:123], v[140:143], v[164:167], v[108:123]
  s_waitcnt lgkmcnt(0)
  v_mfma_f32_32x32x16_bf16 v[20:35], v[144:147], v[4:7], v[20:35]
  ds_read_b128 v[136:139], v239 offset:10240
  ds_read_b64_tr_b16 v[156:157], v232 offset:14336
  ds_read_b64_tr_b16 v[158:159], v232 offset:14848
  v_mfma_f32_32x32x16_bf16 v[60:75], v[4:7], v[148:151], v[60:75]
  ds_read_b64_tr_b16 v[160:161], v232 offset:16384
  ds_read_b64_tr_b16 v[162:163], v232 offset:16896
  ds_read_b64_tr_b16 v[164:165], v232 offset:18432
  v_mfma_f32_32x32x16_bf16 v[92:107], v[4:7], v[152:155], v[92:107]
  ds_read_b64_tr_b16 v[166:167], v232 offset:18944
  ds_read_b128 v[140:143], v238 offset:10240
  v_mfma_f32_32x32x16_bf16 v[44:59], v[144:147], v[8:11], v[44:59]
  s_waitcnt vmcnt(8)
  v_cmp_ne_u32 vcc, s42, v211
  s_cbranch_vccnz POLL_62
POLLOK_63:
  buffer_load_dwordx4 v[36:39], v254, s[32:35], s72 offen sc1
  v_mfma_f32_32x32x16_bf16 v[76:91], v[8:11], v[148:151], v[76:91]
  s_add_u32 s78, s76, 327680
  s_sub_u32 s3, s78, 1441792
  s_min_u32 s78, s78, s3
  s_add_u32 m0, s43, 30720
  s_nop 0
  buffer_load_dwordx4 v253, s[80:83], s78 offen lds
  v_mfma_f32_32x32x16_bf16 v[108:123], v[8:11], v[152:155], v[108:123]
  s_add_u32 m0, s43, 30720
  s_nop 0
  buffer_load_dwordx4 v252, s[80:83], s78 offen offset:1024 lds
  v_mfma_f32_16x16x32_bf16 v[124:127], v[16:19], v[144:147], v[124:127]
  v_mfma_f32_16x16x32_bf16 v[128:131], v[16:19], v[148:151], v[128:131]
  v_mfma_f32_16x16x32_bf16 v[132:135], v[16:19], v[152:155], v[132:135]
  s_waitcnt lgkmcnt(0)
  v_mfma_f32_32x32x16_bf16 v[20:35], v[156:159], v[136:139], v[20:35]
  ds_read_b128 v[4:7], v237 offset:10240
  ds_read_b64_tr_b16 v[144:145], v231 offset:14336
  ds_read_b64_tr_b16 v[146:147], v231 offset:14848
  v_mfma_f32_32x32x16_bf16 v[60:75], v[136:139], v[160:163], v[60:75]
  ds_read_b64_tr_b16 v[148:149], v231 offset:16384
  ds_read_b64_tr_b16 v[150:151], v231 offset:16896
  ds_read_b64_tr_b16 v[152:153], v231 offset:18432
  v_mfma_f32_32x32x16_bf16 v[92:107], v[136:139], v[164:167], v[92:107]
  ds_read_b64_tr_b16 v[154:155], v231 offset:18944
  ds_read_b128 v[8:11], v236 offset:10240
  v_mfma_f32_32x32x16_bf16 v[44:59], v[156:159], v[140:143], v[44:59]
  s_add_u32 s78, s76, 393216
  s_sub_u32 s3, s78, 1441792
  s_min_u32 s78, s78, s3
  s_add_u32 m0, s43, 32768
  s_nop 0
  buffer_load_dwordx4 v253, s[80:83], s78 offen lds
  v_mfma_f32_32x32x16_bf16 v[76:91], v[140:143], v[160:163], v[76:91]
  s_add_u32 m0, s43, 32768
  s_nop 0
  buffer_load_dwordx4 v252, s[80:83], s78 offen offset:1024 lds
  v_mfma_f32_32x32x16_bf16 v[108:123], v[140:143], v[164:167], v[108:123]
  s_waitcnt lgkmcnt(0)
  v_mfma_f32_32x32x16_bf16 v[20:35], v[144:147], v[4:7], v[20:35]
  ds_read_b128 v[136:139], v235 offset:10240
  ds_read_b64_tr_b16 v[156:157], v230 offset:14336
  ds_read_b64_tr_b16 v[158:159], v230 offset:14848
  v_mfma_f32_32x32x16_bf16 v[60:75], v[4:7], v[148:151], v[60:75]
  ds_read_b64_tr_b16 v[160:161], v230 offset:16384
  ds_read_b64_tr_b16 v[162:163], v230 offset:16896
  ds_read_b64_tr_b16 v[164:165], v230 offset:18432
  v_mfma_f32_32x32x16_bf16 v[92:107], v[4:7], v[152:155], v[92:107]
  ds_read_b64_tr_b16 v[166:167], v230 offset:18944
  ds_read_b128 v[140:143], v234 offset:10240
  v_mfma_f32_32x32x16_bf16 v[44:59], v[144:147], v[8:11], v[44:59]
  s_add_u32 s78, s76, 458752
  s_sub_u32 s3, s78, 1441792
  s_min_u32 s78, s78, s3
  s_add_u32 m0, s43, 34816
  s_nop 0
  buffer_load_dwordx4 v253, s[80:83], s78 offen lds
  v_mfma_f32_32x32x16_bf16 v[76:91], v[8:11], v[148:151], v[76:91]
  s_add_u32 m0, s43, 34816
  s_nop 0
  buffer_load_dwordx4 v252, s[80:83], s78 offen offset:1024 lds
  v_mfma_f32_32x32x16_bf16 v[108:123], v[8:11], v[152:155], v[108:123]
  s_waitcnt vmcnt(6)
  ds_write_b128 v224, v[36:39]
  v_mfma_f32_16x16x32_bf16 v[124:127], v[16:19], v[144:147], v[124:127]
  v_mfma_f32_16x16x32_bf16 v[128:131], v[16:19], v[148:151], v[128:131]
  v_mfma_f32_16x16x32_bf16 v[132:135], v[16:19], v[152:155], v[132:135]
  s_nop 0
  ds_write_b32 v223, v124 offset:1024
  ds_write_b32 v223, v125 offset:1088
  s_nop 0
  ds_write_b32 v223, v128 offset:1152
  ds_write_b32 v223, v129 offset:1216
  s_nop 1
  ds_write_b32 v223, v132 offset:1280
  ds_write_b32 v223, v133 offset:1344
  s_waitcnt lgkmcnt(0)
  s_barrier
  v_mfma_f32_32x32x16_bf16 v[20:35], v[156:159], v[136:139], v[20:35]
  ds_read_b32 v210, v220 offset:0
  ds_read_b32 v211, v220 offset:32
  ds_read_b32 v208, v220 offset:256
  ds_read_b32 v209, v220 offset:288
  ds_read_b32 v206, v221 offset:1152
  ds_read_b32 v207, v221 offset:1280
  v_mfma_f32_32x32x16_bf16 v[60:75], v[136:139], v[160:163], v[60:75]
  ds_read_b32 v204, v219 offset:1152
  ds_read_b32 v205, v219 offset:1280
  ds_read_b128 v[184:187], v222 offset:32
  ds_read_b128 v[188:191], v222 offset:96
  ds_read_b128 v[192:195], v222 offset:160
  v_mfma_f32_32x32x16_bf16 v[92:107], v[136:139], v[164:167], v[92:107]
  ds_read_b128 v[196:199], v222 offset:224
  ds_read_b128 v[168:171], v222 offset:0
  ds_read_b128 v[172:175], v222 offset:64
  ds_read_b128 v[176:179], v222 offset:128
  ds_read_b128 v[180:183], v222 offset:192
  v_mfma_f32_32x32x16_bf16 v[44:59], v[156:159], v[140:143], v[44:59]
  s_add_u32 s78, s76, 524288
  s_sub_u32 s3, s78, 1441792
  s_min_u32 s78, s78, s3
  s_add_u32 m0, s43, 36864
  s_nop 0
  buffer_load_dwordx4 v253, s[80:83], s78 offen lds
  v_mfma_f32_32x32x16_bf16 v[76:91], v[140:143], v[160:163], v[76:91]
  s_add_u32 m0, s43, 36864
  s_nop 0
  buffer_load_dwordx4 v252, s[80:83], s78 offen offset:1024 lds
  v_mfma_f32_32x32x16_bf16 v[108:123], v[140:143], v[164:167], v[108:123]
  ds_read_b128 v[40:43], v222 offset:288
  ds_read_b128 v[124:127], v222 offset:352
  ds_read_b128 v[128:131], v222 offset:416
  ds_read_b128 v[132:135], v222 offset:480
  ds_read_b128 v[4:7], v222 offset:256
  ds_read_b128 v[8:11], v222 offset:320
  ds_read_b128 v[16:19], v222 offset:384
  ds_read_b128 v[36:39], v222 offset:448
  s_mov_b32 s52, 0x358637bd
  s_mov_b32 s54, 0x3f317218
  s_waitcnt lgkmcnt(8)
  v_pk_add_f32 v[206:207], v[206:207], v[204:205]
  v_pk_mul_f32 v[92:93], v[92:93], v[184:185]
  v_pk_mul_f32 v[94:95], v[94:95], v[186:187]
  v_pk_mul_f32 v[96:97], v[96:97], v[188:189]
  v_pk_mul_f32 v[98:99], v[98:99], v[190:191]
  v_pk_mul_f32 v[100:101], v[100:101], v[192:193]
  v_pk_mul_f32 v[102:103], v[102:103], v[194:195]
  v_pk_mul_f32 v[104:105], v[104:105], v[196:197]
  v_pk_mul_f32 v[106:107], v[106:107], v[198:199]
  v_pk_mul_f32 v[60:61], v[60:61], v[184:185]
  v_pk_mul_f32 v[62:63], v[62:63], v[186:187]
  v_pk_mul_f32 v[64:65], v[64:65], v[188:189]
  v_pk_mul_f32 v[66:67], v[66:67], v[190:191]
  v_pk_mul_f32 v[68:69], v[68:69], v[192:193]
  v_pk_mul_f32 v[70:71], v[70:71], v[194:195]
  v_pk_mul_f32 v[72:73], v[72:73], v[196:197]
  v_pk_mul_f32 v[74:75], v[74:75], v[198:199]
  v_pk_fma_f32 v[92:93], v[168:169], v[206:207], v[92:93] op_sel:[0,1,0] op_sel_hi:[1,1,1] neg_lo:[1,0,0] neg_hi:[1,0,0]
  v_pk_fma_f32 v[94:95], v[170:171], v[206:207], v[94:95] op_sel:[0,1,0] op_sel_hi:[1,1,1] neg_lo:[1,0,0] neg_hi:[1,0,0]
  v_pk_fma_f32 v[96:97], v[172:173], v[206:207], v[96:97] op_sel:[0,1,0] op_sel_hi:[1,1,1] neg_lo:[1,0,0] neg_hi:[1,0,0]
  v_pk_fma_f32 v[98:99], v[174:175], v[206:207], v[98:99] op_sel:[0,1,0] op_sel_hi:[1,1,1] neg_lo:[1,0,0] neg_hi:[1,0,0]
  v_pk_fma_f32 v[100:101], v[176:177], v[206:207], v[100:101] op_sel:[0,1,0] op_sel_hi:[1,1,1] neg_lo:[1,0,0] neg_hi:[1,0,0]
  v_pk_fma_f32 v[102:103], v[178:179], v[206:207], v[102:103] op_sel:[0,1,0] op_sel_hi:[1,1,1] neg_lo:[1,0,0] neg_hi:[1,0,0]
  v_pk_fma_f32 v[104:105], v[180:181], v[206:207], v[104:105] op_sel:[0,1,0] op_sel_hi:[1,1,1] neg_lo:[1,0,0] neg_hi:[1,0,0]
  v_pk_fma_f32 v[106:107], v[182:183], v[206:207], v[106:107] op_sel:[0,1,0] op_sel_hi:[1,1,1] neg_lo:[1,0,0] neg_hi:[1,0,0]
  v_cvt_pk_bf16_f32 v92, v92, v93
  v_cvt_pk_bf16_f32 v93, v94, v95
  v_cvt_pk_bf16_f32 v94, v96, v97
  v_cvt_pk_bf16_f32 v95, v98, v99
  v_cvt_pk_bf16_f32 v96, v100, v101
  v_cvt_pk_bf16_f32 v97, v102, v103
  v_cvt_pk_bf16_f32 v98, v104, v105
  v_cvt_pk_bf16_f32 v99, v106, v107
  v_pk_fma_f32 v[60:61], v[168:169], v[206:207], v[60:61] op_sel_hi:[1,0,1] neg_lo:[1,0,0] neg_hi:[1,0,0]
  v_pk_fma_f32 v[62:63], v[170:171], v[206:207], v[62:63] op_sel_hi:[1,0,1] neg_lo:[1,0,0] neg_hi:[1,0,0]
  v_pk_fma_f32 v[64:65], v[172:173], v[206:207], v[64:65] op_sel_hi:[1,0,1] neg_lo:[1,0,0] neg_hi:[1,0,0]
  v_pk_fma_f32 v[66:67], v[174:175], v[206:207], v[66:67] op_sel_hi:[1,0,1] neg_lo:[1,0,0] neg_hi:[1,0,0]
  v_pk_fma_f32 v[68:69], v[176:177], v[206:207], v[68:69] op_sel_hi:[1,0,1] neg_lo:[1,0,0] neg_hi:[1,0,0]
  v_pk_fma_f32 v[70:71], v[178:179], v[206:207], v[70:71] op_sel_hi:[1,0,1] neg_lo:[1,0,0] neg_hi:[1,0,0]
  v_pk_fma_f32 v[72:73], v[180:181], v[206:207], v[72:73] op_sel_hi:[1,0,1] neg_lo:[1,0,0] neg_hi:[1,0,0]
  v_pk_fma_f32 v[74:75], v[182:183], v[206:207], v[74:75] op_sel_hi:[1,0,1] neg_lo:[1,0,0] neg_hi:[1,0,0]
  v_exp_f32 v152, v60 clamp
  v_exp_f32 v153, v61 clamp
  v_exp_f32 v154, v62 clamp
  v_exp_f32 v155, v63 clamp
  v_exp_f32 v156, v64 clamp
  v_exp_f32 v157, v65 clamp
  v_exp_f32 v158, v66 clamp
  v_exp_f32 v159, v67 clamp
  v_exp_f32 v160, v68 clamp
  v_exp_f32 v161, v69 clamp
  v_exp_f32 v162, v70 clamp
  v_exp_f32 v163, v71 clamp
  v_exp_f32 v164, v72 clamp
  v_exp_f32 v165, v73 clamp
  v_exp_f32 v166, v74 clamp
  v_exp_f32 v167, v75 clamp
  v_pk_fma_f32 v[60:61], v[60:61], s[54:55], 1.0 op_sel_hi:[1,0,0]
  v_pk_fma_f32 v[62:63], v[62:63], s[54:55], 1.0 op_sel_hi:[1,0,0]
  v_pk_fma_f32 v[64:65], v[64:65], s[54:55], 1.0 op_sel_hi:[1,0,0]
  v_pk_fma_f32 v[66:67], v[66:67], s[54:55], 1.0 op_sel_hi:[1,0,0]
  v_pk_fma_f32 v[68:69], v[68:69], s[54:55], 1.0 op_sel_hi:[1,0,0]
  v_pk_fma_f32 v[70:71], v[70:71], s[54:55], 1.0 op_sel_hi:[1,0,0]
  v_pk_fma_f32 v[72:73], v[72:73], s[54:55], 1.0 op_sel_hi:[1,0,0]
  v_pk_fma_f32 v[74:75], v[74:75], s[54:55], 1.0 op_sel_hi:[1,0,0]
  v_max_f32 v60, v60, v152
  v_max_f32 v61, v61, v153
  v_max_f32 v62, v62, v154
  v_max_f32 v63, v63, v155
  v_max_f32 v64, v64, v156
  v_max_f32 v65, v65, v157
  v_max_f32 v66, v66, v158
  v_max_f32 v67, v67, v159
  v_max_f32 v68, v68, v160
  v_max_f32 v69, v69, v161
  v_max_f32 v70, v70, v162
  v_max_f32 v71, v71, v163
  v_max_f32 v72, v72, v164
  v_max_f32 v73, v73, v165
  v_max_f32 v74, v74, v166
  v_max_f32 v75, v75, v167
  v_pk_add_f32 v[60:61], v[60:61], s[52:53] op_sel_hi:[1,0]
  v_pk_add_f32 v[62:63], v[62:63], s[52:53] op_sel_hi:[1,0]
  v_pk_add_f32 v[64:65], v[64:65], s[52:53] op_sel_hi:[1,0]
  v_pk_add_f32 v[66:67], v[66:67], s[52:53] op_sel_hi:[1,0]
  v_pk_add_f32 v[68:69], v[68:69], s[52:53] op_sel_hi:[1,0]
  v_pk_add_f32 v[70:71], v[70:71], s[52:53] op_sel_hi:[1,0]
  v_pk_add_f32 v[72:73], v[72:73], s[52:53] op_sel_hi:[1,0]
  v_pk_add_f32 v[74:75], v[74:75], s[52:53] op_sel_hi:[1,0]
  v_cvt_pk_bf16_f32 v60, v60, v61
  v_cvt_pk_bf16_f32 v61, v62, v63
  v_cvt_pk_bf16_f32 v62, v64, v65
  v_cvt_pk_bf16_f32 v63, v66, v67
  v_cvt_pk_bf16_f32 v64, v68, v69
  v_cvt_pk_bf16_f32 v65, v70, v71
  v_cvt_pk_bf16_f32 v66, v72, v73
  v_cvt_pk_bf16_f32 v67, v74, v75
  ds_read_b128 v[136:139], v222 offset:1024
  ds_read_b128 v[100:103], v218 offset:1024
  ds_read_b128 v[140:143], v222 offset:1056
  ds_read_b128 v[104:107], v218 offset:1056
  ds_read_b128 v[144:147], v222 offset:1088
  ds_read_b128 v[68:71], v218 offset:1088
  ds_read_b128 v[148:151], v222 offset:1120
  ds_read_b128 v[72:75], v218 offset:1120
  v_mfma_f32_32x32x16_bf16 v[184:199], v[60:63], v[92:95], 0
  v_mfma_f32_32x32x16_bf16 v[168:183], v[60:63], v[12:15], 0
  v_mfma_f32_32x32x16_bf16 v[184:199], v[64:67], v[96:99], v[184:199]
  v_mfma_f32_32x32x16_bf16 v[168:183], v[64:67], v[12:15], v[168:183]
  s_add_u32 s78, s76, 589824
  s_sub_u32 s3, s78, 1441792
  s_min_u32 s78, s78, s3
  s_add_u32 m0, s43, 10240
  s_nop 0
  buffer_load_dwordx4 v253, s[80:83], s78 offen lds
  buffer_load_dwordx4 v252, s[80:83], s78 offen offset:1024 lds
  s_add_u32 s78, s76, 655360
  s_sub_u32 s3, s78, 1441792
  s_min_u32 s78, s78, s3
  s_add_u32 m0, s43, 12288
  s_nop 0
  buffer_load_dwordx4 v253, s[80:83], s78 offen lds
  buffer_load_dwordx4 v252, s[80:83], s78 offen offset:1024 lds
  s_waitcnt lgkmcnt(8)
  v_pk_mul_f32 v[108:109], v[108:109], v[40:41]
  v_pk_mul_f32 v[110:111], v[110:111], v[42:43]
  v_pk_mul_f32 v[112:113], v[112:113], v[124:125]
  v_pk_mul_f32 v[114:115], v[114:115], v[126:127]
  v_pk_mul_f32 v[116:117], v[116:117], v[128:129]
  v_pk_mul_f32 v[118:119], v[118:119], v[130:131]
  v_pk_mul_f32 v[120:121], v[120:121], v[132:133]
  v_pk_mul_f32 v[122:123], v[122:123], v[134:135]
  v_pk_mul_f32 v[76:77], v[76:77], v[40:41]
  v_pk_mul_f32 v[78:79], v[78:79], v[42:43]
  v_pk_mul_f32 v[80:81], v[80:81], v[124:125]
  v_pk_mul_f32 v[82:83], v[82:83], v[126:127]
  v_pk_mul_f32 v[84:85], v[84:85], v[128:129]
  v_pk_mul_f32 v[86:87], v[86:87], v[130:131]
  v_pk_mul_f32 v[88:89], v[88:89], v[132:133]
  v_pk_mul_f32 v[90:91], v[90:91], v[134:135]
  v_pk_fma_f32 v[108:109], v[4:5], v[206:207], v[108:109] op_sel:[0,1,0] op_sel_hi:[1,1,1] neg_lo:[1,0,0] neg_hi:[1,0,0]
  v_pk_fma_f32 v[110:111], v[6:7], v[206:207], v[110:111] op_sel:[0,1,0] op_sel_hi:[1,1,1] neg_lo:[1,0,0] neg_hi:[1,0,0]
  v_pk_fma_f32 v[112:113], v[8:9], v[206:207], v[112:113] op_sel:[0,1,0] op_sel_hi:[1,1,1] neg_lo:[1,0,0] neg_hi:[1,0,0]
  v_pk_fma_f32 v[114:115], v[10:11], v[206:207], v[114:115] op_sel:[0,1,0] op_sel_hi:[1,1,1] neg_lo:[1,0,0] neg_hi:[1,0,0]
  v_pk_fma_f32 v[116:117], v[16:17], v[206:207], v[116:117] op_sel:[0,1,0] op_sel_hi:[1,1,1] neg_lo:[1,0,0] neg_hi:[1,0,0]
  v_pk_fma_f32 v[118:119], v[18:19], v[206:207], v[118:119] op_sel:[0,1,0] op_sel_hi:[1,1,1] neg_lo:[1,0,0] neg_hi:[1,0,0]
  v_pk_fma_f32 v[120:121], v[36:37], v[206:207], v[120:121] op_sel:[0,1,0] op_sel_hi:[1,1,1] neg_lo:[1,0,0] neg_hi:[1,0,0]
  v_pk_fma_f32 v[122:123], v[38:39], v[206:207], v[122:123] op_sel:[0,1,0] op_sel_hi:[1,1,1] neg_lo:[1,0,0] neg_hi:[1,0,0]
  v_cvt_pk_bf16_f32 v108, v108, v109
  v_cvt_pk_bf16_f32 v109, v110, v111
  v_cvt_pk_bf16_f32 v110, v112, v113
  v_cvt_pk_bf16_f32 v111, v114, v115
  v_cvt_pk_bf16_f32 v112, v116, v117
  v_cvt_pk_bf16_f32 v113, v118, v119
  v_cvt_pk_bf16_f32 v114, v120, v121
  v_cvt_pk_bf16_f32 v115, v122, v123
  v_pk_fma_f32 v[76:77], v[4:5], v[206:207], v[76:77] op_sel_hi:[1,0,1] neg_lo:[1,0,0] neg_hi:[1,0,0]
  v_pk_fma_f32 v[78:79], v[6:7], v[206:207], v[78:79] op_sel_hi:[1,0,1] neg_lo:[1,0,0] neg_hi:[1,0,0]
  v_pk_fma_f32 v[80:81], v[8:9], v[206:207], v[80:81] op_sel_hi:[1,0,1] neg_lo:[1,0,0] neg_hi:[1,0,0]
  v_pk_fma_f32 v[82:83], v[10:11], v[206:207], v[82:83] op_sel_hi:[1,0,1] neg_lo:[1,0,0] neg_hi:[1,0,0]
  v_pk_fma_f32 v[84:85], v[16:17], v[206:207], v[84:85] op_sel_hi:[1,0,1] neg_lo:[1,0,0] neg_hi:[1,0,0]
  v_pk_fma_f32 v[86:87], v[18:19], v[206:207], v[86:87] op_sel_hi:[1,0,1] neg_lo:[1,0,0] neg_hi:[1,0,0]
  v_pk_fma_f32 v[88:89], v[36:37], v[206:207], v[88:89] op_sel_hi:[1,0,1] neg_lo:[1,0,0] neg_hi:[1,0,0]
  v_pk_fma_f32 v[90:91], v[38:39], v[206:207], v[90:91] op_sel_hi:[1,0,1] neg_lo:[1,0,0] neg_hi:[1,0,0]
  v_exp_f32 v152, v76 clamp
  v_exp_f32 v153, v77 clamp
  v_exp_f32 v154, v78 clamp
  v_exp_f32 v155, v79 clamp
  v_exp_f32 v156, v80 clamp
  v_exp_f32 v157, v81 clamp
  v_exp_f32 v158, v82 clamp
  v_exp_f32 v159, v83 clamp
  v_exp_f32 v160, v84 clamp
  v_exp_f32 v161, v85 clamp
  v_exp_f32 v162, v86 clamp
  v_exp_f32 v163, v87 clamp
  v_exp_f32 v164, v88 clamp
  v_exp_f32 v165, v89 clamp
  v_exp_f32 v166, v90 clamp
  v_exp_f32 v167, v91 clamp
  v_pk_fma_f32 v[76:77], v[76:77], s[54:55], 1.0 op_sel_hi:[1,0,0]
  v_pk_fma_f32 v[78:79], v[78:79], s[54:55], 1.0 op_sel_hi:[1,0,0]
  v_pk_fma_f32 v[80:81], v[80:81], s[54:55], 1.0 op_sel_hi:[1,0,0]
  v_pk_fma_f32 v[82:83], v[82:83], s[54:55], 1.0 op_sel_hi:[1,0,0]
  v_pk_fma_f32 v[84:85], v[84:85], s[54:55], 1.0 op_sel_hi:[1,0,0]
  v_pk_fma_f32 v[86:87], v[86:87], s[54:55], 1.0 op_sel_hi:[1,0,0]
  v_pk_fma_f32 v[88:89], v[88:89], s[54:55], 1.0 op_sel_hi:[1,0,0]
  v_pk_fma_f32 v[90:91], v[90:91], s[54:55], 1.0 op_sel_hi:[1,0,0]
  v_max_f32 v76, v76, v152
  v_max_f32 v77, v77, v153
  v_max_f32 v78, v78, v154
  v_max_f32 v79, v79, v155
  v_max_f32 v80, v80, v156
  v_max_f32 v81, v81, v157
  v_max_f32 v82, v82, v158
  v_max_f32 v83, v83, v159
  v_max_f32 v84, v84, v160
  v_max_f32 v85, v85, v161
  v_max_f32 v86, v86, v162
  v_max_f32 v87, v87, v163
  v_max_f32 v88, v88, v164
  v_max_f32 v89, v89, v165
  v_max_f32 v90, v90, v166
  v_max_f32 v91, v91, v167
  v_pk_add_f32 v[76:77], v[76:77], s[52:53] op_sel_hi:[1,0]
  v_pk_add_f32 v[78:79], v[78:79], s[52:53] op_sel_hi:[1,0]
  v_pk_add_f32 v[80:81], v[80:81], s[52:53] op_sel_hi:[1,0]
  v_pk_add_f32 v[82:83], v[82:83], s[52:53] op_sel_hi:[1,0]
  v_pk_add_f32 v[84:85], v[84:85], s[52:53] op_sel_hi:[1,0]
  v_pk_add_f32 v[86:87], v[86:87], s[52:53] op_sel_hi:[1,0]
  v_pk_add_f32 v[88:89], v[88:89], s[52:53] op_sel_hi:[1,0]
  v_pk_add_f32 v[90:91], v[90:91], s[52:53] op_sel_hi:[1,0]
  v_cvt_pk_bf16_f32 v76, v76, v77
  v_cvt_pk_bf16_f32 v77, v78, v79
  v_cvt_pk_bf16_f32 v78, v80, v81
  v_cvt_pk_bf16_f32 v79, v82, v83
  v_cvt_pk_bf16_f32 v80, v84, v85
  v_cvt_pk_bf16_f32 v81, v86, v87
  v_cvt_pk_bf16_f32 v82, v88, v89
  v_cvt_pk_bf16_f32 v83, v90, v91
  v_mfma_f32_32x32x16_bf16 v[184:199], v[76:79], v[108:111], v[184:199]
  v_mfma_f32_32x32x16_bf16 v[168:183], v[76:79], v[12:15], v[168:183]
  v_mfma_f32_32x32x16_bf16 v[184:199], v[80:83], v[112:115], v[184:199]
  v_mfma_f32_32x32x16_bf16 v[168:183], v[80:83], v[12:15], v[168:183]
  v_mov_b32 v206, s42
  v_lshlrev_b32 v207, 13, v255
  v_and_b32 v204, 16, v255
  v_cmp_eq_u32 vcc, 0, v204
  s_add_u32 s45, s95, 4096
  v_mov_b32 v204, 1
  v_lshlrev_b32 v205, 7, v255
  s_nop 4
  v_cndmask_b32 v160, v176, v168, vcc
  v_cndmask_b32 v161, v177, v169, vcc
  v_cndmask_b32 v162, v178, v170, vcc
  v_cndmask_b32 v163, v179, v171, vcc
  v_cndmask_b32 v164, v180, v172, vcc
  v_cndmask_b32 v165, v181, v173, vcc
  v_cndmask_b32 v166, v182, v174, vcc
  v_cndmask_b32 v167, v183, v175, vcc
  v_cndmask_b32 v152, v192, v184, vcc
  v_cndmask_b32 v153, v193, v185, vcc
  v_cndmask_b32 v154, v194, v186, vcc
  v_cndmask_b32 v155, v195, v187, vcc
  v_cndmask_b32 v156, v196, v188, vcc
  v_cndmask_b32 v157, v197, v189, vcc
  v_cndmask_b32 v158, v198, v190, vcc
  v_cndmask_b32 v159, v199, v191, vcc
  ds_write_b128 v214, v[160:163] offset:256
  ds_write_b128 v214, v[164:167] offset:800
  v_pk_mul_f32 v[152:153], v[152:153], s[54:55] op_sel_hi:[1,0]
  v_pk_mul_f32 v[154:155], v[154:155], s[54:55] op_sel_hi:[1,0]
  v_pk_mul_f32 v[156:157], v[156:157], s[54:55] op_sel_hi:[1,0]
  v_pk_mul_f32 v[158:159], v[158:159], s[54:55] op_sel_hi:[1,0]
  ds_write_b128 v213, v[152:155] offset:0
  ds_write_b128 v213, v[156:159] offset:544
  s_waitcnt lgkmcnt(4)
  v_pk_add_f32 v[136:137], v[136:137], v[100:101]
  v_pk_add_f32 v[138:139], v[138:139], v[102:103]
  v_pk_add_f32 v[140:141], v[140:141], v[104:105]
  v_pk_add_f32 v[142:143], v[142:143], v[106:107]
  v_pk_add_f32 v[144:145], v[144:145], v[68:69]
  v_pk_add_f32 v[146:147], v[146:147], v[70:71]
  v_pk_add_f32 v[148:149], v[148:149], v[72:73]
  v_pk_add_f32 v[150:151], v[150:151], v[74:75]
  v_pk_mul_f32 v[20:21], v[20:21], v[210:211] op_sel:[0,1] op_sel_hi:[1,1]
  v_pk_mul_f32 v[22:23], v[22:23], v[210:211] op_sel:[0,1] op_sel_hi:[1,1]
  v_pk_mul_f32 v[24:25], v[24:25], v[210:211] op_sel:[0,1] op_sel_hi:[1,1]
  v_pk_mul_f32 v[26:27], v[26:27], v[210:211] op_sel:[0,1] op_sel_hi:[1,1]
  v_pk_mul_f32 v[28:29], v[28:29], v[210:211] op_sel:[0,1] op_sel_hi:[1,1]
  v_pk_mul_f32 v[30:31], v[30:31], v[210:211] op_sel:[0,1] op_sel_hi:[1,1]
  v_pk_mul_f32 v[32:33], v[32:33], v[210:211] op_sel:[0,1] op_sel_hi:[1,1]
  v_pk_mul_f32 v[34:35], v[34:35], v[210:211] op_sel:[0,1] op_sel_hi:[1,1]
  s_waitcnt lgkmcnt(0)
  s_barrier
  ds_read_b32 v184, v212 offset:0
  ds_read_b32 v192, v212 offset:4352
  ds_read_b32 v185, v212 offset:1024
  ds_read_b32 v193, v212 offset:5376
  ds_read_b32 v186, v212 offset:2048
  ds_read_b32 v194, v212 offset:6400
  ds_read_b32 v187, v212 offset:3072
  ds_read_b32 v195, v212 offset:7424
  ds_read_b32 v188, v212 offset:4096
  ds_read_b32 v196, v212 offset:8448
  v_pk_fma_f32 v[20:21], v[136:137], v[210:211], v[20:21] op_sel_hi:[1,0,1] neg_lo:[1,0,0] neg_hi:[1,0,0]
  v_pk_fma_f32 v[22:23], v[138:139], v[210:211], v[22:23] op_sel_hi:[1,0,1] neg_lo:[1,0,0] neg_hi:[1,0,0]
  v_pk_fma_f32 v[24:25], v[140:141], v[210:211], v[24:25] op_sel_hi:[1,0,1] neg_lo:[1,0,0] neg_hi:[1,0,0]
  v_pk_fma_f32 v[26:27], v[142:143], v[210:211], v[26:27] op_sel_hi:[1,0,1] neg_lo:[1,0,0] neg_hi:[1,0,0]
  v_pk_fma_f32 v[28:29], v[144:145], v[210:211], v[28:29] op_sel_hi:[1,0,1] neg_lo:[1,0,0] neg_hi:[1,0,0]
  v_pk_fma_f32 v[30:31], v[146:147], v[210:211], v[30:31] op_sel_hi:[1,0,1] neg_lo:[1,0,0] neg_hi:[1,0,0]
  v_pk_fma_f32 v[32:33], v[148:149], v[210:211], v[32:33] op_sel_hi:[1,0,1] neg_lo:[1,0,0] neg_hi:[1,0,0]
  v_pk_fma_f32 v[34:35], v[150:151], v[210:211], v[34:35] op_sel_hi:[1,0,1] neg_lo:[1,0,0] neg_hi:[1,0,0]
  v_pk_mul_f32 v[44:45], v[44:45], v[208:209] op_sel:[0,1] op_sel_hi:[1,1]
  v_pk_mul_f32 v[46:47], v[46:47], v[208:209] op_sel:[0,1] op_sel_hi:[1,1]
  v_pk_mul_f32 v[48:49], v[48:49], v[208:209] op_sel:[0,1] op_sel_hi:[1,1]
  v_pk_mul_f32 v[50:51], v[50:51], v[208:209] op_sel:[0,1] op_sel_hi:[1,1]
  v_pk_mul_f32 v[52:53], v[52:53], v[208:209] op_sel:[0,1] op_sel_hi:[1,1]
  v_pk_mul_f32 v[54:55], v[54:55], v[208:209] op_sel:[0,1] op_sel_hi:[1,1]
  v_pk_mul_f32 v[56:57], v[56:57], v[208:209] op_sel:[0,1] op_sel_hi:[1,1]
  v_pk_mul_f32 v[58:59], v[58:59], v[208:209] op_sel:[0,1] op_sel_hi:[1,1]
  s_waitcnt lgkmcnt(0)
  v_add_f32 v184, v184, v192
  buffer_atomic_add_f32 v184, v212, s[32:35], s95 offen offset:0 sc0
  v_add_f32 v185, v185, v193
  buffer_atomic_add_f32 v185, v212, s[32:35], s95 offen offset:1024 sc0
  v_add_f32 v186, v186, v194
  buffer_atomic_add_f32 v186, v212, s[32:35], s95 offen offset:2048 sc0
  v_add_f32 v187, v187, v195
  buffer_atomic_add_f32 v187, v212, s[32:35], s95 offen offset:3072 sc0
  s_cmp_lg_u32 s26, 0
  s_cbranch_scc1 AT5_64
  v_add_f32 v188, v188, v196
  buffer_atomic_add_f32 v188, v212, s[32:35], s45 offen sc0
AT5_64:
  v_exp_f32 v152, v20 clamp
  v_exp_f32 v153, v21 clamp
  v_exp_f32 v154, v22 clamp
  v_exp_f32 v155, v23 clamp
  v_exp_f32 v156, v24 clamp
  v_exp_f32 v157, v25 clamp
  v_exp_f32 v158, v26 clamp
  v_exp_f32 v159, v27 clamp
  v_exp_f32 v160, v28 clamp
  v_exp_f32 v161, v29 clamp
  v_exp_f32 v162, v30 clamp
  v_exp_f32 v163, v31 clamp
  v_exp_f32 v164, v32 clamp
  v_exp_f32 v165, v33 clamp
  v_exp_f32 v166, v34 clamp
  v_exp_f32 v167, v35 clamp
  v_pk_fma_f32 v[20:21], v[20:21], s[54:55], 1.0 op_sel_hi:[1,0,0]
  v_pk_fma_f32 v[22:23], v[22:23], s[54:55], 1.0 op_sel_hi:[1,0,0]
  v_pk_fma_f32 v[24:25], v[24:25], s[54:55], 1.0 op_sel_hi:[1,0,0]
  v_pk_fma_f32 v[26:27], v[26:27], s[54:55], 1.0 op_sel_hi:[1,0,0]
  v_pk_fma_f32 v[28:29], v[28:29], s[54:55], 1.0 op_sel_hi:[1,0,0]
  v_pk_fma_f32 v[30:31], v[30:31], s[54:55], 1.0 op_sel_hi:[1,0,0]
  v_pk_fma_f32 v[32:33], v[32:33], s[54:55], 1.0 op_sel_hi:[1,0,0]
  v_pk_fma_f32 v[34:35], v[34:35], s[54:55], 1.0 op_sel_hi:[1,0,0]
  v_max_f32 v20, v20, v152
  v_max_f32 v21, v21, v153
  v_max_f32 v22, v22, v154
  v_max_f32 v23, v23, v155
  v_max_f32 v24, v24, v156
  v_max_f32 v25, v25, v157
  v_max_f32 v26, v26, v158
  v_max_f32 v27, v27, v159
  v_max_f32 v28, v28, v160
  v_max_f32 v29, v29, v161
  v_max_f32 v30, v30, v162
  v_max_f32 v31, v31, v163
  v_max_f32 v32, v32, v164
  v_max_f32 v33, v33, v165
  v_max_f32 v34, v34, v166
  v_max_f32 v35, v35, v167
  v_pk_add_f32 v[20:21], v[20:21], s[52:53] op_sel_hi:[1,0]
  v_pk_add_f32 v[22:23], v[22:23], s[52:53] op_sel_hi:[1,0]
  v_pk_add_f32 v[24:25], v[24:25], s[52:53] op_sel_hi:[1,0]
  v_pk_add_f32 v[26:27], v[26:27], s[52:53] op_sel_hi:[1,0]
  v_pk_add_f32 v[28:29], v[28:29], s[52:53] op_sel_hi:[1,0]
  v_pk_add_f32 v[30:31], v[30:31], s[52:53] op_sel_hi:[1,0]
  v_pk_add_f32 v[32:33], v[32:33], s[52:53] op_sel_hi:[1,0]
  v_pk_add_f32 v[34:35], v[34:35], s[52:53] op_sel_hi:[1,0]
  v_cvt_pk_bf16_f32 v20, v20, v21
  v_cvt_pk_bf16_f32 v21, v22, v23
  v_cvt_pk_bf16_f32 v22, v24, v25
  v_cvt_pk_bf16_f32 v23, v26, v27
  v_cvt_pk_bf16_f32 v24, v28, v29
  v_cvt_pk_bf16_f32 v25, v30, v31
  v_cvt_pk_bf16_f32 v26, v32, v33
  v_cvt_pk_bf16_f32 v27, v34, v35
  v_pk_fma_f32 v[44:45], v[136:137], v[208:209], v[44:45] op_sel_hi:[1,0,1] neg_lo:[1,0,0] neg_hi:[1,0,0]
  v_pk_fma_f32 v[46:47], v[138:139], v[208:209], v[46:47] op_sel_hi:[1,0,1] neg_lo:[1,0,0] neg_hi:[1,0,0]
  v_pk_fma_f32 v[48:49], v[140:141], v[208:209], v[48:49] op_sel_hi:[1,0,1] neg_lo:[1,0,0] neg_hi:[1,0,0]
  v_pk_fma_f32 v[50:51], v[142:143], v[208:209], v[50:51] op_sel_hi:[1,0,1] neg_lo:[1,0,0] neg_hi:[1,0,0]
  v_pk_fma_f32 v[52:53], v[144:145], v[208:209], v[52:53] op_sel_hi:[1,0,1] neg_lo:[1,0,0] neg_hi:[1,0,0]
  v_pk_fma_f32 v[54:55], v[146:147], v[208:209], v[54:55] op_sel_hi:[1,0,1] neg_lo:[1,0,0] neg_hi:[1,0,0]
  v_pk_fma_f32 v[56:57], v[148:149], v[208:209], v[56:57] op_sel_hi:[1,0,1] neg_lo:[1,0,0] neg_hi:[1,0,0]
  v_pk_fma_f32 v[58:59], v[150:151], v[208:209], v[58:59] op_sel_hi:[1,0,1] neg_lo:[1,0,0] neg_hi:[1,0,0]
  v_exp_f32 v152, v44 clamp
  v_exp_f32 v153, v45 clamp
  v_exp_f32 v154, v46 clamp
  v_exp_f32 v155, v47 clamp
  v_exp_f32 v156, v48 clamp
  v_exp_f32 v157, v49 clamp
  v_exp_f32 v158, v50 clamp
  v_exp_f32 v159, v51 clamp
  v_exp_f32 v160, v52 clamp
  v_exp_f32 v161, v53 clamp
  v_exp_f32 v162, v54 clamp
  v_exp_f32 v163, v55 clamp
  v_exp_f32 v164, v56 clamp
  v_exp_f32 v165, v57 clamp
  v_exp_f32 v166, v58 clamp
  v_exp_f32 v167, v59 clamp
  v_pk_fma_f32 v[44:45], v[44:45], s[54:55], 1.0 op_sel_hi:[1,0,0]
  v_pk_fma_f32 v[46:47], v[46:47], s[54:55], 1.0 op_sel_hi:[1,0,0]
  v_pk_fma_f32 v[48:49], v[48:49], s[54:55], 1.0 op_sel_hi:[1,0,0]
  v_pk_fma_f32 v[50:51], v[50:51], s[54:55], 1.0 op_sel_hi:[1,0,0]
  v_pk_fma_f32 v[52:53], v[52:53], s[54:55], 1.0 op_sel_hi:[1,0,0]
  v_pk_fma_f32 v[54:55], v[54:55], s[54:55], 1.0 op_sel_hi:[1,0,0]
  v_pk_fma_f32 v[56:57], v[56:57], s[54:55], 1.0 op_sel_hi:[1,0,0]
  v_pk_fma_f32 v[58:59], v[58:59], s[54:55], 1.0 op_sel_hi:[1,0,0]
  v_max_f32 v44, v44, v152
  v_max_f32 v45, v45, v153
  v_max_f32 v46, v46, v154
  v_max_f32 v47, v47, v155
  v_max_f32 v48, v48, v156
  v_max_f32 v49, v49, v157
  v_max_f32 v50, v50, v158
  v_max_f32 v51, v51, v159
  v_max_f32 v52, v52, v160
  v_max_f32 v53, v53, v161
  v_max_f32 v54, v54, v162
  v_max_f32 v55, v55, v163
  v_max_f32 v56, v56, v164
  v_max_f32 v57, v57, v165
  v_max_f32 v58, v58, v166
  v_max_f32 v59, v59, v167
  v_pk_add_f32 v[44:45], v[44:45], s[52:53] op_sel_hi:[1,0]
  v_pk_add_f32 v[46:47], v[46:47], s[52:53] op_sel_hi:[1,0]
  v_pk_add_f32 v[48:49], v[48:49], s[52:53] op_sel_hi:[1,0]
  v_pk_add_f32 v[50:51], v[50:51], s[52:53] op_sel_hi:[1,0]
  v_pk_add_f32 v[52:53], v[52:53], s[52:53] op_sel_hi:[1,0]
  v_pk_add_f32 v[54:55], v[54:55], s[52:53] op_sel_hi:[1,0]
  v_pk_add_f32 v[56:57], v[56:57], s[52:53] op_sel_hi:[1,0]
  v_pk_add_f32 v[58:59], v[58:59], s[52:53] op_sel_hi:[1,0]
  v_cvt_pk_bf16_f32 v44, v44, v45
  v_cvt_pk_bf16_f32 v45, v46, v47
  v_cvt_pk_bf16_f32 v46, v48, v49
  v_cvt_pk_bf16_f32 v47, v50, v51
  v_cvt_pk_bf16_f32 v48, v52, v53
  v_cvt_pk_bf16_f32 v49, v54, v55
  v_cvt_pk_bf16_f32 v50, v56, v57
  v_cvt_pk_bf16_f32 v51, v58, v59
  s_waitcnt vmcnt(0)
  s_barrier
  s_cmp_lg_u32 s26, 0
  s_cbranch_scc1 QF_65
  s_mov_b64 exec, 0x1
  buffer_store_dword v206, v207, s[32:35], s94 offen sc1
  s_mov_b64 exec, -1
QF_65:
  v_and_b32 v251, 15, v255
  v_lshlrev_b32 v251, 7, v251
  s_lshl_b32 s44, s57, 11
  s_add_u32 s44, s44, 0x640000
  v_add_u32 v251, s44, v251
  v_and_b32 v250, 31, v255
  v_min_u32 v250, 16, v250
  v_lshlrev_b32 v250, 4, v250
  v_lshrrev_b32 v204, 5, v255
  v_mul_u32_u24 v204, 272, v204
  v_add_u32 v250, v250, v204
  s_mul_i32 s46, s59, 2176
  s_add_u32 s46, s46, s95
  s_add_u32 s78, s76, 720896
  s_sub_u32 s3, s78, 1441792
  s_min_u32 s78, s78, s3
  s_add_u32 m0, s43, 38912
  s_nop 0
  buffer_load_dwordx4 v253, s[80:83], s78 offen lds
  buffer_load_dwordx4 v252, s[80:83], s78 offen offset:1024 lds
  s_add_u32 s78, s76, 786432
  s_sub_u32 s3, s78, 1441792
  s_min_u32 s78, s78, s3
  s_add_u32 m0, s43, 0
  s_nop 0
  buffer_load_dwordx4 v253, s[80:83], s78 offen lds
  buffer_load_dwordx4 v252, s[80:83], s78 offen offset:1024 lds
  s_add_u32 s78, s77, 0
  s_and_b32 s78, s78, 7
  s_lshl_b32 s78, s78, 14
  s_add_u32 m0, s43, 2048
  s_nop 0
  buffer_load_dwordx4 v229, s[88:91], s78 offen lds
  buffer_load_dwordx4 v228, s[88:91], s78 offen offset:1024 lds
  s_add_u32 s78, s77, 1
  s_and_b32 s78, s78, 7
  s_lshl_b32 s78, s78, 14
  s_add_u32 m0, s43, 4096
  s_nop 0
  buffer_load_dwordx4 v229, s[88:91], s78 offen lds
  buffer_load_dwordx4 v228, s[88:91], s78 offen offset:1024 lds
  s_add_u32 s78, s77, 2
  s_and_b32 s78, s78, 7
  s_lshl_b32 s78, s78, 14
  s_add_u32 m0, s43, 6144
  s_nop 0
  buffer_load_dwordx4 v229, s[88:91], s78 offen lds
  buffer_load_dwordx4 v228, s[88:91], s78 offen offset:1024 lds
  s_add_u32 s78, s77, 3
  s_and_b32 s78, s78, 7
  s_lshl_b32 s78, s78, 14
  s_add_u32 m0, s43, 8192
  s_nop 0
  buffer_load_dwordx4 v229, s[88:91], s78 offen lds
  buffer_load_dwordx4 v228, s[88:91], s78 offen offset:1024 lds
  s_add_u32 s78, s77, 4
  s_and_b32 s78, s78, 7
  s_lshl_b32 s78, s78, 14
  s_add_u32 m0, s43, 14336
  s_nop 0
  buffer_load_dwordx4 v229, s[88:91], s78 offen lds
  buffer_load_dwordx4 v228, s[88:91], s78 offen offset:1024 lds
  s_add_u32 s78, s77, 5
  s_and_b32 s78, s78, 7
  s_lshl_b32 s78, s78, 14
  s_add_u32 m0, s43, 16384
  s_nop 0
  buffer_load_dwordx4 v229, s[88:91], s78 offen lds
  buffer_load_dwordx4 v228, s[88:91], s78 offen offset:1024 lds
  s_add_u32 s78, s77, 6
  s_and_b32 s78, s78, 7
  s_lshl_b32 s78, s78, 14
  s_add_u32 m0, s43, 18432
  s_nop 0
  buffer_load_dwordx4 v229, s[88:91], s78 offen lds
  buffer_load_dwordx4 v228, s[88:91], s78 offen offset:1024 lds
  ds_read_b64_tr_b16 a[0:1], v245 offset:20480
  ds_read_b64_tr_b16 a[2:3], v245 offset:21504
  ds_read_b64_tr_b16 a[4:5], v244 offset:20480
  ds_read_b64_tr_b16 a[6:7], v244 offset:21504
  s_waitcnt lgkmcnt(0)
  s_add_u32 s78, s77, 7
  s_and_b32 s78, s78, 7
  s_lshl_b32 s78, s78, 14
  s_add_u32 m0, s43, 20480
  s_nop 0
  buffer_load_dwordx4 v229, s[88:91], s78 offen lds
  buffer_load_dwordx4 v228, s[88:91], s78 offen offset:1024 lds
  ds_read_b64_tr_b16 a[8:9], v245 offset:22528
  ds_read_b64_tr_b16 a[10:11], v245 offset:23552
  ds_read_b64_tr_b16 a[12:13], v244 offset:22528
  ds_read_b64_tr_b16 a[14:15], v244 offset:23552
  s_waitcnt lgkmcnt(0)
  s_add_u32 s78, s76, 851968
  s_sub_u32 s3, s78, 1441792
  s_min_u32 s78, s78, s3
  s_add_u32 m0, s43, 22528
  s_nop 0
  buffer_load_dwordx4 v253, s[80:83], s78 offen lds
  buffer_load_dwordx4 v252, s[80:83], s78 offen offset:1024 lds
  ds_read_b64_tr_b16 a[16:17], v245 offset:24576
  ds_read_b64_tr_b16 a[18:19], v245 offset:25600
  ds_read_b64_tr_b16 a[20:21], v244 offset:24576
  ds_read_b64_tr_b16 a[22:23], v244 offset:25600
  s_waitcnt lgkmcnt(0)
  s_add_u32 s78, s76, 917504
  s_sub_u32 s3, s78, 1441792
  s_min_u32 s78, s78, s3
  s_add_u32 m0, s43, 24576
  s_nop 0
  buffer_load_dwordx4 v253, s[80:83], s78 offen lds
  buffer_load_dwordx4 v252, s[80:83], s78 offen offset:1024 lds
  ds_read_b64_tr_b16 a[24:25], v245 offset:26624
  ds_read_b64_tr_b16 a[26:27], v245 offset:27648
  ds_read_b64_tr_b16 a[28:29], v244 offset:26624
  ds_read_b64_tr_b16 a[30:31], v244 offset:27648
  s_waitcnt lgkmcnt(0)
  s_add_u32 s78, s76, 983040
  s_sub_u32 s3, s78, 1441792
  s_min_u32 s78, s78, s3
  s_add_u32 m0, s43, 26624
  s_nop 0
  buffer_load_dwordx4 v253, s[80:83], s78 offen lds
  buffer_load_dwordx4 v252, s[80:83], s78 offen offset:1024 lds
  buffer_load_dword v249, v251, s[32:35], 0 offen sc1
  s_mul_i32 s44, s26, 240306
  s_lshr_b32 s44, s44, 16
  s_mul_i32 s45, s26, 22
  s_add_u32 s45, s45, 21
  s_min_u32 s45, s45, 85
  s_mul_i32 s45, s45, 10923
  s_lshr_b32 s45, s45, 16
  v_bfe_u32 v248, v255, 2, 3
  v_add_u32 v248, s44, v248
  v_min_u32 v248, s45, v248
  v_lshrrev_b32 v247, 2, v248
  v_and_b32 v248, 3, v248
  v_lshlrev_b32 v248, 2, v248
  v_lshl_add_u32 v248, v247, 5, v248
  v_bfe_u32 v247, v255, 1, 1
  v_lshl_add_u32 v248, v247, 4, v248
  v_and_b32 v247, 1, v255
  v_lshl_add_u32 v248, v247, 7, v248
  s_and_b32 s44, s74, 1
  s_lshl_b32 s44, s44, 8
  s_lshr_b32 s45, s74, 1
  s_add_u32 s44, s44, s45
  v_add_u32 v248, s44, v248
  v_lshlrev_b32 v248, 5, v248
  v_add_u32 v248, 0x620000, v248
  v_and_b32 v247, 3, v255
  v_lshlrev_b32 v247, 8, v247
  s_lshr_b32 s44, s73, 1
  s_lshl_b32 s44, s44, 2
  s_add_u32 s44, s44, s26
  s_lshl_b32 s44, s44, 3
  s_and_b32 s45, s73, 1
  s_add_u32 s44, s44, s45
  s_lshl_b32 s44, s44, 7
  s_add_u32 s44, s44, 0x680000
  v_add_u32 v247, s44, v247
  s_lshl_b32 s44, s26, 19
  s_lshl_b32 s45, s73, 11
  s_add_u32 s44, s44, s45
  s_lshr_b32 s45, s26, 1
  s_lshl_b32 s45, s45, 10
  s_add_u32 s44, s44, s45
  s_add_u32 s44, s44, 0x400000
  v_add_u32 v246, s44, v254
  v_xor_b32 v241, 1024, v246
  s_mul_i32 s44, s26, 240306
  s_lshr_b32 s44, s44, 16
  s_mul_i32 s45, s26, 22
  s_add_u32 s45, s45, 21
  s_min_u32 s45, s45, 85
  s_mul_i32 s45, s45, 10923
  s_lshr_b32 s45, s45, 16
  v_bfe_u32 v240, v255, 2, 3
  v_add_u32 v240, s44, v240
  v_min_u32 v240, s45, v240
  v_mul_u32_u24 v240, 6, v240
  v_bfe_u32 v239, v255, 1, 1
  v_mad_u32_u24 v240, v239, 3, v240
  v_add_u32 v240, 2, v240
  v_lshlrev_b32 v240, 14, v240
  v_and_b32 v239, 1, v255
  v_lshl_add_u32 v240, v239, 9, v240
  s_lshl_b32 s44, s74, 10
  v_add_u32 v240, s44, v240
  buffer_load_dword v239, v248, s[32:35], 0 offen sc1
  v_and_b32 v237, 31, v255
  v_lshrrev_b32 v238, 5, v255
  v_lshlrev_b32 v238, 4, v238
  v_lshl_add_u32 v238, v237, 10, v238
  v_lshlrev_b32 v237, 1, v237
  s_lshr_b32 s60, s26, 1
  s_lshl_b32 s61, s73, 1
  s_add_u32 s60, s60, s61
  s_lshl_b32 s61, s60, 6
  s_lshl_b32 s60, s60, 9
  s_and_b32 s64, s26, 1
  s_add_u32 s60, s60, s64
  s_lshl_b32 s64, s74, 1
  s_add_u32 s60, s60, s64
  s_lshl_b32 s60, s60, 6
  s_mov_b32 s64, s18
  s_mov_b32 s65, s19
  s_mov_b32 s66, 0x1000
  s_mov_b32 s67, 0x20000
  ds_read_b64_tr_b16 a[32:33], v245 offset:28672
  ds_read_b64_tr_b16 a[34:35], v245 offset:29696
  ds_read_b64_tr_b16 a[36:37], v244 offset:28672
  ds_read_b64_tr_b16 a[38:39], v244 offset:29696
  s_waitcnt lgkmcnt(0)
  s_add_u32 s78, s76, 1048576
  s_sub_u32 s3, s78, 1441792
  s_min_u32 s78, s78, s3
  s_add_u32 m0, s43, 28672
  s_nop 0
  buffer_load_dwordx4 v253, s[80:83], s78 offen lds
  buffer_load_dwordx4 v252, s[80:83], s78 offen offset:1024 lds
  ds_read_b64_tr_b16 a[40:41], v245 offset:30720
  ds_read_b64_tr_b16 a[42:43], v245 offset:31744
  ds_read_b64_tr_b16 a[44:45], v244 offset:30720
  ds_read_b64_tr_b16 a[46:47], v244 offset:31744
  s_waitcnt lgkmcnt(0)
  s_add_u32 s78, s76, 1114112
  s_sub_u32 s3, s78, 1441792
  s_min_u32 s78, s78, s3
  s_add_u32 m0, s43, 30720
  s_nop 0
  buffer_load_dwordx4 v253, s[80:83], s78 offen lds
  buffer_load_dwordx4 v252, s[80:83], s78 offen offset:1024 lds
  ds_read_b64_tr_b16 a[48:49], v245 offset:32768
  ds_read_b64_tr_b16 a[50:51], v245 offset:33792
  ds_read_b64_tr_b16 a[52:53], v244 offset:32768
  ds_read_b64_tr_b16 a[54:55], v244 offset:33792
  s_waitcnt lgkmcnt(0)
  s_add_u32 s78, s76, 1179648
  s_sub_u32 s3, s78, 1441792
  s_min_u32 s78, s78, s3
  s_add_u32 m0, s43, 32768
  s_nop 0
  buffer_load_dwordx4 v253, s[80:83], s78 offen lds
  buffer_load_dwordx4 v252, s[80:83], s78 offen offset:1024 lds
  ds_read_b64_tr_b16 a[56:57], v245 offset:34816
  ds_read_b64_tr_b16 a[58:59], v245 offset:35840
  ds_read_b64_tr_b16 a[60:61], v244 offset:34816
  ds_read_b64_tr_b16 a[62:63], v244 offset:35840
  s_waitcnt lgkmcnt(0)
  s_add_u32 s78, s76, 1245184
  s_sub_u32 s3, s78, 1441792
  s_min_u32 s78, s78, s3
  s_add_u32 m0, s43, 34816
  s_nop 0
  buffer_load_dwordx4 v253, s[80:83], s78 offen lds
  buffer_load_dwordx4 v252, s[80:83], s78 offen offset:1024 lds
  s_waitcnt vmcnt(9)
  v_cmp_ne_u32 vcc, s42, v249
  s_cbranch_vccnz POLL_66
POLLOK_67:
  buffer_load_dwordx4 v[36:39], v250, s[32:35], s46 offen offset:0 sc1
  buffer_load_dwordx4 v[40:43], v250, s[32:35], s46 offen offset:544 sc1
  buffer_load_dwordx4 v[60:63], v250, s[32:35], s46 offen offset:1088 sc1
  buffer_load_dwordx4 v[64:67], v250, s[32:35], s46 offen offset:1632 sc1
  buffer_load_dwordx4 v[4:7], v238, s[28:31], s60 offen
  buffer_load_dwordx4 v[8:11], v238, s[28:31], s60 offen offset:32
  buffer_load_ushort v237, v237, s[64:67], s61 offen
  ds_read_b64_tr_b16 a[64:65], v245 offset:36864
  ds_read_b64_tr_b16 a[66:67], v245 offset:37888
  ds_read_b64_tr_b16 a[68:69], v244 offset:36864
  ds_read_b64_tr_b16 a[70:71], v244 offset:37888
  s_waitcnt lgkmcnt(0)
  s_add_u32 s78, s76, 1310720
  s_sub_u32 s3, s78, 1441792
  s_min_u32 s78, s78, s3
  s_add_u32 m0, s43, 36864
  s_nop 0
  buffer_load_dwordx4 v253, s[80:83], s78 offen lds
  buffer_load_dwordx4 v252, s[80:83], s78 offen offset:1024 lds
  ds_read_b64_tr_b16 a[72:73], v245 offset:10240
  ds_read_b64_tr_b16 a[74:75], v245 offset:11264
  ds_read_b64_tr_b16 a[76:77], v244 offset:10240
  ds_read_b64_tr_b16 a[78:79], v244 offset:11264
  s_waitcnt lgkmcnt(0)
  s_add_u32 s78, s76, 1376256
  s_sub_u32 s3, s78, 1441792
  s_min_u32 s78, s78, s3
  s_add_u32 m0, s43, 10240
  s_nop 0
  buffer_load_dwordx4 v253, s[80:83], s78 offen lds
  buffer_load_dwordx4 v252, s[80:83], s78 offen offset:1024 lds
  s_waitcnt vmcnt(7)
  v_cvt_pk_bf16_f32 v36, v36, v37
  v_cvt_pk_bf16_f32 v37, v38, v39
  v_cvt_pk_bf16_f32 v38, v40, v41
  v_cvt_pk_bf16_f32 v39, v42, v43
  s_nop 1
  v_mfma_f32_32x32x16_bf16 v[68:83], v[36:39], v[20:23], 0
  v_mfma_f32_32x32x16_bf16 v[84:99], v[36:39], v[44:47], 0
  v_cvt_pk_bf16_f32 v60, v60, v61
  v_cvt_pk_bf16_f32 v61, v62, v63
  v_cvt_pk_bf16_f32 v62, v64, v65
  v_cvt_pk_bf16_f32 v63, v66, v67
  s_nop 1
  v_mfma_f32_32x32x16_bf16 v[100:115], v[60:63], v[24:27], 0
  v_mfma_f32_32x32x16_bf16 v[116:131], v[60:63], v[48:51], 0
  v_add_f32 v76, s52, v76
  v_rcp_f32 v76, v76
  s_nop 0
  v_pk_mul_f32 v[68:69], v[68:69], v[76:77] op_sel_hi:[1,0]
  v_pk_mul_f32 v[70:71], v[70:71], v[76:77] op_sel_hi:[1,0]
  v_pk_mul_f32 v[72:73], v[72:73], v[76:77] op_sel_hi:[1,0]
  v_pk_mul_f32 v[74:75], v[74:75], v[76:77] op_sel_hi:[1,0]
  v_cvt_pk_bf16_f32 v68, v68, v69
  v_cvt_pk_bf16_f32 v69, v70, v71
  v_cvt_pk_bf16_f32 v70, v72, v73
  v_cvt_pk_bf16_f32 v71, v74, v75
  buffer_store_dwordx4 v[68:71], v254, s[32:35], s79 offen offset:0 sc1
  v_add_f32 v92, s52, v92
  v_rcp_f32 v92, v92
  s_nop 0
  v_pk_mul_f32 v[84:85], v[84:85], v[92:93] op_sel_hi:[1,0]
  v_pk_mul_f32 v[86:87], v[86:87], v[92:93] op_sel_hi:[1,0]
  v_pk_mul_f32 v[88:89], v[88:89], v[92:93] op_sel_hi:[1,0]
  v_pk_mul_f32 v[90:91], v[90:91], v[92:93] op_sel_hi:[1,0]
  v_cvt_pk_bf16_f32 v84, v84, v85
  v_cvt_pk_bf16_f32 v85, v86, v87
  v_cvt_pk_bf16_f32 v86, v88, v89
  v_cvt_pk_bf16_f32 v87, v90, v91
  buffer_store_dwordx4 v[84:87], v254, s[32:35], s79 offen offset:1024 sc1
  v_add_f32 v108, s52, v108
  v_rcp_f32 v108, v108
  s_nop 0
  v_pk_mul_f32 v[100:101], v[100:101], v[108:109] op_sel_hi:[1,0]
  v_pk_mul_f32 v[102:103], v[102:103], v[108:109] op_sel_hi:[1,0]
  v_pk_mul_f32 v[104:105], v[104:105], v[108:109] op_sel_hi:[1,0]
  v_pk_mul_f32 v[106:107], v[106:107], v[108:109] op_sel_hi:[1,0]
  v_cvt_pk_bf16_f32 v100, v100, v101
  v_cvt_pk_bf16_f32 v101, v102, v103
  v_cvt_pk_bf16_f32 v102, v104, v105
  v_cvt_pk_bf16_f32 v103, v106, v107
  buffer_store_dwordx4 v[100:103], v254, s[32:35], s92 offen offset:0 sc1
  v_add_f32 v124, s52, v124
  v_rcp_f32 v124, v124
  s_nop 0
  v_pk_mul_f32 v[116:117], v[116:117], v[124:125] op_sel_hi:[1,0]
  v_pk_mul_f32 v[118:119], v[118:119], v[124:125] op_sel_hi:[1,0]
  v_pk_mul_f32 v[120:121], v[120:121], v[124:125] op_sel_hi:[1,0]
  v_pk_mul_f32 v[122:123], v[122:123], v[124:125] op_sel_hi:[1,0]
  v_cvt_pk_bf16_f32 v116, v116, v117
  v_cvt_pk_bf16_f32 v117, v118, v119
  v_cvt_pk_bf16_f32 v118, v120, v121
  v_cvt_pk_bf16_f32 v119, v122, v123
  buffer_store_dwordx4 v[116:119], v254, s[32:35], s92 offen offset:1024 sc1
  v_cmp_ne_u32 vcc, s42, v239
  s_cbranch_vccnz POLL_68
POLLOK_69:
  buffer_load_dword v251, v240, s[36:39], 0 offen sc1
  s_waitcnt vmcnt(9)
  v_lshlrev_b32 v237, 16, v237
  v_lshlrev_b32 v12, 16, v4
  v_and_b32 v13, 0xffff0000, v4
  v_lshlrev_b32 v14, 16, v5
  v_and_b32 v15, 0xffff0000, v5
  v_lshlrev_b32 v16, 16, v6
  v_and_b32 v17, 0xffff0000, v6
  v_lshlrev_b32 v18, 16, v7
  v_and_b32 v19, 0xffff0000, v7
  v_lshlrev_b32 v20, 16, v8
  v_and_b32 v21, 0xffff0000, v8
  v_lshlrev_b32 v22, 16, v9
  v_and_b32 v23, 0xffff0000, v9
  v_lshlrev_b32 v24, 16, v10
  v_and_b32 v25, 0xffff0000, v10
  v_lshlrev_b32 v26, 16, v11
  v_and_b32 v27, 0xffff0000, v11
  v_add_f32 v12, v12, v237
  v_add_f32 v13, v13, v237
  v_add_f32 v14, v14, v237
  v_add_f32 v15, v15, v237
  v_add_f32 v16, v16, v237
  v_add_f32 v17, v17, v237
  v_add_f32 v18, v18, v237
  v_add_f32 v19, v19, v237
  v_add_f32 v20, v20, v237
  v_add_f32 v21, v21, v237
  v_add_f32 v22, v22, v237
  v_add_f32 v23, v23, v237
  v_add_f32 v24, v24, v237
  v_add_f32 v25, v25, v237
  v_add_f32 v26, v26, v237
  v_add_f32 v27, v27, v237
  v_permlane32_swap_b32 v12, v16
  v_permlane32_swap_b32 v13, v17
  v_permlane32_swap_b32 v14, v18
  v_permlane32_swap_b32 v15, v19
  v_permlane32_swap_b32 v20, v24
  v_permlane32_swap_b32 v21, v25
  v_permlane32_swap_b32 v22, v26
  v_permlane32_swap_b32 v23, v27
  s_mov_b32 s12, s20
  s_mov_b32 s13, s21
  s_mov_b32 s14, 0x200000
  s_mov_b32 s15, 0x20000
  ds_read_b64_tr_b16 a[80:81], v245 offset:12288
  ds_read_b64_tr_b16 a[82:83], v245 offset:13312
  ds_read_b64_tr_b16 a[84:85], v244 offset:12288
  ds_read_b64_tr_b16 a[86:87], v244 offset:13312
  s_waitcnt vmcnt(0)
  v_cmp_eq_u32 vcc, -1, v251
  s_cbranch_vccnz POLL_70
POLLOK_71:
  s_mov_b64 exec, 1
  buffer_store_dword v206, v207, s[32:35], s93 offen sc1
  s_mov_b64 exec, -1
  s_add_u32 s56, s75, 0
  s_sub_u32 s3, s56, 360448
  s_min_u32 s56, s56, s3
  buffer_load_dwordx4 v[4:7], v243, s[84:87], s56 offen sc1
  buffer_load_dwordx4 v[8:11], v242, s[84:87], s56 offen sc1
  s_add_u32 s57, s75, 16384
  s_sub_u32 s3, s57, 360448
  s_min_u32 s57, s57, s3
  buffer_load_dwordx4 v[76:79], v243, s[84:87], s57 offen sc1
  buffer_load_dwordx4 v[80:83], v242, s[84:87], s57 offen sc1
  s_add_u32 s58, s75, 32768
  s_sub_u32 s3, s58, 360448
  s_min_u32 s58, s58, s3
  buffer_load_dwordx4 v[84:87], v243, s[84:87], s58 offen sc1
  buffer_load_dwordx4 v[88:91], v242, s[84:87], s58 offen sc1
  s_add_u32 s59, s75, 49152
  s_sub_u32 s3, s59, 360448
  s_min_u32 s59, s59, s3
  buffer_load_dwordx4 v[92:95], v243, s[84:87], s59 offen sc1
  buffer_load_dwordx4 v[96:99], v242, s[84:87], s59 offen sc1
  s_add_u32 s61, s75, 65536
  s_sub_u32 s3, s61, 360448
  s_min_u32 s61, s61, s3
  buffer_load_dwordx4 v[100:103], v243, s[84:87], s61 offen sc1
  buffer_load_dwordx4 v[104:107], v242, s[84:87], s61 offen sc1
  s_add_u32 s62, s75, 81920
  s_sub_u32 s3, s62, 360448
  s_min_u32 s62, s62, s3
  buffer_load_dwordx4 v[108:111], v243, s[84:87], s62 offen sc1
  buffer_load_dwordx4 v[112:115], v242, s[84:87], s62 offen sc1
  s_waitcnt vmcnt(10)
  v_max3_u32 v250, v4, v5, v6
  v_max3_u32 v250, v250, v7, v8
  v_max3_u32 v250, v250, v9, v10
  v_max_u32 v250, v250, v11
  v_cmp_eq_u32 vcc, -1, v250
  s_cbranch_vccnz CHK_72
CHKOK_73:
  v_mfma_f32_32x32x16_bf16 v[60:75], v[8:11], a[4:7], 0
  v_mfma_f32_32x32x16_bf16 v[44:59], v[8:11], a[0:3], 0
  ds_read_b64_tr_b16 a[88:89], v245 offset:38912
  ds_read_b64_tr_b16 a[90:91], v245 offset:39936
  ds_read_b64_tr_b16 a[92:93], v244 offset:38912
  ds_read_b64_tr_b16 a[94:95], v244 offset:39936
  v_mfma_f32_32x32x16_bf16 v[28:43], v[4:7], a[4:7], 0
  s_waitcnt vmcnt(8)
  v_max3_u32 v250, v76, v77, v78
  v_max3_u32 v250, v250, v79, v80
  v_max3_u32 v250, v250, v81, v82
  v_max_u32 v250, v250, v83
  v_cmp_eq_u32 vcc, -1, v250
  v_mfma_f32_32x32x16_bf16 v[12:27], v[4:7], a[0:3], v[12:27]
  s_cbranch_vccnz CHK_74
CHKOK_75:
  v_mfma_f32_32x32x16_bf16 v[60:75], v[80:83], a[12:15], v[60:75]
  s_add_u32 s56, s75, 98304
  s_sub_u32 s3, s56, 360448
  s_min_u32 s56, s56, s3
  buffer_load_dwordx4 v[4:7], v243, s[84:87], s56 offen sc1
  buffer_load_dwordx4 v[8:11], v242, s[84:87], s56 offen sc1
  v_mfma_f32_32x32x16_bf16 v[44:59], v[80:83], a[8:11], v[44:59]
  ds_read_b64_tr_b16 a[0:1], v245 offset:0
  ds_read_b64_tr_b16 a[2:3], v245 offset:1024
  ds_read_b64_tr_b16 a[4:5], v244 offset:0
  ds_read_b64_tr_b16 a[6:7], v244 offset:1024
  v_mfma_f32_32x32x16_bf16 v[28:43], v[76:79], a[12:15], v[28:43]
  s_waitcnt vmcnt(8)
  v_max3_u32 v250, v84, v85, v86
  v_max3_u32 v250, v250, v87, v88
  v_max3_u32 v250, v250, v89, v90
  v_max_u32 v250, v250, v91
  v_cmp_eq_u32 vcc, -1, v250
  v_mfma_f32_32x32x16_bf16 v[12:27], v[76:79], a[8:11], v[12:27]
  s_cbranch_vccnz CHK_76
CHKOK_77:
  v_mfma_f32_32x32x16_bf16 v[60:75], v[88:91], a[20:23], v[60:75]
  s_add_u32 s57, s75, 114688
  s_sub_u32 s3, s57, 360448
  s_min_u32 s57, s57, s3
  buffer_load_dwordx4 v[76:79], v243, s[84:87], s57 offen sc1
  buffer_load_dwordx4 v[80:83], v242, s[84:87], s57 offen sc1
  v_mfma_f32_32x32x16_bf16 v[44:59], v[88:91], a[16:19], v[44:59]
  ds_read_b64_tr_b16 a[8:9], v227 offset:2048
  ds_read_b64_tr_b16 a[10:11], v227 offset:3072
  ds_read_b64_tr_b16 a[12:13], v226 offset:2048
  ds_read_b64_tr_b16 a[14:15], v226 offset:3072
  v_mfma_f32_32x32x16_bf16 v[28:43], v[84:87], a[20:23], v[28:43]
  s_waitcnt vmcnt(8)
  v_max3_u32 v250, v92, v93, v94
  v_max3_u32 v250, v250, v95, v96
  v_max3_u32 v250, v250, v97, v98
  v_max_u32 v250, v250, v99
  v_cmp_eq_u32 vcc, -1, v250
  v_mfma_f32_32x32x16_bf16 v[12:27], v[84:87], a[16:19], v[12:27]
  s_cbranch_vccnz CHK_78
CHKOK_79:
  v_mfma_f32_32x32x16_bf16 v[60:75], v[96:99], a[28:31], v[60:75]
  s_add_u32 s58, s75, 131072
  s_sub_u32 s3, s58, 360448
  s_min_u32 s58, s58, s3
  buffer_load_dwordx4 v[84:87], v243, s[84:87], s58 offen sc1
  buffer_load_dwordx4 v[88:91], v242, s[84:87], s58 offen sc1
  v_mfma_f32_32x32x16_bf16 v[44:59], v[96:99], a[24:27], v[44:59]
  ds_read_b64_tr_b16 a[16:17], v227 offset:4096
  ds_read_b64_tr_b16 a[18:19], v227 offset:5120
  ds_read_b64_tr_b16 a[20:21], v226 offset:4096
  ds_read_b64_tr_b16 a[22:23], v226 offset:5120
  v_mfma_f32_32x32x16_bf16 v[28:43], v[92:95], a[28:31], v[28:43]
  s_waitcnt vmcnt(8)
  v_max3_u32 v250, v100, v101, v102
  v_max3_u32 v250, v250, v103, v104
  v_max3_u32 v250, v250, v105, v106
  v_max_u32 v250, v250, v107
  v_cmp_eq_u32 vcc, -1, v250
  v_mfma_f32_32x32x16_bf16 v[12:27], v[92:95], a[24:27], v[12:27]
  s_cbranch_vccnz CHK_80
CHKOK_81:
  v_mfma_f32_32x32x16_bf16 v[60:75], v[104:107], a[36:39], v[60:75]
  s_add_u32 s59, s75, 147456
  s_sub_u32 s3, s59, 360448
  s_min_u32 s59, s59, s3
  buffer_load_dwordx4 v[92:95], v243, s[84:87], s59 offen sc1
  buffer_load_dwordx4 v[96:99], v242, s[84:87], s59 offen sc1
  v_mfma_f32_32x32x16_bf16 v[44:59], v[104:107], a[32:35], v[44:59]
  ds_read_b64_tr_b16 a[24:25], v227 offset:6144
  ds_read_b64_tr_b16 a[26:27], v227 offset:7168
  ds_read_b64_tr_b16 a[28:29], v226 offset:6144
  ds_read_b64_tr_b16 a[30:31], v226 offset:7168
  v_mfma_f32_32x32x16_bf16 v[28:43], v[100:103], a[36:39], v[28:43]
  s_waitcnt vmcnt(8)
  v_max3_u32 v250, v108, v109, v110
  v_max3_u32 v250, v250, v111, v112
  v_max3_u32 v250, v250, v113, v114
  v_max_u32 v250, v250, v115
  v_cmp_eq_u32 vcc, -1, v250
  v_mfma_f32_32x32x16_bf16 v[12:27], v[100:103], a[32:35], v[12:27]
  s_cbranch_vccnz CHK_82
CHKOK_83:
  v_mfma_f32_32x32x16_bf16 v[60:75], v[112:115], a[44:47], v[60:75]
  s_add_u32 s61, s75, 163840
  s_sub_u32 s3, s61, 360448
  s_min_u32 s61, s61, s3
  buffer_load_dwordx4 v[100:103], v243, s[84:87], s61 offen sc1
  buffer_load_dwordx4 v[104:107], v242, s[84:87], s61 offen sc1
  v_mfma_f32_32x32x16_bf16 v[44:59], v[112:115], a[40:43], v[44:59]
  ds_read_b64_tr_b16 a[32:33], v227 offset:8192
  ds_read_b64_tr_b16 a[34:35], v227 offset:9216
  ds_read_b64_tr_b16 a[36:37], v226 offset:8192
  ds_read_b64_tr_b16 a[38:39], v226 offset:9216
  v_mfma_f32_32x32x16_bf16 v[28:43], v[108:111], a[44:47], v[28:43]
  s_waitcnt vmcnt(8)
  v_max3_u32 v250, v4, v5, v6
  v_max3_u32 v250, v250, v7, v8
  v_max3_u32 v250, v250, v9, v10
  v_max_u32 v250, v250, v11
  v_cmp_eq_u32 vcc, -1, v250
  v_mfma_f32_32x32x16_bf16 v[12:27], v[108:111], a[40:43], v[12:27]
  s_cbranch_vccnz CHK_84
CHKOK_85:
  v_mfma_f32_32x32x16_bf16 v[60:75], v[8:11], a[52:55], v[60:75]
  s_add_u32 s62, s75, 180224
  s_sub_u32 s3, s62, 360448
  s_min_u32 s62, s62, s3
  buffer_load_dwordx4 v[108:111], v243, s[84:87], s62 offen sc1
  buffer_load_dwordx4 v[112:115], v242, s[84:87], s62 offen sc1
  v_mfma_f32_32x32x16_bf16 v[44:59], v[8:11], a[48:51], v[44:59]
  ds_read_b64_tr_b16 a[40:41], v227 offset:14336
  ds_read_b64_tr_b16 a[42:43], v227 offset:15360
  ds_read_b64_tr_b16 a[44:45], v226 offset:14336
  ds_read_b64_tr_b16 a[46:47], v226 offset:15360
  v_mfma_f32_32x32x16_bf16 v[28:43], v[4:7], a[52:55], v[28:43]
  s_waitcnt vmcnt(8)
  v_max3_u32 v250, v76, v77, v78
  v_max3_u32 v250, v250, v79, v80
  v_max3_u32 v250, v250, v81, v82
  v_max_u32 v250, v250, v83
  v_cmp_eq_u32 vcc, -1, v250
  v_mfma_f32_32x32x16_bf16 v[12:27], v[4:7], a[48:51], v[12:27]
  s_cbranch_vccnz CHK_86
CHKOK_87:
  v_mfma_f32_32x32x16_bf16 v[60:75], v[80:83], a[60:63], v[60:75]
  s_add_u32 s56, s75, 196608
  s_sub_u32 s3, s56, 360448
  s_min_u32 s56, s56, s3
  buffer_load_dwordx4 v[4:7], v243, s[84:87], s56 offen sc1
  buffer_load_dwordx4 v[8:11], v242, s[84:87], s56 offen sc1
  v_mfma_f32_32x32x16_bf16 v[44:59], v[80:83], a[56:59], v[44:59]
  ds_read_b64_tr_b16 a[48:49], v227 offset:16384
  ds_read_b64_tr_b16 a[50:51], v227 offset:17408
  ds_read_b64_tr_b16 a[52:53], v226 offset:16384
  ds_read_b64_tr_b16 a[54:55], v226 offset:17408
  v_mfma_f32_32x32x16_bf16 v[28:43], v[76:79], a[60:63], v[28:43]
  s_waitcnt vmcnt(8)
  v_max3_u32 v250, v84, v85, v86
  v_max3_u32 v250, v250, v87, v88
  v_max3_u32 v250, v250, v89, v90
  v_max_u32 v250, v250, v91
  v_cmp_eq_u32 vcc, -1, v250
  v_mfma_f32_32x32x16_bf16 v[12:27], v[76:79], a[56:59], v[12:27]
  s_cbranch_vccnz CHK_88
CHKOK_89:
  v_mfma_f32_32x32x16_bf16 v[60:75], v[88:91], a[68:71], v[60:75]
  s_add_u32 s57, s75, 212992
  s_sub_u32 s3, s57, 360448
  s_min_u32 s57, s57, s3
  buffer_load_dwordx4 v[76:79], v243, s[84:87], s57 offen sc1
  buffer_load_dwordx4 v[80:83], v242, s[84:87], s57 offen sc1
  v_mfma_f32_32x32x16_bf16 v[44:59], v[88:91], a[64:67], v[44:59]
  ds_read_b64_tr_b16 a[56:57], v227 offset:18432
  ds_read_b64_tr_b16 a[58:59], v227 offset:19456
  ds_read_b64_tr_b16 a[60:61], v226 offset:18432
  ds_read_b64_tr_b16 a[62:63], v226 offset:19456
  v_mfma_f32_32x32x16_bf16 v[28:43], v[84:87], a[68:71], v[28:43]
  s_waitcnt vmcnt(8)
  v_max3_u32 v250, v92, v93, v94
  v_max3_u32 v250, v250, v95, v96
  v_max3_u32 v250, v250, v97, v98
  v_max_u32 v250, v250, v99
  v_cmp_eq_u32 vcc, -1, v250
  v_mfma_f32_32x32x16_bf16 v[12:27], v[84:87], a[64:67], v[12:27]
  s_cbranch_vccnz CHK_90
CHKOK_91:
  v_mfma_f32_32x32x16_bf16 v[60:75], v[96:99], a[76:79], v[60:75]
  s_add_u32 s58, s75, 229376
  s_sub_u32 s3, s58, 360448
  s_min_u32 s58, s58, s3
  buffer_load_dwordx4 v[84:87], v243, s[84:87], s58 offen sc1
  buffer_load_dwordx4 v[88:91], v242, s[84:87], s58 offen sc1
  v_mfma_f32_32x32x16_bf16 v[44:59], v[96:99], a[72:75], v[44:59]
  ds_read_b64_tr_b16 a[64:65], v227 offset:20480
  ds_read_b64_tr_b16 a[66:67], v227 offset:21504
  ds_read_b64_tr_b16 a[68:69], v226 offset:20480
  ds_read_b64_tr_b16 a[70:71], v226 offset:21504
  v_mfma_f32_32x32x16_bf16 v[28:43], v[92:95], a[76:79], v[28:43]
  s_waitcnt vmcnt(8)
  v_max3_u32 v250, v100, v101, v102
  v_max3_u32 v250, v250, v103, v104
  v_max3_u32 v250, v250, v105, v106
  v_max_u32 v250, v250, v107
  v_cmp_eq_u32 vcc, -1, v250
  v_mfma_f32_32x32x16_bf16 v[12:27], v[92:95], a[72:75], v[12:27]
  s_cbranch_vccnz CHK_92
CHKOK_93:
  s_waitcnt lgkmcnt(15)
  v_mfma_f32_32x32x16_bf16 v[60:75], v[104:107], a[84:87], v[60:75]
  s_add_u32 s59, s75, 245760
  s_sub_u32 s3, s59, 360448
  s_min_u32 s59, s59, s3
  buffer_load_dwordx4 v[92:95], v243, s[84:87], s59 offen sc1
  buffer_load_dwordx4 v[96:99], v242, s[84:87], s59 offen sc1
  v_mfma_f32_32x32x16_bf16 v[44:59], v[104:107], a[80:83], v[44:59]
  ds_read_b64_tr_b16 a[72:73], v245 offset:22528
  ds_read_b64_tr_b16 a[74:75], v245 offset:23552
  ds_read_b64_tr_b16 a[76:77], v244 offset:22528
  ds_read_b64_tr_b16 a[78:79], v244 offset:23552
  v_mfma_f32_32x32x16_bf16 v[28:43], v[100:103], a[84:87], v[28:43]
  s_waitcnt vmcnt(8)
  v_max3_u32 v250, v108, v109, v110
  v_max3_u32 v250, v250, v111, v112
  v_max3_u32 v250, v250, v113, v114
  v_max_u32 v250, v250, v115
  v_cmp_eq_u32 vcc, -1, v250
  v_mfma_f32_32x32x16_bf16 v[12:27], v[100:103], a[80:83], v[12:27]
  s_cbranch_vccnz CHK_94
CHKOK_95:
  v_mfma_f32_32x32x16_bf16 v[60:75], v[112:115], a[92:95], v[60:75]
  s_add_u32 s61, s75, 262144
  s_sub_u32 s3, s61, 360448
  s_min_u32 s61, s61, s3
  buffer_load_dwordx4 v[100:103], v243, s[84:87], s61 offen sc1
  buffer_load_dwordx4 v[104:107], v242, s[84:87], s61 offen sc1
  v_mfma_f32_32x32x16_bf16 v[44:59], v[112:115], a[88:91], v[44:59]
  ds_read_b64_tr_b16 a[80:81], v245 offset:24576
  ds_read_b64_tr_b16 a[82:83], v245 offset:25600
  ds_read_b64_tr_b16 a[84:85], v244 offset:24576
  ds_read_b64_tr_b16 a[86:87], v244 offset:25600
  v_mfma_f32_32x32x16_bf16 v[28:43], v[108:111], a[92:95], v[28:43]
  s_waitcnt vmcnt(8)
  v_max3_u32 v250, v4, v5, v6
  v_max3_u32 v250, v250, v7, v8
  v_max3_u32 v250, v250, v9, v10
  v_max_u32 v250, v250, v11
  v_cmp_eq_u32 vcc, -1, v250
  v_mfma_f32_32x32x16_bf16 v[12:27], v[108:111], a[88:91], v[12:27]
  s_cbranch_vccnz CHK_96
CHKOK_97:
  v_mfma_f32_32x32x16_bf16 v[60:75], v[8:11], a[4:7], v[60:75]
  s_add_u32 s62, s75, 278528
  s_sub_u32 s3, s62, 360448
  s_min_u32 s62, s62, s3
  buffer_load_dwordx4 v[108:111], v243, s[84:87], s62 offen sc1
  buffer_load_dwordx4 v[112:115], v242, s[84:87], s62 offen sc1
  buffer_load_dword v251, v247, s[32:35], 0 offen sc1
  v_mfma_f32_32x32x16_bf16 v[44:59], v[8:11], a[0:3], v[44:59]
  ds_read_b64_tr_b16 a[88:89], v245 offset:26624
  ds_read_b64_tr_b16 a[90:91], v245 offset:27648
  ds_read_b64_tr_b16 a[92:93], v244 offset:26624
  ds_read_b64_tr_b16 a[94:95], v244 offset:27648
  v_mfma_f32_32x32x16_bf16 v[28:43], v[4:7], a[4:7], v[28:43]
  s_waitcnt vmcnt(9)
  v_max3_u32 v250, v76, v77, v78
  v_max3_u32 v250, v250, v79, v80
  v_max3_u32 v250, v250, v81, v82
  v_max_u32 v250, v250, v83
  v_cmp_eq_u32 vcc, -1, v250
  v_mfma_f32_32x32x16_bf16 v[12:27], v[4:7], a[0:3], v[12:27]
  s_cbranch_vccnz CHK_98
CHKOK_99:
  s_waitcnt lgkmcnt(8)
  v_mfma_f32_32x32x16_bf16 v[60:75], v[80:83], a[76:79], v[60:75]
  s_add_u32 s56, s75, 294912
  s_sub_u32 s3, s56, 360448
  s_min_u32 s56, s56, s3
  buffer_load_dwordx4 v[4:7], v243, s[84:87], s56 offen sc1
  buffer_load_dwordx4 v[8:11], v242, s[84:87], s56 offen sc1
  v_mfma_f32_32x32x16_bf16 v[44:59], v[80:83], a[72:75], v[44:59]
  ds_read_b64_tr_b16 a[0:1], v245 offset:28672
  ds_read_b64_tr_b16 a[2:3], v245 offset:29696
  ds_read_b64_tr_b16 a[4:5], v244 offset:28672
  ds_read_b64_tr_b16 a[6:7], v244 offset:29696
  v_mfma_f32_32x32x16_bf16 v[28:43], v[76:79], a[76:79], v[28:43]
  s_waitcnt vmcnt(9)
  v_max3_u32 v250, v84, v85, v86
  v_max3_u32 v250, v250, v87, v88
  v_max3_u32 v250, v250, v89, v90
  v_max_u32 v250, v250, v91
  v_cmp_eq_u32 vcc, -1, v250
  v_mfma_f32_32x32x16_bf16 v[12:27], v[76:79], a[72:75], v[12:27]
  s_cbranch_vccnz CHK_100
CHKOK_101:
  s_waitcnt lgkmcnt(8)
  v_mfma_f32_32x32x16_bf16 v[60:75], v[88:91], a[84:87], v[60:75]
  s_add_u32 s57, s75, 311296
  s_sub_u32 s3, s57, 360448
  s_min_u32 s57, s57, s3
  buffer_load_dwordx4 v[76:79], v243, s[84:87], s57 offen sc1
  buffer_load_dwordx4 v[80:83], v242, s[84:87], s57 offen sc1
  v_mfma_f32_32x32x16_bf16 v[44:59], v[88:91], a[80:83], v[44:59]
  ds_read_b64_tr_b16 a[72:73], v245 offset:30720
  ds_read_b64_tr_b16 a[74:75], v245 offset:31744
  ds_read_b64_tr_b16 a[76:77], v244 offset:30720
  ds_read_b64_tr_b16 a[78:79], v244 offset:31744
  v_mfma_f32_32x32x16_bf16 v[28:43], v[84:87], a[84:87], v[28:43]
  s_waitcnt vmcnt(9)
  v_max3_u32 v250, v92, v93, v94
  v_max3_u32 v250, v250, v95, v96
  v_max3_u32 v250, v250, v97, v98
  v_max_u32 v250, v250, v99
  v_cmp_eq_u32 vcc, -1, v250
  v_mfma_f32_32x32x16_bf16 v[12:27], v[84:87], a[80:83], v[12:27]
  s_cbranch_vccnz CHK_102
CHKOK_103:
  s_waitcnt lgkmcnt(8)
  v_mfma_f32_32x32x16_bf16 v[60:75], v[96:99], a[92:95], v[60:75]
  s_add_u32 s58, s75, 327680
  s_sub_u32 s3, s58, 360448
  s_min_u32 s58, s58, s3
  buffer_load_dwordx4 v[84:87], v243, s[84:87], s58 offen sc1
  buffer_load_dwordx4 v[88:91], v242, s[84:87], s58 offen sc1
  v_mfma_f32_32x32x16_bf16 v[44:59], v[96:99], a[88:91], v[44:59]
  ds_read_b64_tr_b16 a[80:81], v245 offset:32768
  ds_read_b64_tr_b16 a[82:83], v245 offset:33792
  ds_read_b64_tr_b16 a[84:85], v244 offset:32768
  ds_read_b64_tr_b16 a[86:87], v244 offset:33792
  v_mfma_f32_32x32x16_bf16 v[28:43], v[92:95], a[92:95], v[28:43]
  s_waitcnt vmcnt(9)
  v_max3_u32 v250, v100, v101, v102
  v_max3_u32 v250, v250, v103, v104
  v_max3_u32 v250, v250, v105, v106
  v_max_u32 v250, v250, v107
  v_cmp_eq_u32 vcc, -1, v250
  v_mfma_f32_32x32x16_bf16 v[12:27], v[92:95], a[88:91], v[12:27]
  s_cbranch_vccnz CHK_104
CHKOK_105:
  s_waitcnt lgkmcnt(8)
  v_mfma_f32_32x32x16_bf16 v[60:75], v[104:107], a[4:7], v[60:75]
  s_add_u32 s59, s75, 344064
  s_sub_u32 s3, s59, 360448
  s_min_u32 s59, s59, s3
  buffer_load_dwordx4 v[92:95], v243, s[84:87], s59 offen sc1
  buffer_load_dwordx4 v[96:99], v242, s[84:87], s59 offen sc1
  v_mfma_f32_32x32x16_bf16 v[44:59], v[104:107], a[0:3], v[44:59]
  ds_read_b64_tr_b16 a[88:89], v245 offset:34816
  ds_read_b64_tr_b16 a[90:91], v245 offset:35840
  ds_read_b64_tr_b16 a[92:93], v244 offset:34816
  ds_read_b64_tr_b16 a[94:95], v244 offset:35840
  v_mfma_f32_32x32x16_bf16 v[28:43], v[100:103], a[4:7], v[28:43]
  s_waitcnt vmcnt(9)
  v_max3_u32 v250, v108, v109, v110
  v_max3_u32 v250, v250, v111, v112
  v_max3_u32 v250, v250, v113, v114
  v_max_u32 v250, v250, v115
  v_cmp_eq_u32 vcc, -1, v250
  v_mfma_f32_32x32x16_bf16 v[12:27], v[100:103], a[0:3], v[12:27]
  s_cbranch_vccnz CHK_106
CHKOK_107:
  s_waitcnt lgkmcnt(8)
  v_mfma_f32_32x32x16_bf16 v[60:75], v[112:115], a[76:79], v[60:75]
  s_waitcnt vmcnt(8)
  v_cmp_ne_u32 vcc, s42, v251
  s_cbranch_vccnz POLL_110
POLLOK_111:
  s_add_u32 s61, s77, 0
  s_and_b32 s61, s61, 7
  s_lshl_b32 s61, s61, 16
  buffer_load_dwordx4 v[100:103], v246, s[32:35], s61 offen sc1
  buffer_load_dwordx4 v[104:107], v241, s[32:35], s61 offen sc1
  v_mfma_f32_32x32x16_bf16 v[44:59], v[112:115], a[72:75], v[44:59]
  ds_read_b64_tr_b16 a[0:1], v245 offset:36864
  ds_read_b64_tr_b16 a[2:3], v245 offset:37888
  ds_read_b64_tr_b16 a[4:5], v244 offset:36864
  ds_read_b64_tr_b16 a[6:7], v244 offset:37888
  v_mfma_f32_32x32x16_bf16 v[28:43], v[108:111], a[76:79], v[28:43]
  s_waitcnt vmcnt(8)
  v_max3_u32 v250, v4, v5, v6
  v_max3_u32 v250, v250, v7, v8
  v_max3_u32 v250, v250, v9, v10
  v_max_u32 v250, v250, v11
  v_cmp_eq_u32 vcc, -1, v250
  v_mfma_f32_32x32x16_bf16 v[12:27], v[108:111], a[72:75], v[12:27]
  s_cbranch_vccnz CHK_108
CHKOK_109:
  s_waitcnt lgkmcnt(8)
  v_mfma_f32_32x32x16_bf16 v[60:75], v[8:11], a[84:87], v[60:75]
  s_add_u32 s62, s77, 1
  s_and_b32 s62, s62, 7
  s_lshl_b32 s62, s62, 16
  buffer_load_dwordx4 v[108:111], v246, s[32:35], s62 offen sc1
  buffer_load_dwordx4 v[112:115], v241, s[32:35], s62 offen sc1
  v_mfma_f32_32x32x16_bf16 v[44:59], v[8:11], a[80:83], v[44:59]
  ds_read_b64_tr_b16 a[72:73], v245 offset:10240
  ds_read_b64_tr_b16 a[74:75], v245 offset:11264
  ds_read_b64_tr_b16 a[76:77], v244 offset:10240
  ds_read_b64_tr_b16 a[78:79], v244 offset:11264
  v_mfma_f32_32x32x16_bf16 v[28:43], v[4:7], a[84:87], v[28:43]
  s_waitcnt vmcnt(8)
  v_max3_u32 v250, v76, v77, v78
  v_max3_u32 v250, v250, v79, v80
  v_max3_u32 v250, v250, v81, v82
  v_max_u32 v250, v250, v83
  v_cmp_eq_u32 vcc, -1, v250
  v_mfma_f32_32x32x16_bf16 v[12:27], v[4:7], a[80:83], v[12:27]
  s_cbranch_vccnz CHK_112
CHKOK_113:
  s_waitcnt lgkmcnt(8)
  v_mfma_f32_32x32x16_bf16 v[60:75], v[80:83], a[92:95], v[60:75]
  s_add_u32 s56, s77, 2
  s_and_b32 s56, s56, 7
  s_lshl_b32 s56, s56, 16
  buffer_load_dwordx4 v[4:7], v246, s[32:35], s56 offen sc1
  buffer_load_dwordx4 v[8:11], v241, s[32:35], s56 offen sc1
  v_mfma_f32_32x32x16_bf16 v[44:59], v[80:83], a[88:91], v[44:59]
  v_mfma_f32_32x32x16_bf16 v[28:43], v[76:79], a[92:95], v[28:43]
  s_waitcnt vmcnt(8)
  v_max3_u32 v250, v84, v85, v86
  v_max3_u32 v250, v250, v87, v88
  v_max3_u32 v250, v250, v89, v90
  v_max_u32 v250, v250, v91
  v_cmp_eq_u32 vcc, -1, v250
  v_mfma_f32_32x32x16_bf16 v[12:27], v[76:79], a[88:91], v[12:27]
  s_cbranch_vccnz CHK_114
CHKOK_115:
  s_waitcnt lgkmcnt(4)
  v_mfma_f32_32x32x16_bf16 v[60:75], v[88:91], a[4:7], v[60:75]
  s_add_u32 s57, s77, 3
  s_and_b32 s57, s57, 7
  s_lshl_b32 s57, s57, 16
  buffer_load_dwordx4 v[76:79], v246, s[32:35], s57 offen sc1
  buffer_load_dwordx4 v[80:83], v241, s[32:35], s57 offen sc1
  v_mfma_f32_32x32x16_bf16 v[44:59], v[88:91], a[0:3], v[44:59]
  v_mfma_f32_32x32x16_bf16 v[28:43], v[84:87], a[4:7], v[28:43]
  s_waitcnt vmcnt(8)
  v_max3_u32 v250, v92, v93, v94
  v_max3_u32 v250, v250, v95, v96
  v_max3_u32 v250, v250, v97, v98
  v_max_u32 v250, v250, v99
  v_cmp_eq_u32 vcc, -1, v250
  v_mfma_f32_32x32x16_bf16 v[12:27], v[84:87], a[0:3], v[12:27]
  s_cbranch_vccnz CHK_116
CHKOK_117:
  s_waitcnt lgkmcnt(0)
  v_mfma_f32_32x32x16_bf16 v[60:75], v[96:99], a[76:79], v[60:75]
  s_add_u32 s58, s77, 4
  s_and_b32 s58, s58, 7
  s_lshl_b32 s58, s58, 16
  buffer_load_dwordx4 v[84:87], v246, s[32:35], s58 offen sc1
  buffer_load_dwordx4 v[88:91], v241, s[32:35], s58 offen sc1
  v_mfma_f32_32x32x16_bf16 v[44:59], v[96:99], a[72:75], v[44:59]
  v_mfma_f32_32x32x16_bf16 v[28:43], v[92:95], a[76:79], v[28:43]
  s_waitcnt vmcnt(8)
  v_mfma_f32_32x32x16_bf16 v[12:27], v[92:95], a[72:75], v[12:27]
  v_mfma_f32_32x32x16_bf16 v[60:75], a[12:15], v[104:107], v[60:75]
  s_add_u32 s59, s77, 5
  s_and_b32 s59, s59, 7
  s_lshl_b32 s59, s59, 16
  buffer_load_dwordx4 v[92:95], v246, s[32:35], s59 offen sc1
  buffer_load_dwordx4 v[96:99], v241, s[32:35], s59 offen sc1
  v_mfma_f32_32x32x16_bf16 v[44:59], a[12:15], v[100:103], v[44:59]
  v_mfma_f32_32x32x16_bf16 v[28:43], a[8:11], v[104:107], v[28:43]
  s_waitcnt vmcnt(8)
  v_mfma_f32_32x32x16_bf16 v[12:27], a[8:11], v[100:103], v[12:27]
  v_mfma_f32_32x32x16_bf16 v[60:75], a[20:23], v[112:115], v[60:75]
  s_add_u32 s61, s77, 6
  s_and_b32 s61, s61, 7
  s_lshl_b32 s61, s61, 16
  buffer_load_dwordx4 v[100:103], v246, s[32:35], s61 offen sc1
  buffer_load_dwordx4 v[104:107], v241, s[32:35], s61 offen sc1
  v_mfma_f32_32x32x16_bf16 v[44:59], a[20:23], v[108:111], v[44:59]
  v_mfma_f32_32x32x16_bf16 v[28:43], a[16:19], v[112:115], v[28:43]
  s_waitcnt vmcnt(8)
  v_mfma_f32_32x32x16_bf16 v[12:27], a[16:19], v[108:111], v[12:27]
  v_mfma_f32_32x32x16_bf16 v[60:75], a[28:31], v[8:11], v[60:75]
  s_add_u32 s62, s77, 7
  s_and_b32 s62, s62, 7
  s_lshl_b32 s62, s62, 16
  buffer_load_dwordx4 v[108:111], v246, s[32:35], s62 offen sc1
  buffer_load_dwordx4 v[112:115], v241, s[32:35], s62 offen sc1
  v_mfma_f32_32x32x16_bf16 v[44:59], a[28:31], v[4:7], v[44:59]
  v_mfma_f32_32x32x16_bf16 v[28:43], a[24:27], v[8:11], v[28:43]
  s_waitcnt vmcnt(8)
  v_mfma_f32_32x32x16_bf16 v[12:27], a[24:27], v[4:7], v[12:27]
  v_mfma_f32_32x32x16_bf16 v[60:75], a[36:39], v[80:83], v[60:75]
  v_mfma_f32_32x32x16_bf16 v[44:59], a[36:39], v[76:79], v[44:59]
  v_mfma_f32_32x32x16_bf16 v[28:43], a[32:35], v[80:83], v[28:43]
  s_waitcnt vmcnt(6)
  v_mfma_f32_32x32x16_bf16 v[12:27], a[32:35], v[76:79], v[12:27]
  v_mfma_f32_32x32x16_bf16 v[60:75], a[44:47], v[88:91], v[60:75]
  v_mfma_f32_32x32x16_bf16 v[44:59], a[44:47], v[84:87], v[44:59]
  v_mfma_f32_32x32x16_bf16 v[28:43], a[40:43], v[88:91], v[28:43]
  s_waitcnt vmcnt(4)
  v_mfma_f32_32x32x16_bf16 v[12:27], a[40:43], v[84:87], v[12:27]
  v_mfma_f32_32x32x16_bf16 v[60:75], a[52:55], v[96:99], v[60:75]
  v_mfma_f32_32x32x16_bf16 v[44:59], a[52:55], v[92:95], v[44:59]
  v_mfma_f32_32x32x16_bf16 v[28:43], a[48:51], v[96:99], v[28:43]
  s_waitcnt vmcnt(2)
  v_mfma_f32_32x32x16_bf16 v[12:27], a[48:51], v[92:95], v[12:27]
  v_mfma_f32_32x32x16_bf16 v[60:75], a[60:63], v[104:107], v[60:75]
  v_mfma_f32_32x32x16_bf16 v[44:59], a[60:63], v[100:103], v[44:59]
  v_mfma_f32_32x32x16_bf16 v[28:43], a[56:59], v[104:107], v[28:43]
  s_waitcnt vmcnt(0)
  v_mfma_f32_32x32x16_bf16 v[12:27], a[56:59], v[100:103], v[12:27]
  v_mfma_f32_32x32x16_bf16 v[60:75], a[68:71], v[112:115], v[60:75]
  v_mfma_f32_32x32x16_bf16 v[44:59], a[68:71], v[108:111], v[44:59]
  v_mfma_f32_32x32x16_bf16 v[28:43], a[64:67], v[112:115], v[28:43]
  v_mfma_f32_32x32x16_bf16 v[12:27], a[64:67], v[108:111], v[12:27]
  v_add_u32 v251, s43, v254
  s_xor_b32 s44, s26, 1
  s_mul_i32 s44, s44, 40960
  v_add_u32 v249, s44, v254
  s_xor_b32 s44, s26, 2
  s_mul_i32 s44, s44, 40960
  v_add_u32 v248, s44, v254
  s_xor_b32 s44, s26, 3
  s_mul_i32 s44, s44, 40960
  v_add_u32 v240, s44, v254
  ds_write_b128 v251, v[44:47] offset:18432
  ds_write_b128 v251, v[48:51] offset:19456
  ds_write_b128 v251, v[52:55] offset:20480
  ds_write_b128 v251, v[56:59] offset:21504
  ds_write_b128 v251, v[28:31] offset:22528
  ds_write_b128 v251, v[32:35] offset:23552
  ds_write_b128 v251, v[36:39] offset:24576
  ds_write_b128 v251, v[40:43] offset:25600
  ds_write_b128 v251, v[60:63] offset:26624
  ds_write_b128 v251, v[64:67] offset:27648
  ds_write_b128 v251, v[68:71] offset:28672
  ds_write_b128 v251, v[72:75] offset:29696
  s_waitcnt lgkmcnt(0)
  s_barrier
  ds_read_b128 v[44:47], v249 offset:18432
  ds_read_b128 v[48:51], v249 offset:19456
  ds_read_b128 v[52:55], v249 offset:20480
  ds_read_b128 v[56:59], v249 offset:21504
  ds_read_b128 v[28:31], v248 offset:22528
  ds_read_b128 v[32:35], v248 offset:23552
  ds_read_b128 v[36:39], v248 offset:24576
  ds_read_b128 v[40:43], v248 offset:25600
  ds_read_b128 v[60:63], v240 offset:26624
  ds_read_b128 v[64:67], v240 offset:27648
  ds_read_b128 v[68:71], v240 offset:28672
  ds_read_b128 v[72:75], v240 offset:29696
  s_waitcnt lgkmcnt(8)
  v_pk_add_f32 v[12:13], v[12:13], v[44:45]
  v_pk_add_f32 v[14:15], v[14:15], v[46:47]
  v_pk_add_f32 v[16:17], v[16:17], v[48:49]
  v_pk_add_f32 v[18:19], v[18:19], v[50:51]
  v_pk_add_f32 v[20:21], v[20:21], v[52:53]
  v_pk_add_f32 v[22:23], v[22:23], v[54:55]
  v_pk_add_f32 v[24:25], v[24:25], v[56:57]
  v_pk_add_f32 v[26:27], v[26:27], v[58:59]
  s_waitcnt lgkmcnt(4)
  v_pk_add_f32 v[12:13], v[12:13], v[28:29]
  v_pk_add_f32 v[14:15], v[14:15], v[30:31]
  v_pk_add_f32 v[16:17], v[16:17], v[32:33]
  v_pk_add_f32 v[18:19], v[18:19], v[34:35]
  v_pk_add_f32 v[20:21], v[20:21], v[36:37]
  v_pk_add_f32 v[22:23], v[22:23], v[38:39]
  v_pk_add_f32 v[24:25], v[24:25], v[40:41]
  v_pk_add_f32 v[26:27], v[26:27], v[42:43]
  s_waitcnt lgkmcnt(0)
  v_pk_add_f32 v[12:13], v[12:13], v[60:61]
  v_pk_add_f32 v[14:15], v[14:15], v[62:63]
  v_pk_add_f32 v[16:17], v[16:17], v[64:65]
  v_pk_add_f32 v[18:19], v[18:19], v[66:67]
  v_pk_add_f32 v[20:21], v[20:21], v[68:69]
  v_pk_add_f32 v[22:23], v[22:23], v[70:71]
  v_pk_add_f32 v[24:25], v[24:25], v[72:73]
  v_pk_add_f32 v[26:27], v[26:27], v[74:75]
  v_cvt_pk_bf16_f32 v12, v12, v13
  v_cvt_pk_bf16_f32 v13, v14, v15
  v_cvt_pk_bf16_f32 v14, v16, v17
  v_cvt_pk_bf16_f32 v15, v18, v19
  v_cvt_pk_bf16_f32 v20, v20, v21
  v_cvt_pk_bf16_f32 v21, v22, v23
  v_cvt_pk_bf16_f32 v22, v24, v25
  v_cvt_pk_bf16_f32 v23, v26, v27
  v_permlane32_swap_b32 v12, v14
  v_permlane32_swap_b32 v13, v15
  v_permlane32_swap_b32 v20, v22
  v_permlane32_swap_b32 v21, v23
  buffer_store_dwordx4 v[12:15], v238, s[12:15], s60 offen offset:0
  buffer_store_dwordx4 v[20:23], v238, s[12:15], s60 offen offset:32
END:
  s_endpgm
CODEEND:
TAG_3:
  s_mov_b32 s3, 0
TAG_3_a:
  s_add_u32 s3, s3, 1
  s_cmp_gt_u32 s3, 100000
  s_cbranch_scc1 TAGOK_4
  global_load_dword v49, v248, s[22:23] sc1
  s_waitcnt vmcnt(0)
  v_readfirstlane_b32 s42, v49
  s_cmp_eq_u32 s42, 0
  s_cbranch_scc1 TAG_3_a
  s_branch TAGOK_4
POLL_5:
  s_mov_b32 s3, 0
POLL_5_a:
  s_add_u32 s3, s3, 1
  s_cmp_gt_u32 s3, 100000
  s_cbranch_scc1 POLLOK_6
  s_sleep 2
  buffer_load_dword v253, v247, s[32:35], 0 offen sc1
  s_waitcnt vmcnt(0)
  v_cmp_ne_u32 vcc, s42, v253
  s_cbranch_vccnz POLL_5_a
  s_branch POLLOK_6
UCHK_7:
  s_mov_b32 s3, 0
UCHK_7_a:
  s_add_u32 s3, s3, 1
  s_cmp_gt_u32 s3, 100000
  s_cbranch_scc1 UOK_8
  s_sleep 1
  buffer_load_dwordx4 v[116:119], v254, s[32:35], s74 offen offset:0 sc1
  buffer_load_dwordx4 v[120:123], v254, s[32:35], s74 offen offset:1024 sc1
  buffer_load_dwordx4 v[124:127], v254, s[32:35], s74 offen offset:2048 sc1
  buffer_load_dwordx4 v[128:131], v254, s[32:35], s74 offen offset:3072 sc1
  s_waitcnt vmcnt(0)
  v_xor_b32 v52, s42, v119
  v_xor_b32 v53, s42, v123
  v_xor_b32 v54, s42, v127
  v_xor_b32 v55, s42, v131
  v_or3_b32 v52, v52, v53, v54
  v_or_b32 v52, v52, v55
  v_cmp_ne_u32 vcc, 0, v52
  s_cbranch_vccnz UCHK_7_a
  s_branch UOK_8
POLL_9:
  s_mov_b32 s3, 0
POLL_9_a:
  s_add_u32 s3, s3, 1
  s_cmp_gt_u32 s3, 100000
  s_cbranch_scc1 POLLOK_10
  s_sleep 2
  buffer_load_dword v249, v230, s[32:35], 0 offen sc1
  s_waitcnt vmcnt(0)
  v_cmp_ne_u32 vcc, s42, v249
  s_cbranch_vccnz POLL_9_a
  s_branch POLLOK_10
POLL_11:
  s_mov_b32 s3, 0
POLL_11_a:
  s_add_u32 s3, s3, 1
  s_cmp_gt_u32 s3, 100000
  s_cbranch_scc1 POLLOK_12
  s_sleep 2
  buffer_load_dword v253, v226, s[36:39], 0 offen sc1
  s_waitcnt vmcnt(0)
  v_cmp_eq_u32 vcc, -1, v253
  s_cbranch_vccnz POLL_11_a
  s_branch POLLOK_12
CHK_13:
  s_mov_b32 s49, 0
CHK_13_a:
  s_add_u32 s49, s49, 1
  s_cmp_gt_u32 s49, 100000
  s_cbranch_scc1 CHKOK_14
  s_sleep 1
  buffer_load_dwordx4 v[4:7], v246, s[84:87], s57 offen sc1
  buffer_load_dwordx4 v[8:11], v245, s[84:87], s57 offen sc1
  s_waitcnt vmcnt(0)
  v_max3_u32 v252, v4, v5, v6
  v_max3_u32 v252, v252, v7, v8
  v_max3_u32 v252, v252, v9, v10
  v_max_u32 v252, v252, v11
  v_cmp_eq_u32 vcc, -1, v252
  s_cbranch_vccnz CHK_13_a
  s_branch CHKOK_14
CHK_15:
  s_mov_b32 s49, 0
CHK_15_a:
  s_add_u32 s49, s49, 1
  s_cmp_gt_u32 s49, 100000
  s_cbranch_scc1 CHKOK_16
  s_sleep 1
  buffer_load_dwordx4 v[76:79], v246, s[84:87], s58 offen sc1
  buffer_load_dwordx4 v[80:83], v245, s[84:87], s58 offen sc1
  s_waitcnt vmcnt(0)
  v_max3_u32 v252, v76, v77, v78
  v_max3_u32 v252, v252, v79, v80
  v_max3_u32 v252, v252, v81, v82
  v_max_u32 v252, v252, v83
  v_cmp_eq_u32 vcc, -1, v252
  s_cbranch_vccnz CHK_15_a
  s_branch CHKOK_16
CHK_17:
  s_mov_b32 s49, 0
CHK_17_a:
  s_add_u32 s49, s49, 1
  s_cmp_gt_u32 s49, 100000
  s_cbranch_scc1 CHKOK_18
  s_sleep 1
  buffer_load_dwordx4 v[84:87], v246, s[84:87], s59 offen sc1
  buffer_load_dwordx4 v[88:91], v245, s[84:87], s59 offen sc1
  s_waitcnt vmcnt(0)
  v_max3_u32 v252, v84, v85, v86
  v_max3_u32 v252, v252, v87, v88
  v_max3_u32 v252, v252, v89, v90
  v_max_u32 v252, v252, v91
  v_cmp_eq_u32 vcc, -1, v252
  s_cbranch_vccnz CHK_17_a
  s_branch CHKOK_18
CHK_19:
  s_mov_b32 s49, 0
CHK_19_a:
  s_add_u32 s49, s49, 1
  s_cmp_gt_u32 s49, 100000
  s_cbranch_scc1 CHKOK_20
  s_sleep 1
  buffer_load_dwordx4 v[92:95], v246, s[84:87], s60 offen sc1
  buffer_load_dwordx4 v[96:99], v245, s[84:87], s60 offen sc1
  s_waitcnt vmcnt(0)
  v_max3_u32 v252, v92, v93, v94
  v_max3_u32 v252, v252, v95, v96
  v_max3_u32 v252, v252, v97, v98
  v_max_u32 v252, v252, v99
  v_cmp_eq_u32 vcc, -1, v252
  s_cbranch_vccnz CHK_19_a
  s_branch CHKOK_20
CHK_21:
  s_mov_b32 s49, 0
CHK_21_a:
  s_add_u32 s49, s49, 1
  s_cmp_gt_u32 s49, 100000
  s_cbranch_scc1 CHKOK_22
  s_sleep 1
  buffer_load_dwordx4 v[100:103], v246, s[84:87], s61 offen sc1
  buffer_load_dwordx4 v[104:107], v245, s[84:87], s61 offen sc1
  s_waitcnt vmcnt(0)
  v_max3_u32 v252, v100, v101, v102
  v_max3_u32 v252, v252, v103, v104
  v_max3_u32 v252, v252, v105, v106
  v_max_u32 v252, v252, v107
  v_cmp_eq_u32 vcc, -1, v252
  s_cbranch_vccnz CHK_21_a
  s_branch CHKOK_22
CHK_23:
  s_mov_b32 s49, 0
CHK_23_a:
  s_add_u32 s49, s49, 1
  s_cmp_gt_u32 s49, 100000
  s_cbranch_scc1 CHKOK_24
  s_sleep 1
  buffer_load_dwordx4 v[108:111], v246, s[84:87], s62 offen sc1
  buffer_load_dwordx4 v[112:115], v245, s[84:87], s62 offen sc1
  s_waitcnt vmcnt(0)
  v_max3_u32 v252, v108, v109, v110
  v_max3_u32 v252, v252, v111, v112
  v_max3_u32 v252, v252, v113, v114
  v_max_u32 v252, v252, v115
  v_cmp_eq_u32 vcc, -1, v252
  s_cbranch_vccnz CHK_23_a
  s_branch CHKOK_24
CHK_25:
  s_mov_b32 s49, 0
CHK_25_a:
  s_add_u32 s49, s49, 1
  s_cmp_gt_u32 s49, 100000
  s_cbranch_scc1 CHKOK_26
  s_sleep 1
  buffer_load_dwordx4 v[4:7], v246, s[84:87], s57 offen sc1
  buffer_load_dwordx4 v[8:11], v245, s[84:87], s57 offen sc1
  s_waitcnt vmcnt(0)
  v_max3_u32 v252, v4, v5, v6
  v_max3_u32 v252, v252, v7, v8
  v_max3_u32 v252, v252, v9, v10
  v_max_u32 v252, v252, v11
  v_cmp_eq_u32 vcc, -1, v252
  s_cbranch_vccnz CHK_25_a
  s_branch CHKOK_26
CHK_27:
  s_mov_b32 s49, 0
CHK_27_a:
  s_add_u32 s49, s49, 1
  s_cmp_gt_u32 s49, 100000
  s_cbranch_scc1 CHKOK_28
  s_sleep 1
  buffer_load_dwordx4 v[76:79], v246, s[84:87], s58 offen sc1
  buffer_load_dwordx4 v[80:83], v245, s[84:87], s58 offen sc1
  s_waitcnt vmcnt(0)
  v_max3_u32 v252, v76, v77, v78
  v_max3_u32 v252, v252, v79, v80
  v_max3_u32 v252, v252, v81, v82
  v_max_u32 v252, v252, v83
  v_cmp_eq_u32 vcc, -1, v252
  s_cbranch_vccnz CHK_27_a
  s_branch CHKOK_28
CHK_29:
  s_mov_b32 s49, 0
CHK_29_a:
  s_add_u32 s49, s49, 1
  s_cmp_gt_u32 s49, 100000
  s_cbranch_scc1 CHKOK_30
  s_sleep 1
  buffer_load_dwordx4 v[84:87], v246, s[84:87], s59 offen sc1
  buffer_load_dwordx4 v[88:91], v245, s[84:87], s59 offen sc1
  s_waitcnt vmcnt(0)
  v_max3_u32 v252, v84, v85, v86
  v_max3_u32 v252, v252, v87, v88
  v_max3_u32 v252, v252, v89, v90
  v_max_u32 v252, v252, v91
  v_cmp_eq_u32 vcc, -1, v252
  s_cbranch_vccnz CHK_29_a
  s_branch CHKOK_30
CHK_31:
  s_mov_b32 s49, 0
CHK_31_a:
  s_add_u32 s49, s49, 1
  s_cmp_gt_u32 s49, 100000
  s_cbranch_scc1 CHKOK_32
  s_sleep 1
  buffer_load_dwordx4 v[92:95], v246, s[84:87], s60 offen sc1
  buffer_load_dwordx4 v[96:99], v245, s[84:87], s60 offen sc1
  s_waitcnt vmcnt(0)
  v_max3_u32 v252, v92, v93, v94
  v_max3_u32 v252, v252, v95, v96
  v_max3_u32 v252, v252, v97, v98
  v_max_u32 v252, v252, v99
  v_cmp_eq_u32 vcc, -1, v252
  s_cbranch_vccnz CHK_31_a
  s_branch CHKOK_32
CHK_33:
  s_mov_b32 s49, 0
CHK_33_a:
  s_add_u32 s49, s49, 1
  s_cmp_gt_u32 s49, 100000
  s_cbranch_scc1 CHKOK_34
  s_sleep 1
  buffer_load_dwordx4 v[100:103], v246, s[84:87], s61 offen sc1
  buffer_load_dwordx4 v[104:107], v245, s[84:87], s61 offen sc1
  s_waitcnt vmcnt(0)
  v_max3_u32 v252, v100, v101, v102
  v_max3_u32 v252, v252, v103, v104
  v_max3_u32 v252, v252, v105, v106
  v_max_u32 v252, v252, v107
  v_cmp_eq_u32 vcc, -1, v252
  s_cbranch_vccnz CHK_33_a
  s_branch CHKOK_34
CHK_35:
  s_mov_b32 s49, 0
CHK_35_a:
  s_add_u32 s49, s49, 1
  s_cmp_gt_u32 s49, 100000
  s_cbranch_scc1 CHKOK_36
  s_sleep 1
  buffer_load_dwordx4 v[108:111], v246, s[84:87], s62 offen sc1
  buffer_load_dwordx4 v[112:115], v245, s[84:87], s62 offen sc1
  s_waitcnt vmcnt(0)
  v_max3_u32 v252, v108, v109, v110
  v_max3_u32 v252, v252, v111, v112
  v_max3_u32 v252, v252, v113, v114
  v_max_u32 v252, v252, v115
  v_cmp_eq_u32 vcc, -1, v252
  s_cbranch_vccnz CHK_35_a
  s_branch CHKOK_36
CHK_37:
  s_mov_b32 s49, 0
CHK_37_a:
  s_add_u32 s49, s49, 1
  s_cmp_gt_u32 s49, 100000
  s_cbranch_scc1 CHKOK_38
  s_sleep 1
  buffer_load_dwordx4 v[4:7], v246, s[84:87], s57 offen sc1
  buffer_load_dwordx4 v[8:11], v245, s[84:87], s57 offen sc1
  s_waitcnt vmcnt(0)
  v_max3_u32 v252, v4, v5, v6
  v_max3_u32 v252, v252, v7, v8
  v_max3_u32 v252, v252, v9, v10
  v_max_u32 v252, v252, v11
  v_cmp_eq_u32 vcc, -1, v252
  s_cbranch_vccnz CHK_37_a
  s_branch CHKOK_38
CHK_39:
  s_mov_b32 s49, 0
CHK_39_a:
  s_add_u32 s49, s49, 1
  s_cmp_gt_u32 s49, 100000
  s_cbranch_scc1 CHKOK_40
  s_sleep 1
  buffer_load_dwordx4 v[76:79], v246, s[84:87], s58 offen sc1
  buffer_load_dwordx4 v[80:83], v245, s[84:87], s58 offen sc1
  s_waitcnt vmcnt(0)
  v_max3_u32 v252, v76, v77, v78
  v_max3_u32 v252, v252, v79, v80
  v_max3_u32 v252, v252, v81, v82
  v_max_u32 v252, v252, v83
  v_cmp_eq_u32 vcc, -1, v252
  s_cbranch_vccnz CHK_39_a
  s_branch CHKOK_40
CHK_41:
  s_mov_b32 s49, 0
CHK_41_a:
  s_add_u32 s49, s49, 1
  s_cmp_gt_u32 s49, 100000
  s_cbranch_scc1 CHKOK_42
  s_sleep 1
  buffer_load_dwordx4 v[84:87], v246, s[84:87], s59 offen sc1
  buffer_load_dwordx4 v[88:91], v245, s[84:87], s59 offen sc1
  s_waitcnt vmcnt(0)
  v_max3_u32 v252, v84, v85, v86
  v_max3_u32 v252, v252, v87, v88
  v_max3_u32 v252, v252, v89, v90
  v_max_u32 v252, v252, v91
  v_cmp_eq_u32 vcc, -1, v252
  s_cbranch_vccnz CHK_41_a
  s_branch CHKOK_42
CHK_43:
  s_mov_b32 s49, 0
CHK_43_a:
  s_add_u32 s49, s49, 1
  s_cmp_gt_u32 s49, 100000
  s_cbranch_scc1 CHKOK_44
  s_sleep 1
  buffer_load_dwordx4 v[92:95], v246, s[84:87], s60 offen sc1
  buffer_load_dwordx4 v[96:99], v245, s[84:87], s60 offen sc1
  s_waitcnt vmcnt(0)
  v_max3_u32 v252, v92, v93, v94
  v_max3_u32 v252, v252, v95, v96
  v_max3_u32 v252, v252, v97, v98
  v_max_u32 v252, v252, v99
  v_cmp_eq_u32 vcc, -1, v252
  s_cbranch_vccnz CHK_43_a
  s_branch CHKOK_44
CHK_45:
  s_mov_b32 s49, 0
CHK_45_a:
  s_add_u32 s49, s49, 1
  s_cmp_gt_u32 s49, 100000
  s_cbranch_scc1 CHKOK_46
  s_sleep 1
  buffer_load_dwordx4 v[100:103], v246, s[84:87], s61 offen sc1
  buffer_load_dwordx4 v[104:107], v245, s[84:87], s61 offen sc1
  s_waitcnt vmcnt(0)
  v_max3_u32 v252, v100, v101, v102
  v_max3_u32 v252, v252, v103, v104
  v_max3_u32 v252, v252, v105, v106
  v_max_u32 v252, v252, v107
  v_cmp_eq_u32 vcc, -1, v252
  s_cbranch_vccnz CHK_45_a
  s_branch CHKOK_46
CHK_47:
  s_mov_b32 s49, 0
CHK_47_a:
  s_add_u32 s49, s49, 1
  s_cmp_gt_u32 s49, 100000
  s_cbranch_scc1 CHKOK_48
  s_sleep 1
  buffer_load_dwordx4 v[108:111], v246, s[84:87], s62 offen sc1
  buffer_load_dwordx4 v[112:115], v245, s[84:87], s62 offen sc1
  s_waitcnt vmcnt(0)
  v_max3_u32 v252, v108, v109, v110
  v_max3_u32 v252, v252, v111, v112
  v_max3_u32 v252, v252, v113, v114
  v_max_u32 v252, v252, v115
  v_cmp_eq_u32 vcc, -1, v252
  s_cbranch_vccnz CHK_47_a
  s_branch CHKOK_48
CHK_49:
  s_mov_b32 s49, 0
CHK_49_a:
  s_add_u32 s49, s49, 1
  s_cmp_gt_u32 s49, 100000
  s_cbranch_scc1 CHKOK_50
  s_sleep 1
  buffer_load_dwordx4 v[4:7], v246, s[84:87], s57 offen sc1
  buffer_load_dwordx4 v[8:11], v245, s[84:87], s57 offen sc1
  s_waitcnt vmcnt(0)
  v_max3_u32 v252, v4, v5, v6
  v_max3_u32 v252, v252, v7, v8
  v_max3_u32 v252, v252, v9, v10
  v_max_u32 v252, v252, v11
  v_cmp_eq_u32 vcc, -1, v252
  s_cbranch_vccnz CHK_49_a
  s_branch CHKOK_50
POLL_51:
  s_mov_b32 s3, 0
POLL_51_a:
  s_add_u32 s3, s3, 1
  s_cmp_gt_u32 s3, 100000
  s_cbranch_scc1 POLLOK_52
  s_sleep 2
  buffer_load_dword v253, v229, s[32:35], 0 offen sc1
  s_waitcnt vmcnt(0)
  v_cmp_ne_u32 vcc, s42, v253
  s_cbranch_vccnz POLL_51_a
  s_branch POLLOK_52
CHK_53:
  s_mov_b32 s49, 0
CHK_53_a:
  s_add_u32 s49, s49, 1
  s_cmp_gt_u32 s49, 100000
  s_cbranch_scc1 CHKOK_54
  s_sleep 1
  buffer_load_dwordx4 v[76:79], v246, s[84:87], s58 offen sc1
  buffer_load_dwordx4 v[80:83], v245, s[84:87], s58 offen sc1
  s_waitcnt vmcnt(0)
  v_max3_u32 v252, v76, v77, v78
  v_max3_u32 v252, v252, v79, v80
  v_max3_u32 v252, v252, v81, v82
  v_max_u32 v252, v252, v83
  v_cmp_eq_u32 vcc, -1, v252
  s_cbranch_vccnz CHK_53_a
  s_branch CHKOK_54
CHK_55:
  s_mov_b32 s49, 0
CHK_55_a:
  s_add_u32 s49, s49, 1
  s_cmp_gt_u32 s49, 100000
  s_cbranch_scc1 CHKOK_56
  s_sleep 1
  buffer_load_dwordx4 v[84:87], v246, s[84:87], s59 offen sc1
  buffer_load_dwordx4 v[88:91], v245, s[84:87], s59 offen sc1
  s_waitcnt vmcnt(0)
  v_max3_u32 v252, v84, v85, v86
  v_max3_u32 v252, v252, v87, v88
  v_max3_u32 v252, v252, v89, v90
  v_max_u32 v252, v252, v91
  v_cmp_eq_u32 vcc, -1, v252
  s_cbranch_vccnz CHK_55_a
  s_branch CHKOK_56
CHK_57:
  s_mov_b32 s49, 0
CHK_57_a:
  s_add_u32 s49, s49, 1
  s_cmp_gt_u32 s49, 100000
  s_cbranch_scc1 CHKOK_58
  s_sleep 1
  buffer_load_dwordx4 v[92:95], v246, s[84:87], s60 offen sc1
  buffer_load_dwordx4 v[96:99], v245, s[84:87], s60 offen sc1
  s_waitcnt vmcnt(0)
  v_max3_u32 v252, v92, v93, v94
  v_max3_u32 v252, v252, v95, v96
  v_max3_u32 v252, v252, v97, v98
  v_max_u32 v252, v252, v99
  v_cmp_eq_u32 vcc, -1, v252
  s_cbranch_vccnz CHK_57_a
  s_branch CHKOK_58
TAG_60:
  s_mov_b32 s3, 0
TAG_60_a:
  s_add_u32 s3, s3, 1
  s_cmp_gt_u32 s3, 100000
  s_cbranch_scc1 TAGOK_61
  global_load_dword v41, v245, s[22:23] sc1
  s_waitcnt vmcnt(0)
  v_readfirstlane_b32 s42, v41
  s_cmp_eq_u32 s42, 0
  s_cbranch_scc1 TAG_60_a
  s_branch TAGOK_61
POLL_62:
  s_mov_b32 s3, 0
POLL_62_a:
  s_add_u32 s3, s3, 1
  s_cmp_gt_u32 s3, 100000
  s_cbranch_scc1 POLLOK_63
  s_sleep 2
  buffer_load_dword v211, v225, s[32:35], 0 offen sc1
  s_waitcnt vmcnt(0)
  v_cmp_ne_u32 vcc, s42, v211
  s_cbranch_vccnz POLL_62_a
  s_branch POLLOK_63
POLL_66:
  s_mov_b32 s3, 0
POLL_66_a:
  s_add_u32 s3, s3, 1
  s_cmp_gt_u32 s3, 100000
  s_cbranch_scc1 POLLOK_67
  s_sleep 2
  buffer_load_dword v249, v251, s[32:35], 0 offen sc1
  s_waitcnt vmcnt(0)
  v_cmp_ne_u32 vcc, s42, v249
  s_cbranch_vccnz POLL_66_a
  s_branch POLLOK_67
POLL_68:
  s_mov_b32 s3, 0
POLL_68_a:
  s_add_u32 s3, s3, 1
  s_cmp_gt_u32 s3, 100000
  s_cbranch_scc1 POLLOK_69
  s_sleep 2
  buffer_load_dword v239, v248, s[32:35], 0 offen sc1
  s_waitcnt vmcnt(0)
  v_cmp_ne_u32 vcc, s42, v239
  s_cbranch_vccnz POLL_68_a
  s_branch POLLOK_69
POLL_70:
  s_waitcnt vmcnt(0)
  s_mov_b64 exec, 1
  buffer_store_dword v206, v207, s[32:35], s93 offen sc1
  s_mov_b64 exec, -1
  s_mov_b32 s3, 0
POLL_70_a:
  s_add_u32 s3, s3, 1
  s_cmp_gt_u32 s3, 100000
  s_cbranch_scc1 POLLOK_71
  s_sleep 2
  buffer_load_dword v251, v240, s[36:39], 0 offen sc1
  s_waitcnt vmcnt(0)
  v_cmp_eq_u32 vcc, -1, v251
  s_cbranch_vccnz POLL_70_a
  s_branch POLLOK_71
CHK_72:
  s_mov_b32 s49, 0
CHK_72_a:
  s_add_u32 s49, s49, 1
  s_cmp_gt_u32 s49, 100000
  s_cbranch_scc1 CHKOK_73
  s_sleep 1
  buffer_load_dwordx4 v[4:7], v243, s[84:87], s56 offen sc1
  buffer_load_dwordx4 v[8:11], v242, s[84:87], s56 offen sc1
  s_waitcnt vmcnt(0)
  v_max3_u32 v250, v4, v5, v6
  v_max3_u32 v250, v250, v7, v8
  v_max3_u32 v250, v250, v9, v10
  v_max_u32 v250, v250, v11
  v_cmp_eq_u32 vcc, -1, v250
  s_cbranch_vccnz CHK_72_a
  s_branch CHKOK_73
CHK_74:
  s_mov_b32 s49, 0
CHK_74_a:
  s_add_u32 s49, s49, 1
  s_cmp_gt_u32 s49, 100000
  s_cbranch_scc1 CHKOK_75
  s_sleep 1
  buffer_load_dwordx4 v[76:79], v243, s[84:87], s57 offen sc1
  buffer_load_dwordx4 v[80:83], v242, s[84:87], s57 offen sc1
  s_waitcnt vmcnt(0)
  v_max3_u32 v250, v76, v77, v78
  v_max3_u32 v250, v250, v79, v80
  v_max3_u32 v250, v250, v81, v82
  v_max_u32 v250, v250, v83
  v_cmp_eq_u32 vcc, -1, v250
  s_cbranch_vccnz CHK_74_a
  s_branch CHKOK_75
CHK_76:
  s_mov_b32 s49, 0
CHK_76_a:
  s_add_u32 s49, s49, 1
  s_cmp_gt_u32 s49, 100000
  s_cbranch_scc1 CHKOK_77
  s_sleep 1
  buffer_load_dwordx4 v[84:87], v243, s[84:87], s58 offen sc1
  buffer_load_dwordx4 v[88:91], v242, s[84:87], s58 offen sc1
  s_waitcnt vmcnt(0)
  v_max3_u32 v250, v84, v85, v86
  v_max3_u32 v250, v250, v87, v88
  v_max3_u32 v250, v250, v89, v90
  v_max_u32 v250, v250, v91
  v_cmp_eq_u32 vcc, -1, v250
  s_cbranch_vccnz CHK_76_a
  s_branch CHKOK_77
CHK_78:
  s_mov_b32 s49, 0
CHK_78_a:
  s_add_u32 s49, s49, 1
  s_cmp_gt_u32 s49, 100000
  s_cbranch_scc1 CHKOK_79
  s_sleep 1
  buffer_load_dwordx4 v[92:95], v243, s[84:87], s59 offen sc1
  buffer_load_dwordx4 v[96:99], v242, s[84:87], s59 offen sc1
  s_waitcnt vmcnt(0)
  v_max3_u32 v250, v92, v93, v94
  v_max3_u32 v250, v250, v95, v96
  v_max3_u32 v250, v250, v97, v98
  v_max_u32 v250, v250, v99
  v_cmp_eq_u32 vcc, -1, v250
  s_cbranch_vccnz CHK_78_a
  s_branch CHKOK_79
CHK_80:
  s_mov_b32 s49, 0
CHK_80_a:
  s_add_u32 s49, s49, 1
  s_cmp_gt_u32 s49, 100000
  s_cbranch_scc1 CHKOK_81
  s_sleep 1
  buffer_load_dwordx4 v[100:103], v243, s[84:87], s61 offen sc1
  buffer_load_dwordx4 v[104:107], v242, s[84:87], s61 offen sc1
  s_waitcnt vmcnt(0)
  v_max3_u32 v250, v100, v101, v102
  v_max3_u32 v250, v250, v103, v104
  v_max3_u32 v250, v250, v105, v106
  v_max_u32 v250, v250, v107
  v_cmp_eq_u32 vcc, -1, v250
  s_cbranch_vccnz CHK_80_a
  s_branch CHKOK_81
CHK_82:
  s_mov_b32 s49, 0
CHK_82_a:
  s_add_u32 s49, s49, 1
  s_cmp_gt_u32 s49, 100000
  s_cbranch_scc1 CHKOK_83
  s_sleep 1
  buffer_load_dwordx4 v[108:111], v243, s[84:87], s62 offen sc1
  buffer_load_dwordx4 v[112:115], v242, s[84:87], s62 offen sc1
  s_waitcnt vmcnt(0)
  v_max3_u32 v250, v108, v109, v110
  v_max3_u32 v250, v250, v111, v112
  v_max3_u32 v250, v250, v113, v114
  v_max_u32 v250, v250, v115
  v_cmp_eq_u32 vcc, -1, v250
  s_cbranch_vccnz CHK_82_a
  s_branch CHKOK_83
CHK_84:
  s_mov_b32 s49, 0
CHK_84_a:
  s_add_u32 s49, s49, 1
  s_cmp_gt_u32 s49, 100000
  s_cbranch_scc1 CHKOK_85
  s_sleep 1
  buffer_load_dwordx4 v[4:7], v243, s[84:87], s56 offen sc1
  buffer_load_dwordx4 v[8:11], v242, s[84:87], s56 offen sc1
  s_waitcnt vmcnt(0)
  v_max3_u32 v250, v4, v5, v6
  v_max3_u32 v250, v250, v7, v8
  v_max3_u32 v250, v250, v9, v10
  v_max_u32 v250, v250, v11
  v_cmp_eq_u32 vcc, -1, v250
  s_cbranch_vccnz CHK_84_a
  s_branch CHKOK_85
CHK_86:
  s_mov_b32 s49, 0
CHK_86_a:
  s_add_u32 s49, s49, 1
  s_cmp_gt_u32 s49, 100000
  s_cbranch_scc1 CHKOK_87
  s_sleep 1
  buffer_load_dwordx4 v[76:79], v243, s[84:87], s57 offen sc1
  buffer_load_dwordx4 v[80:83], v242, s[84:87], s57 offen sc1
  s_waitcnt vmcnt(0)
  v_max3_u32 v250, v76, v77, v78
  v_max3_u32 v250, v250, v79, v80
  v_max3_u32 v250, v250, v81, v82
  v_max_u32 v250, v250, v83
  v_cmp_eq_u32 vcc, -1, v250
  s_cbranch_vccnz CHK_86_a
  s_branch CHKOK_87
CHK_88:
  s_mov_b32 s49, 0
CHK_88_a:
  s_add_u32 s49, s49, 1
  s_cmp_gt_u32 s49, 100000
  s_cbranch_scc1 CHKOK_89
  s_sleep 1
  buffer_load_dwordx4 v[84:87], v243, s[84:87], s58 offen sc1
  buffer_load_dwordx4 v[88:91], v242, s[84:87], s58 offen sc1
  s_waitcnt vmcnt(0)
  v_max3_u32 v250, v84, v85, v86
  v_max3_u32 v250, v250, v87, v88
  v_max3_u32 v250, v250, v89, v90
  v_max_u32 v250, v250, v91
  v_cmp_eq_u32 vcc, -1, v250
  s_cbranch_vccnz CHK_88_a
  s_branch CHKOK_89
CHK_90:
  s_mov_b32 s49, 0
CHK_90_a:
  s_add_u32 s49, s49, 1
  s_cmp_gt_u32 s49, 100000
  s_cbranch_scc1 CHKOK_91
  s_sleep 1
  buffer_load_dwordx4 v[92:95], v243, s[84:87], s59 offen sc1
  buffer_load_dwordx4 v[96:99], v242, s[84:87], s59 offen sc1
  s_waitcnt vmcnt(0)
  v_max3_u32 v250, v92, v93, v94
  v_max3_u32 v250, v250, v95, v96
  v_max3_u32 v250, v250, v97, v98
  v_max_u32 v250, v250, v99
  v_cmp_eq_u32 vcc, -1, v250
  s_cbranch_vccnz CHK_90_a
  s_branch CHKOK_91
CHK_92:
  s_mov_b32 s49, 0
CHK_92_a:
  s_add_u32 s49, s49, 1
  s_cmp_gt_u32 s49, 100000
  s_cbranch_scc1 CHKOK_93
  s_sleep 1
  buffer_load_dwordx4 v[100:103], v243, s[84:87], s61 offen sc1
  buffer_load_dwordx4 v[104:107], v242, s[84:87], s61 offen sc1
  s_waitcnt vmcnt(0)
  v_max3_u32 v250, v100, v101, v102
  v_max3_u32 v250, v250, v103, v104
  v_max3_u32 v250, v250, v105, v106
  v_max_u32 v250, v250, v107
  v_cmp_eq_u32 vcc, -1, v250
  s_cbranch_vccnz CHK_92_a
  s_branch CHKOK_93
CHK_94:
  s_mov_b32 s49, 0
CHK_94_a:
  s_add_u32 s49, s49, 1
  s_cmp_gt_u32 s49, 100000
  s_cbranch_scc1 CHKOK_95
  s_sleep 1
  buffer_load_dwordx4 v[108:111], v243, s[84:87], s62 offen sc1
  buffer_load_dwordx4 v[112:115], v242, s[84:87], s62 offen sc1
  s_waitcnt vmcnt(0)
  v_max3_u32 v250, v108, v109, v110
  v_max3_u32 v250, v250, v111, v112
  v_max3_u32 v250, v250, v113, v114
  v_max_u32 v250, v250, v115
  v_cmp_eq_u32 vcc, -1, v250
  s_cbranch_vccnz CHK_94_a
  s_branch CHKOK_95
CHK_96:
  s_mov_b32 s49, 0
CHK_96_a:
  s_add_u32 s49, s49, 1
  s_cmp_gt_u32 s49, 100000
  s_cbranch_scc1 CHKOK_97
  s_sleep 1
  buffer_load_dwordx4 v[4:7], v243, s[84:87], s56 offen sc1
  buffer_load_dwordx4 v[8:11], v242, s[84:87], s56 offen sc1
  s_waitcnt vmcnt(0)
  v_max3_u32 v250, v4, v5, v6
  v_max3_u32 v250, v250, v7, v8
  v_max3_u32 v250, v250, v9, v10
  v_max_u32 v250, v250, v11
  v_cmp_eq_u32 vcc, -1, v250
  s_cbranch_vccnz CHK_96_a
  s_branch CHKOK_97
CHK_98:
  s_mov_b32 s49, 0
CHK_98_a:
  s_add_u32 s49, s49, 1
  s_cmp_gt_u32 s49, 100000
  s_cbranch_scc1 CHKOK_99
  s_sleep 1
  buffer_load_dwordx4 v[76:79], v243, s[84:87], s57 offen sc1
  buffer_load_dwordx4 v[80:83], v242, s[84:87], s57 offen sc1
  s_waitcnt vmcnt(0)
  v_max3_u32 v250, v76, v77, v78
  v_max3_u32 v250, v250, v79, v80
  v_max3_u32 v250, v250, v81, v82
  v_max_u32 v250, v250, v83
  v_cmp_eq_u32 vcc, -1, v250
  s_cbranch_vccnz CHK_98_a
  s_branch CHKOK_99
CHK_100:
  s_mov_b32 s49, 0
CHK_100_a:
  s_add_u32 s49, s49, 1
  s_cmp_gt_u32 s49, 100000
  s_cbranch_scc1 CHKOK_101
  s_sleep 1
  buffer_load_dwordx4 v[84:87], v243, s[84:87], s58 offen sc1
  buffer_load_dwordx4 v[88:91], v242, s[84:87], s58 offen sc1
  s_waitcnt vmcnt(0)
  v_max3_u32 v250, v84, v85, v86
  v_max3_u32 v250, v250, v87, v88
  v_max3_u32 v250, v250, v89, v90
  v_max_u32 v250, v250, v91
  v_cmp_eq_u32 vcc, -1, v250
  s_cbranch_vccnz CHK_100_a
  s_branch CHKOK_101
CHK_102:
  s_mov_b32 s49, 0
CHK_102_a:
  s_add_u32 s49, s49, 1
  s_cmp_gt_u32 s49, 100000
  s_cbranch_scc1 CHKOK_103
  s_sleep 1
  buffer_load_dwordx4 v[92:95], v243, s[84:87], s59 offen sc1
  buffer_load_dwordx4 v[96:99], v242, s[84:87], s59 offen sc1
  s_waitcnt vmcnt(0)
  v_max3_u32 v250, v92, v93, v94
  v_max3_u32 v250, v250, v95, v96
  v_max3_u32 v250, v250, v97, v98
  v_max_u32 v250, v250, v99
  v_cmp_eq_u32 vcc, -1, v250
  s_cbranch_vccnz CHK_102_a
  s_branch CHKOK_103
CHK_104:
  s_mov_b32 s49, 0
CHK_104_a:
  s_add_u32 s49, s49, 1
  s_cmp_gt_u32 s49, 100000
  s_cbranch_scc1 CHKOK_105
  s_sleep 1
  buffer_load_dwordx4 v[100:103], v243, s[84:87], s61 offen sc1
  buffer_load_dwordx4 v[104:107], v242, s[84:87], s61 offen sc1
  s_waitcnt vmcnt(0)
  v_max3_u32 v250, v100, v101, v102
  v_max3_u32 v250, v250, v103, v104
  v_max3_u32 v250, v250, v105, v106
  v_max_u32 v250, v250, v107
  v_cmp_eq_u32 vcc, -1, v250
  s_cbranch_vccnz CHK_104_a
  s_branch CHKOK_105
CHK_106:
  s_mov_b32 s49, 0
CHK_106_a:
  s_add_u32 s49, s49, 1
  s_cmp_gt_u32 s49, 100000
  s_cbranch_scc1 CHKOK_107
  s_sleep 1
  buffer_load_dwordx4 v[108:111], v243, s[84:87], s62 offen sc1
  buffer_load_dwordx4 v[112:115], v242, s[84:87], s62 offen sc1
  s_waitcnt vmcnt(0)
  v_max3_u32 v250, v108, v109, v110
  v_max3_u32 v250, v250, v111, v112
  v_max3_u32 v250, v250, v113, v114
  v_max_u32 v250, v250, v115
  v_cmp_eq_u32 vcc, -1, v250
  s_cbranch_vccnz CHK_106_a
  s_branch CHKOK_107
CHK_108:
  s_mov_b32 s49, 0
CHK_108_a:
  s_add_u32 s49, s49, 1
  s_cmp_gt_u32 s49, 100000
  s_cbranch_scc1 CHKOK_109
  s_sleep 1
  buffer_load_dwordx4 v[4:7], v243, s[84:87], s56 offen sc1
  buffer_load_dwordx4 v[8:11], v242, s[84:87], s56 offen sc1
  s_waitcnt vmcnt(0)
  v_max3_u32 v250, v4, v5, v6
  v_max3_u32 v250, v250, v7, v8
  v_max3_u32 v250, v250, v9, v10
  v_max_u32 v250, v250, v11
  v_cmp_eq_u32 vcc, -1, v250
  s_cbranch_vccnz CHK_108_a
  s_branch CHKOK_109
POLL_110:
  s_mov_b32 s3, 0
POLL_110_a:
  s_add_u32 s3, s3, 1
  s_cmp_gt_u32 s3, 100000
  s_cbranch_scc1 POLLOK_111
  s_sleep 2
  buffer_load_dword v251, v247, s[32:35], 0 offen sc1
  s_waitcnt vmcnt(0)
  v_cmp_ne_u32 vcc, s42, v251
  s_cbranch_vccnz POLL_110_a
  s_branch POLLOK_111
CHK_112:
  s_mov_b32 s49, 0
CHK_112_a:
  s_add_u32 s49, s49, 1
  s_cmp_gt_u32 s49, 100000
  s_cbranch_scc1 CHKOK_113
  s_sleep 1
  buffer_load_dwordx4 v[76:79], v243, s[84:87], s57 offen sc1
  buffer_load_dwordx4 v[80:83], v242, s[84:87], s57 offen sc1
  s_waitcnt vmcnt(0)
  v_max3_u32 v250, v76, v77, v78
  v_max3_u32 v250, v250, v79, v80
  v_max3_u32 v250, v250, v81, v82
  v_max_u32 v250, v250, v83
  v_cmp_eq_u32 vcc, -1, v250
  s_cbranch_vccnz CHK_112_a
  s_branch CHKOK_113
CHK_114:
  s_mov_b32 s49, 0
CHK_114_a:
  s_add_u32 s49, s49, 1
  s_cmp_gt_u32 s49, 100000
  s_cbranch_scc1 CHKOK_115
  s_sleep 1
  buffer_load_dwordx4 v[84:87], v243, s[84:87], s58 offen sc1
  buffer_load_dwordx4 v[88:91], v242, s[84:87], s58 offen sc1
  s_waitcnt vmcnt(0)
  v_max3_u32 v250, v84, v85, v86
  v_max3_u32 v250, v250, v87, v88
  v_max3_u32 v250, v250, v89, v90
  v_max_u32 v250, v250, v91
  v_cmp_eq_u32 vcc, -1, v250
  s_cbranch_vccnz CHK_114_a
  s_branch CHKOK_115
CHK_116:
  s_mov_b32 s49, 0
CHK_116_a:
  s_add_u32 s49, s49, 1
  s_cmp_gt_u32 s49, 100000
  s_cbranch_scc1 CHKOK_117
  s_sleep 1
  buffer_load_dwordx4 v[92:95], v243, s[84:87], s59 offen sc1
  buffer_load_dwordx4 v[96:99], v242, s[84:87], s59 offen sc1
  s_waitcnt vmcnt(0)
  v_max3_u32 v250, v92, v93, v94
  v_max3_u32 v250, v250, v95, v96
  v_max3_u32 v250, v250, v97, v98
  v_max_u32 v250, v250, v99
  v_cmp_eq_u32 vcc, -1, v250
  s_cbranch_vccnz CHK_116_a
  s_branch CHKOK_117
  s_endpgm
.section .rodata,"a"
.p2align 6
.amdhsa_kernel parallel_sum__linear_attn_block__mixer_token_mlp__prompt_kernel
  .amdhsa_next_free_vgpr 512
  .amdhsa_next_free_sgpr 102
  .amdhsa_accum_offset 256
  .amdhsa_group_segment_fixed_size 0
  .amdhsa_kernarg_size 88
  .amdhsa_user_sgpr_count 2
  .amdhsa_user_sgpr_kernarg_segment_ptr 1
  .amdhsa_system_sgpr_workgroup_id_x 1
.end_amdhsa_kernel
```
